```python
import torch

def _softmax(x, axis=-1):
    return torch.softmax(x, dim=axis)
def _gelu(x):
    return torch.nn.functional.gelu(x, approximate="tanh")
def _silu(x):
    return torch.nn.functional.silu(x)
def _sigmoid(x):
    return torch.sigmoid(x)
def _layernorm(x, axis=-1, eps=1e-5):
    m = x.mean(dim=axis, keepdim=True)
    v = x.var(dim=axis, keepdim=True, unbiased=False)
    return (x - m) / torch.sqrt(v + eps)
def _scatter_add(tgt, idx, src, axis=0):
    return tgt.clone().index_add_(axis, idx, src)
def _segment_sum(src, seg, n):
    out = torch.zeros((n,) + src.shape[1:], dtype=src.dtype)
    return out.index_add_(0, seg, src)
def _pad(x, pw):
    flat = tuple(v for pair in reversed(pw) for v in pair)
    return torch.nn.functional.pad(x, flat)

kernel_name = 'concat_heads__mha_block_cached__gqa_block_cached__near_ridge'

def setup_inputs():

    _w = (lambda a: (lambda t: t.to(torch.bfloat16) if t.is_floating_point() else t)(torch.as_tensor(a)))
    def _A_setup():
        B, Sq, D = 8, 192, 640
        H, Sk, Dh = 32, 512, 192
        return {
            "x": _w((lambda *s: torch.randn(*s, dtype=torch.bfloat16) * 0.8)(B, Sq, D)),
            "k_cache": _w((lambda *s: torch.randn(*s, dtype=torch.bfloat16) * 0.8)(B, H, Sk, Dh)),
            "v_cache": _w((lambda *s: torch.randn(*s, dtype=torch.bfloat16) * 0.05)(B, H, Sk, Dh)),
            "wq": _w((lambda *s: torch.randn(*s, dtype=torch.bfloat16) * 0.8)(D, H * Dh) * (D ** -0.5)),
            "wo": _w((lambda *s: torch.randn(*s, dtype=torch.bfloat16) * 0.05)(H * Dh, D) * ((H * Dh) ** -0.5)),
        }
    _A_in = _A_setup()

    def _B_setup():
        B, Sq, D = 8, 192, 640
        Hq, Hkv, Sk, Dh = 32, 32, 512, 192
        assert Hq % Hkv == 0, (Hq, Hkv)
        return {
            "x": _w((lambda *s: torch.randn(*s, dtype=torch.bfloat16) * 0.8)(B, Sq, D)),
            "k_cache": _w((lambda *s: torch.randn(*s, dtype=torch.bfloat16) * 0.8)(B, Hkv, Sk, Dh)),
            "v_cache": _w((lambda *s: torch.randn(*s, dtype=torch.bfloat16) * 0.05)(B, Hkv, Sk, Dh)),
            "wq": _w((lambda *s: torch.randn(*s, dtype=torch.bfloat16) * 0.8)(D, Hq * Dh) * (D ** -0.5)),
            "wo": _w((lambda *s: torch.randn(*s, dtype=torch.bfloat16) * 0.05)(Hq * Dh, D) * ((Hq * Dh) ** -0.5)),
        }
    _B_in = _B_setup()

    return {
        "A_x": _A_in["x"],
        "A_k_cache": _A_in["k_cache"],
        "A_v_cache": _A_in["v_cache"],
        "A_wq": _A_in["wq"],
        "A_wo": _A_in["wo"],
        "B_x": _B_in["x"],
        "B_k_cache": _B_in["k_cache"],
        "B_v_cache": _B_in["v_cache"],
        "B_wq": _B_in["wq"],
        "B_wo": _B_in["wo"],
    }

def reference(A_x, A_k_cache, A_v_cache, A_wq, A_wo, B_x, B_k_cache, B_v_cache, B_wq, B_wo):
    def _A_ref(x, k_cache, v_cache, wq, wo):
        B, Sq, D = x.shape
        H, Dh = 32, 192
        q = (lambda x, *d: x.permute(*d))((x @ wq).reshape(B, Sq, H, Dh), 0, 2, 1, 3)
        scores = torch.einsum("bhqd,bhkd->bhqk", q, k_cache) * (Dh ** -0.5)
        p = _softmax(scores, axis=-1)
        o = torch.einsum("bhqk,bhkd->bhqd", p, v_cache)
        return (lambda x, *d: x.permute(*d))(o, 0, 2, 1, 3).reshape(B, Sq, H * Dh) @ wo

    def _B_ref(x, k_cache, v_cache, wq, wo):
        B, Sq, D = x.shape
        Hq, Dh = 32, 192
        Hkv = k_cache.shape[1]
        rep = Hq // Hkv
        q = (lambda x, *d: x.permute(*d))((x @ wq).reshape(B, Sq, Hq, Dh), 0, 2, 1, 3)
        k = (lambda x, n, axis: torch.repeat_interleave(x, n, dim=axis))(k_cache, rep, axis=1)
        v = (lambda x, n, axis: torch.repeat_interleave(x, n, dim=axis))(v_cache, rep, axis=1)
        scores = torch.einsum("bhqd,bhkd->bhqk", q, k) * (Dh ** -0.5)
        p = _softmax(scores, axis=-1)
        o = torch.einsum("bhqk,bhkd->bhqd", p, v)
        return (lambda x, *d: x.permute(*d))(o, 0, 2, 1, 3).reshape(B, Sq, Hq * Dh) @ wo

    a = _A_ref(A_x, A_k_cache, A_v_cache, A_wq, A_wo)
    b = _B_ref(B_x, B_k_cache, B_v_cache, B_wq, B_wo)
    return torch.concatenate([a, b], axis=-1)
```

```asm
; @launch grid=(256,1,1) block=(256,1,1) lds=163840
.amdgcn_target "amdgcn-amd-amdhsa--gfx950"
.text
.globl concat_heads__mha_block_cached__gqa_block_cached__near_ridge_kernel
.p2align 8
.type concat_heads__mha_block_cached__gqa_block_cached__near_ridge_kernel,@function
concat_heads__mha_block_cached__gqa_block_cached__near_ridge_kernel:
    s_cmp_ge_u32 s2, 256
    s_cbranch_scc1 K1_end
    s_load_dwordx16 s[64:79], s[0:1], 0
    s_load_dwordx4 s[80:83], s[0:1], 64
    s_load_dwordx2 s[94:95], s[0:1], 96
    s_load_dwordx2 s[62:63], s[0:1], 88
    v_and_b32 v1, 63, v0
    v_lshrrev_b32 v2, 6, v0
    s_nop 0
    v_readfirstlane_b32 s3, v2
    s_and_b32 s4, s2, 7
    s_lshr_b32 s5, s2, 3
    s_lshr_b32 s6, s4, 2
    s_and_b32 s49, s4, 3
    s_and_b32 s7, s5, 7
    s_lshr_b32 s50, s5, 3
    s_lshl_b32 s49, s49, 3
    s_add_u32 s92, s49, s50
    s_mov_b32 s51, 2731
    v_add_u32 v2, 0, v1
    v_mul_lo_u32 v3, v2, s51
    v_lshrrev_b32 v3, 16, v3
    v_mul_u32_u24 v4, 24, v3
    v_sub_u32 v4, v2, v4
    v_lshrrev_b32 v5, 1, v3
    v_and_b32 v5, 3, v5
    v_lshlrev_b32 v5, 1, v5
    v_xor_b32 v4, v4, v5
    v_lshlrev_b32 v4, 4, v4
    s_lshl_b32 s52, s3, 4
    v_add_u32 v6, s52, v3
    s_mov_b32 s50, 384
    v_mul_lo_u32 v6, v6, s50
    v_add_u32 v8, v6, v4
    s_lshr_b32 s52, s3, 1
    s_lshl_b32 s52, s52, 5
    s_and_b32 s50, s3, 1
    s_lshl_b32 s50, s50, 2
    s_add_u32 s52, s52, s50
    v_lshrrev_b32 v6, 2, v3
    v_lshlrev_b32 v6, 3, v6
    v_and_b32 v5, 3, v3
    v_add_u32 v6, v6, v5
    v_add_u32 v6, s52, v6
    s_mov_b32 s50, 12288
    v_mul_lo_u32 v6, v6, s50
    v_add_u32 v247, v6, v4
    v_add_u32 v2, 64, v1
    v_mul_lo_u32 v3, v2, s51
    v_lshrrev_b32 v3, 16, v3
    v_mul_u32_u24 v4, 24, v3
    v_sub_u32 v4, v2, v4
    v_lshrrev_b32 v5, 1, v3
    v_and_b32 v5, 3, v5
    v_lshlrev_b32 v5, 1, v5
    v_xor_b32 v4, v4, v5
    v_lshlrev_b32 v4, 4, v4
    v_subrev_u32 v4, 1024, v4
    s_lshl_b32 s52, s3, 4
    v_add_u32 v6, s52, v3
    s_mov_b32 s50, 384
    v_mul_lo_u32 v6, v6, s50
    v_add_u32 v9, v6, v4
    s_lshr_b32 s52, s3, 1
    s_lshl_b32 s52, s52, 5
    s_and_b32 s50, s3, 1
    s_lshl_b32 s50, s50, 2
    s_add_u32 s52, s52, s50
    v_lshrrev_b32 v6, 2, v3
    v_lshlrev_b32 v6, 3, v6
    v_and_b32 v5, 3, v3
    v_add_u32 v6, v6, v5
    v_add_u32 v6, s52, v6
    s_mov_b32 s50, 12288
    v_mul_lo_u32 v6, v6, s50
    v_add_u32 v248, v6, v4
    v_add_u32 v2, 128, v1
    v_mul_lo_u32 v3, v2, s51
    v_lshrrev_b32 v3, 16, v3
    v_mul_u32_u24 v4, 24, v3
    v_sub_u32 v4, v2, v4
    v_lshrrev_b32 v5, 1, v3
    v_and_b32 v5, 3, v5
    v_lshlrev_b32 v5, 1, v5
    v_xor_b32 v4, v4, v5
    v_lshlrev_b32 v4, 4, v4
    v_subrev_u32 v4, 2048, v4
    s_lshl_b32 s52, s3, 4
    v_add_u32 v6, s52, v3
    s_mov_b32 s50, 384
    v_mul_lo_u32 v6, v6, s50
    v_add_u32 v10, v6, v4
    s_lshr_b32 s52, s3, 1
    s_lshl_b32 s52, s52, 5
    s_and_b32 s50, s3, 1
    s_lshl_b32 s50, s50, 2
    s_add_u32 s52, s52, s50
    v_lshrrev_b32 v6, 2, v3
    v_lshlrev_b32 v6, 3, v6
    v_and_b32 v5, 3, v3
    v_add_u32 v6, v6, v5
    v_add_u32 v6, s52, v6
    s_mov_b32 s50, 12288
    v_mul_lo_u32 v6, v6, s50
    v_add_u32 v249, v6, v4
    v_lshrrev_b32 v2, 2, v1
    v_and_b32 v3, 3, v1
    v_lshrrev_b32 v4, 4, v1
    v_lshrrev_b32 v6, 1, v4
    v_xor_b32 v5, v4, v6
    v_and_b32 v5, 1, v5
    v_lshlrev_b32 v5, 1, v5
    v_or_b32 v5, v5, v6
    v_xor_b32 v3, v3, v5
    v_lshlrev_b32 v3, 4, v3
    s_mul_i32 s52, s3, 48
    v_add_u32 v2, s52, v2
    s_mov_b32 s50, 1280
    v_mul_lo_u32 v2, v2, s50
    v_add_u32 v244, v2, v3
    v_add_u32 v245, 19456, v244
    v_add_u32 v246, 19456, v245
    v_and_b32 v2, 15, v1
    v_lshrrev_b32 v3, 4, v1
    v_lshrrev_b32 v4, 2, v2
    v_lshrrev_b32 v6, 1, v4
    v_xor_b32 v5, v4, v6
    v_and_b32 v5, 1, v5
    v_lshlrev_b32 v5, 1, v5
    v_or_b32 v5, v5, v6
    v_xor_b32 v5, v3, v5
    v_lshlrev_b32 v6, 2, v2
    v_add_u32 v5, v5, v6
    v_lshlrev_b32 v5, 4, v5
    s_mul_i32 s52, s3, 6144
    v_add_u32 v251, s52, v5
    v_lshrrev_b32 v5, 1, v2
    v_and_b32 v5, 3, v5
    v_lshlrev_b32 v5, 1, v5
    v_xor_b32 v5, v3, v5
    v_lshlrev_b32 v5, 4, v5
    s_mov_b32 s50, 384
    v_mul_lo_u32 v6, v2, s50
    v_add_u32 v250, v6, v5
    v_lshrrev_b32 v2, 2, v1
    v_lshrrev_b32 v5, 1, v2
    v_and_b32 v5, 3, v5
    v_lshlrev_b32 v5, 5, v5
    v_mul_lo_u32 v6, v2, s50
    v_add_u32 v6, v6, v5
    v_and_b32 v3, 3, v1
    v_lshlrev_b32 v3, 3, v3
    v_add_u32 v7, v6, v3
    v_lshlrev_b32 v6, 4, v1
    s_mul_i32 s52, s3, 589824
    v_add_u32 v20, s52, v6
    v_mov_b32 v6, 1065369472
    v_accvgpr_write_b32 a156, v6
    v_accvgpr_write_b32 a157, v6
    v_accvgpr_write_b32 a158, v6
    v_accvgpr_write_b32 a159, v6
    s_mov_b32 s47, 24576
    s_mov_b32 s48, 4294918144
    s_mov_b32 s57, 1037384597
    s_mov_b32 s58, 813694976
    s_mov_b32 s59, 1317011456
    s_mul_i32 s52, s3, 6144
    s_add_u32 s41, s52, 49152
    s_add_u32 s42, s52, 122880
    s_mov_b32 s55, 0
    s_mov_b32 s56, 0
    s_mov_b32 s54, 0
    s_waitcnt lgkmcnt(0)
    s_cmp_eq_u32 s6, 0
    s_cselect_b32 s96, s64, s74
    s_cselect_b32 s97, s65, s75
    s_cselect_b32 s84, s66, s76
    s_cselect_b32 s85, s67, s77
    s_cselect_b32 s86, s68, s78
    s_cselect_b32 s87, s69, s79
    s_cselect_b32 s88, s70, s80
    s_cselect_b32 s89, s71, s81
    s_cselect_b32 s70, s72, s82
    s_cselect_b32 s71, s73, s83
    s_mul_i32 s49, s7, 245760
    s_add_u32 s12, s96, s49
    s_addc_u32 s13, s97, 0
    s_and_b32 s13, s13, 65535
    s_mov_b32 s15, 131072
    s_mul_i32 s49, s7, 6291456
    s_add_u32 s84, s84, s49
    s_addc_u32 s85, s85, 0
    s_add_u32 s86, s86, s49
    s_addc_u32 s87, s87, 0
    s_lshl_b32 s49, s6, 3
    s_add_u32 s49, s49, s7
    s_mul_i32 s49, s49, 2359296
    s_add_u32 s90, s94, s49
    s_addc_u32 s91, s95, 0
    s_mov_b32 s11, 131072
    s_mov_b32 s19, 131072
    s_mov_b32 s23, 131072
    s_mov_b32 s27, 131072
    s_mov_b32 s31, 131072
    v_mov_b32 v252, v7
    s_mov_b64 s[60:61], 0
    s_mov_b32 s49, 21846
    v_mul_lo_u32 v3, v1, s49
    v_lshrrev_b32 v3, 16, v3
    v_mul_u32_u24 v2, 3, v3
    v_sub_u32 v2, v1, v2
    v_lshlrev_b32 v2, 7, v2
    s_lshl_b32 s49, s7, 3
    v_add_u32 v3, s49, v3
    s_mov_b32 s50, 12288
    v_mul_lo_u32 v3, v3, s50
    v_add_u32 v4, v3, v2
    s_and_b32 s49, s92, 3
    s_mul_i32 s49, s49, 48
    v_add_u32 v3, s49, v1
    s_mov_b32 s50, 1280
    v_mul_lo_u32 v5, v3, s50
    s_cmp_eq_u32 s3, 0
    s_cselect_b64 s[78:79], -1, 0
    s_cselect_b32 s51, 24, 48
    v_cndmask_b32 v255, v5, v4, s[78:79]
    v_cmp_gt_u32 vcc, s51, v1
    v_mov_b32 v2, 2130706432
    s_nop 0
    v_cndmask_b32 v255, v2, v255, vcc
    s_getpc_b64 s[66:67]
    s_lshr_b32 s49, s2, 3
    s_mul_i32 s49, s49, 1536
    v_lshlrev_b32 v2, 7, v1
    v_add_u32 v2, s49, v2
    v_cmp_gt_u32 vcc, 12, v1
    s_cmp_lg_u32 s3, 0
    s_cbranch_scc1 K1_ct
    s_and_saveexec_b64 s[68:69], vcc
    global_load_dword v254, v2, s[66:67]
    s_mov_b64 exec, -1
K1_ct:
    s_add_u32 s96, s94, 62914560
    s_addc_u32 s97, s95, 0
    s_and_b32 s97, s97, 65535
    s_mov_b32 s98, 65536
    s_mov_b32 s99, 131072
    s_lshl_b32 s49, s6, 3
    s_add_u32 s49, s49, s7
    s_lshl_b32 s49, s49, 2
    s_and_b32 s50, s4, 3
    s_add_u32 s49, s49, s50
    s_add_u32 s49, s49, 64
    s_lshl_b32 s83, s49, 8
    s_mov_b32 s80, 0
K1_cold:
    s_mul_i32 s49, s92, 384
    s_add_u32 s8, s88, s49
    s_addc_u32 s9, s89, 0
    s_and_b32 s9, s9, 65535
    s_sub_u32 s10, 7864320, s49
    s_mul_i32 s49, s92, 196608
    s_add_u32 s16, s84, s49
    s_addc_u32 s17, s85, 0
    s_and_b32 s17, s17, 65535
    s_mov_b32 s18, 196608
    s_mul_i32 s49, s92, 196608
    s_add_u32 s20, s86, s49
    s_addc_u32 s21, s87, 0
    s_and_b32 s21, s21, 65535
    s_mov_b32 s22, 196608
    s_mov_b32 s34, 0
    s_mov_b32 s35, 0
    s_mov_b32 s14, 245760
    s_mov_b32 s30, 0
    s_mov_b32 s28, s90
    s_and_b32 s29, s91, 65535
    s_mov_b32 s32, 0
    s_mov_b32 s33, 0
    s_mov_b32 s43, 0
    s_mov_b32 s44, 0
    s_mul_i32 s39, s3, 6144
    s_add_u32 s40, s39, 73728
    s_cmp_eq_u32 s3, 0
    s_cselect_b32 s72, s8, s12
    s_cselect_b32 s73, s9, s13
    s_cselect_b32 s74, s10, s14
    s_mov_b32 s49, 786432
    s_cselect_b32 s77, s49, 128
    s_mul_i32 s76, s77, 0
    s_cmp_ge_u32 s3, 2
    s_cselect_b32 s74, 0, s74
    s_mov_b32 s75, 131072
    buffer_load_dword v100, v255, s[72:75], s76 offen sc1
    s_add_u32 s76, s76, s77
    buffer_load_dword v101, v255, s[72:75], s76 offen sc1
    s_add_u32 s76, s76, s77
    buffer_load_dword v102, v255, s[72:75], s76 offen sc1
    s_add_u32 s76, s76, s77
    buffer_load_dword v103, v255, s[72:75], s76 offen sc1
    s_add_u32 s76, s76, s77
    s_mov_b32 m0, s39
    s_nop 0
    buffer_load_dwordx4 v247, s[8:11], s32 offen lds
    buffer_load_dwordx4 v248, s[8:11], s32 offen offset:1024 lds
    buffer_load_dwordx4 v249, s[8:11], s32 offen offset:2048 lds
    s_add_u32 s49, s32, 196608
    s_add_u32 m0, s39, 3072
    s_nop 0
    buffer_load_dwordx4 v247, s[8:11], s49 offen lds
    buffer_load_dwordx4 v248, s[8:11], s49 offen offset:1024 lds
    buffer_load_dwordx4 v249, s[8:11], s49 offen offset:2048 lds
    s_add_u32 s32, s32, 786432
    s_cmp_eq_u32 s39, s41
    s_cselect_b32 s51, s48, s47
    s_add_u32 s39, s39, s51
    s_mov_b32 m0, s40
    s_nop 0
    buffer_load_dwordx4 v244, s[12:15], s33 offen lds
    buffer_load_dwordx4 v245, s[12:15], s33 offen offset:1024 lds
    buffer_load_dwordx4 v246, s[12:15], s33 offen offset:2048 lds
    s_add_u32 s50, s33, 64
    s_add_u32 m0, s40, 3072
    s_nop 0
    buffer_load_dwordx4 v244, s[12:15], s50 offen lds
    buffer_load_dwordx4 v245, s[12:15], s50 offen offset:1024 lds
    buffer_load_dwordx4 v246, s[12:15], s50 offen offset:2048 lds
    s_add_u32 s33, s33, 128
    s_cmp_eq_u32 s40, s42
    s_cselect_b32 s51, s48, s47
    s_add_u32 s40, s40, s51
    s_mov_b32 m0, s39
    s_nop 0
    buffer_load_dwordx4 v247, s[8:11], s32 offen lds
    buffer_load_dwordx4 v248, s[8:11], s32 offen offset:1024 lds
    buffer_load_dwordx4 v249, s[8:11], s32 offen offset:2048 lds
    s_add_u32 s49, s32, 196608
    s_add_u32 m0, s39, 3072
    s_nop 0
    buffer_load_dwordx4 v247, s[8:11], s49 offen lds
    buffer_load_dwordx4 v248, s[8:11], s49 offen offset:1024 lds
    buffer_load_dwordx4 v249, s[8:11], s49 offen offset:2048 lds
    s_add_u32 s32, s32, 786432
    s_cmp_eq_u32 s39, s41
    s_cselect_b32 s51, s48, s47
    s_add_u32 s39, s39, s51
    s_mov_b32 m0, s40
    s_nop 0
    buffer_load_dwordx4 v244, s[12:15], s33 offen lds
    buffer_load_dwordx4 v245, s[12:15], s33 offen offset:1024 lds
    buffer_load_dwordx4 v246, s[12:15], s33 offen offset:2048 lds
    s_add_u32 s50, s33, 64
    s_add_u32 m0, s40, 3072
    s_nop 0
    buffer_load_dwordx4 v244, s[12:15], s50 offen lds
    buffer_load_dwordx4 v245, s[12:15], s50 offen offset:1024 lds
    buffer_load_dwordx4 v246, s[12:15], s50 offen offset:2048 lds
    s_add_u32 s33, s33, 128
    s_cmp_eq_u32 s40, s42
    s_cselect_b32 s51, s48, s47
    s_add_u32 s40, s40, s51
    v_xor_b32 v16, 0, v252
    v_xor_b32 v17, 32, v252
    v_xor_b32 v18, 64, v252
    v_xor_b32 v19, 96, v252
    v_add_u32 v14, 73728, v251
    s_waitcnt vmcnt(12)
    s_barrier
    ds_read_b64_tr_b16 a[208:209], v16 offset:0
    ds_read_b64_tr_b16 a[210:211], v16 offset:6144
    ds_read_b64_tr_b16 a[212:213], v16 offset:12288
    ds_read_b64_tr_b16 a[214:215], v16 offset:18432
    ds_read_b64_tr_b16 a[216:217], v17 offset:0
    ds_read_b64_tr_b16 a[218:219], v17 offset:6144
    ds_read_b64_tr_b16 a[220:221], v17 offset:12288
    ds_read_b64_tr_b16 a[222:223], v17 offset:18432
    ds_read_b128 a[160:163], v14 offset:0
    ds_read_b128 a[164:167], v14 offset:1024
    ds_read_b128 a[168:171], v14 offset:2048
    ds_read_b128 a[172:175], v14 offset:3072
    ds_read_b128 a[176:179], v14 offset:4096
    ds_read_b128 a[180:183], v14 offset:5120
    s_waitcnt lgkmcnt(7)
    ds_read_b64_tr_b16 a[224:225], v18 offset:0
    ds_read_b64_tr_b16 a[226:227], v18 offset:6144
    ds_read_b64_tr_b16 a[228:229], v18 offset:12288
    ds_read_b64_tr_b16 a[230:231], v18 offset:18432
    ds_read_b64_tr_b16 a[232:233], v19 offset:0
    ds_read_b64_tr_b16 a[234:235], v19 offset:6144
    ds_read_b64_tr_b16 a[236:237], v19 offset:12288
    ds_read_b64_tr_b16 a[238:239], v19 offset:18432
K1_item:
    s_waitcnt lgkmcnt(4)
    v_mfma_f32_16x16x32_bf16 v[100:103], a[208:211], a[160:163], 0
    ds_read_b64_tr_b16 a[240:241], v16 offset:128
    s_mov_b32 m0, s39
    v_mfma_f32_16x16x32_bf16 v[100:103], a[212:215], a[172:175], v[100:103]
    ds_read_b64_tr_b16 a[242:243], v16 offset:6272
    v_accvgpr_read_b32 v24, a144
    v_mfma_f32_16x16x32_bf16 v[104:107], a[208:211], a[164:167], 0
    ds_read_b64_tr_b16 a[244:245], v16 offset:12416
    v_accvgpr_read_b32 v25, a148
    v_mfma_f32_16x16x32_bf16 v[104:107], a[212:215], a[176:179], v[104:107]
    ds_read_b64_tr_b16 a[246:247], v16 offset:18560
    v_accvgpr_read_b32 v26, a152
    v_mfma_f32_16x16x32_bf16 v[108:111], a[208:211], a[168:171], 0
    ds_read_b64_tr_b16 a[248:249], v17 offset:128
    v_cmp_nge_f32 vcc, v24, s58
    v_mfma_f32_16x16x32_bf16 v[108:111], a[212:215], a[180:183], v[108:111]
    ds_read_b64_tr_b16 a[250:251], v17 offset:6272
    v_rcp_f32 v21, v24
    v_mfma_f32_16x16x32_bf16 v[112:115], a[216:219], a[160:163], 0
    ds_read_b64_tr_b16 a[252:253], v17 offset:12416
    s_or_b64 s[60:61], s[60:61], vcc
    v_mfma_f32_16x16x32_bf16 v[112:115], a[220:223], a[172:175], v[112:115]
    ds_read_b64_tr_b16 a[254:255], v17 offset:18560
    v_cmp_nle_f32 vcc, v24, s59
    v_mfma_f32_16x16x32_bf16 v[116:119], a[216:219], a[164:167], 0
    buffer_load_dwordx4 v247, s[8:11], s32 offen lds
    v_mfma_f32_16x16x32_bf16 v[116:119], a[220:223], a[176:179], v[116:119]
    buffer_load_dwordx4 v248, s[8:11], s32 offen offset:1024 lds
    v_mfma_f32_16x16x32_bf16 v[120:123], a[216:219], a[168:171], 0
    buffer_load_dwordx4 v249, s[8:11], s32 offen offset:2048 lds
    v_mfma_f32_16x16x32_bf16 v[120:123], a[220:223], a[180:183], v[120:123]
    s_add_u32 s49, s32, 196608
    s_waitcnt lgkmcnt(7)
    v_mfma_f32_16x16x32_bf16 v[124:127], a[224:227], a[160:163], 0
    ds_read_b64_tr_b16 a[208:209], v18 offset:128
    s_add_u32 m0, s39, 3072
    v_mfma_f32_16x16x32_bf16 v[124:127], a[228:231], a[172:175], v[124:127]
    ds_read_b64_tr_b16 a[210:211], v18 offset:6272
    s_nop 0
    v_mfma_f32_16x16x32_bf16 v[128:131], a[224:227], a[164:167], 0
    ds_read_b64_tr_b16 a[212:213], v18 offset:12416
    s_or_b64 s[60:61], s[60:61], vcc
    v_mfma_f32_16x16x32_bf16 v[128:131], a[228:231], a[176:179], v[128:131]
    ds_read_b64_tr_b16 a[214:215], v18 offset:18560
    v_cmp_nge_f32 vcc, v25, s58
    v_mfma_f32_16x16x32_bf16 v[132:135], a[224:227], a[168:171], 0
    ds_read_b64_tr_b16 a[216:217], v19 offset:128
    v_rcp_f32 v22, v25
    v_mfma_f32_16x16x32_bf16 v[132:135], a[228:231], a[180:183], v[132:135]
    ds_read_b64_tr_b16 a[218:219], v19 offset:6272
    s_or_b64 s[60:61], s[60:61], vcc
    v_mfma_f32_16x16x32_bf16 v[136:139], a[232:235], a[160:163], 0
    ds_read_b64_tr_b16 a[220:221], v19 offset:12416
    v_cmp_nle_f32 vcc, v25, s59
    v_mfma_f32_16x16x32_bf16 v[136:139], a[236:239], a[172:175], v[136:139]
    ds_read_b64_tr_b16 a[222:223], v19 offset:18560
    s_nop 0
    v_mfma_f32_16x16x32_bf16 v[140:143], a[232:235], a[164:167], 0
    s_cmp_eq_u32 s43, 49152
    s_cselect_b32 s45, s48, s47
    v_mfma_f32_16x16x32_bf16 v[140:143], a[236:239], a[176:179], v[140:143]
    s_add_u32 s43, s43, s45
    s_or_b64 s[60:61], s[60:61], vcc
    v_mfma_f32_16x16x32_bf16 v[144:147], a[232:235], a[168:171], 0
    buffer_load_dwordx4 v247, s[8:11], s49 offen lds
    v_mfma_f32_16x16x32_bf16 v[144:147], a[236:239], a[180:183], v[144:147]
    v_cmp_nge_f32 vcc, v26, s58
    s_waitcnt lgkmcnt(7)
    v_mfma_f32_16x16x32_bf16 v[148:151], a[240:243], a[160:163], 0
    ds_read_b64_tr_b16 a[224:225], v16 offset:256
    v_rcp_f32 v23, v26
    v_mfma_f32_16x16x32_bf16 v[148:151], a[244:247], a[172:175], v[148:151]
    ds_read_b64_tr_b16 a[226:227], v16 offset:6400
    s_or_b64 s[60:61], s[60:61], vcc
    v_mfma_f32_16x16x32_bf16 v[152:155], a[240:243], a[164:167], 0
    ds_read_b64_tr_b16 a[228:229], v16 offset:12544
    v_cmp_nle_f32 vcc, v26, s59
    v_mfma_f32_16x16x32_bf16 v[152:155], a[244:247], a[176:179], v[152:155]
    ds_read_b64_tr_b16 a[230:231], v16 offset:18688
    s_nop 0
    v_mfma_f32_16x16x32_bf16 v[156:159], a[240:243], a[168:171], 0
    ds_read_b64_tr_b16 a[232:233], v17 offset:256
    s_or_b64 s[60:61], s[60:61], vcc
    v_mfma_f32_16x16x32_bf16 v[156:159], a[244:247], a[180:183], v[156:159]
    ds_read_b64_tr_b16 a[234:235], v17 offset:6400
    v_accvgpr_read_b32 v52, a0
    v_mfma_f32_16x16x32_bf16 v[160:163], a[248:251], a[160:163], 0
    ds_read_b64_tr_b16 a[236:237], v17 offset:12544
    v_accvgpr_read_b32 v53, a1
    v_mfma_f32_16x16x32_bf16 v[160:163], a[252:255], a[172:175], v[160:163]
    ds_read_b64_tr_b16 a[238:239], v17 offset:18688
    v_accvgpr_read_b32 v54, a2
    v_mfma_f32_16x16x32_bf16 v[164:167], a[248:251], a[164:167], 0
    buffer_load_dwordx4 v248, s[8:11], s49 offen offset:1024 lds
    v_mfma_f32_16x16x32_bf16 v[164:167], a[252:255], a[176:179], v[164:167]
    buffer_load_dwordx4 v249, s[8:11], s49 offen offset:2048 lds
    v_mfma_f32_16x16x32_bf16 v[168:171], a[248:251], a[168:171], 0
    s_add_u32 s32, s32, 786432
    v_accvgpr_read_b32 v55, a3
    v_mfma_f32_16x16x32_bf16 v[168:171], a[252:255], a[180:183], v[168:171]
    v_mul_f32 v52, v52, v21
    s_waitcnt lgkmcnt(7)
    v_mfma_f32_16x16x32_bf16 v[172:175], a[208:211], a[160:163], 0
    ds_read_b64_tr_b16 a[240:241], v18 offset:256
    v_mul_f32 v53, v53, v21
    v_mfma_f32_16x16x32_bf16 v[172:175], a[212:215], a[172:175], v[172:175]
    ds_read_b64_tr_b16 a[242:243], v18 offset:6400
    v_mul_f32 v54, v54, v21
    v_mfma_f32_16x16x32_bf16 v[176:179], a[208:211], a[164:167], 0
    ds_read_b64_tr_b16 a[244:245], v18 offset:12544
    v_mul_f32 v55, v55, v21
    v_mfma_f32_16x16x32_bf16 v[176:179], a[212:215], a[176:179], v[176:179]
    ds_read_b64_tr_b16 a[246:247], v18 offset:18688
    v_cvt_pk_bf16_f32 v28, v52, v53
    v_mfma_f32_16x16x32_bf16 v[180:183], a[208:211], a[168:171], 0
    ds_read_b64_tr_b16 a[248:249], v19 offset:256
    v_cvt_pk_bf16_f32 v29, v54, v55
    v_mfma_f32_16x16x32_bf16 v[180:183], a[212:215], a[180:183], v[180:183]
    ds_read_b64_tr_b16 a[250:251], v19 offset:6400
    v_accvgpr_read_b32 v56, a12
    v_mfma_f32_16x16x32_bf16 v[184:187], a[216:219], a[160:163], 0
    ds_read_b64_tr_b16 a[252:253], v19 offset:12544
    v_accvgpr_read_b32 v57, a13
    v_mfma_f32_16x16x32_bf16 v[184:187], a[220:223], a[172:175], v[184:187]
    ds_read_b64_tr_b16 a[254:255], v19 offset:18688
    v_accvgpr_read_b32 v58, a14
    v_mfma_f32_16x16x32_bf16 v[188:191], a[216:219], a[164:167], 0
    s_cmp_eq_u32 s39, s41
    s_cselect_b32 s51, s48, s47
    v_mfma_f32_16x16x32_bf16 v[188:191], a[220:223], a[176:179], v[188:191]
    s_add_u32 s39, s39, s51
    s_mov_b32 m0, s40
    v_mfma_f32_16x16x32_bf16 v[192:195], a[216:219], a[168:171], 0
    v_add_u32 v16, s45, v16
    v_add_u32 v17, s45, v17
    v_mfma_f32_16x16x32_bf16 v[192:195], a[220:223], a[180:183], v[192:195]
    v_add_u32 v18, s45, v18
    s_waitcnt lgkmcnt(7)
    v_mfma_f32_16x16x32_bf16 v[196:199], a[224:227], a[160:163], 0
    v_add_u32 v19, s45, v19
    v_add_u32 v14, s45, v14
    v_mfma_f32_16x16x32_bf16 v[196:199], a[228:231], a[172:175], v[196:199]
    s_waitcnt vmcnt(6) lgkmcnt(0)
    s_barrier
    v_mfma_f32_16x16x32_bf16 v[200:203], a[224:227], a[164:167], 0
    ds_read_b64_tr_b16 a[208:209], v16 offset:0
    buffer_load_dwordx4 v244, s[12:15], s33 offen lds
    v_mfma_f32_16x16x32_bf16 v[200:203], a[228:231], a[176:179], v[200:203]
    ds_read_b64_tr_b16 a[210:211], v16 offset:6144
    buffer_load_dwordx4 v245, s[12:15], s33 offen offset:1024 lds
    v_mfma_f32_16x16x32_bf16 v[204:207], a[224:227], a[168:171], 0
    ds_read_b64_tr_b16 a[212:213], v16 offset:12288
    buffer_load_dwordx4 v246, s[12:15], s33 offen offset:2048 lds
    v_mfma_f32_16x16x32_bf16 v[204:207], a[228:231], a[180:183], v[204:207]
    ds_read_b64_tr_b16 a[214:215], v16 offset:18432
    s_add_u32 s50, s33, 64
    v_mfma_f32_16x16x32_bf16 v[208:211], a[232:235], a[160:163], 0
    ds_read_b64_tr_b16 a[216:217], v17 offset:0
    s_add_u32 m0, s40, 3072
    v_mfma_f32_16x16x32_bf16 v[208:211], a[236:239], a[172:175], v[208:211]
    ds_read_b64_tr_b16 a[218:219], v17 offset:6144
    buffer_load_dwordx4 v244, s[12:15], s50 offen lds
    v_mfma_f32_16x16x32_bf16 v[212:215], a[232:235], a[164:167], 0
    ds_read_b64_tr_b16 a[220:221], v17 offset:12288
    buffer_load_dwordx4 v245, s[12:15], s50 offen offset:1024 lds
    v_mfma_f32_16x16x32_bf16 v[212:215], a[236:239], a[176:179], v[212:215]
    ds_read_b64_tr_b16 a[222:223], v17 offset:18432
    buffer_load_dwordx4 v246, s[12:15], s50 offen offset:2048 lds
    v_mfma_f32_16x16x32_bf16 v[216:219], a[232:235], a[168:171], 0
    ds_read_b128 a[184:187], v14 offset:0
    s_add_u32 s33, s33, 128
    v_mfma_f32_16x16x32_bf16 v[216:219], a[236:239], a[180:183], v[216:219]
    ds_read_b128 a[188:191], v14 offset:1024
    s_cmp_eq_u32 s40, s42
    s_cselect_b32 s51, s48, s47
    v_mfma_f32_16x16x32_bf16 v[220:223], a[240:243], a[160:163], 0
    ds_read_b128 a[192:195], v14 offset:2048
    s_add_u32 s40, s40, s51
    v_mfma_f32_16x16x32_bf16 v[220:223], a[244:247], a[172:175], v[220:223]
    ds_read_b128 a[196:199], v14 offset:3072
    buffer_load_dword v254, v255, s[72:75], s76 offen sc1
    v_mfma_f32_16x16x32_bf16 v[224:227], a[240:243], a[164:167], 0
    ds_read_b128 a[200:203], v14 offset:4096
    s_add_u32 s76, s76, s77
    v_mfma_f32_16x16x32_bf16 v[224:227], a[244:247], a[176:179], v[224:227]
    ds_read_b128 a[204:207], v14 offset:5120
    s_waitcnt lgkmcnt(7)
    v_mfma_f32_16x16x32_bf16 v[228:231], a[240:243], a[168:171], 0
    ds_read_b64_tr_b16 a[224:225], v18 offset:0
    v_accvgpr_read_b32 v59, a15
    v_mul_f32 v56, v56, v21
    v_mul_f32 v57, v57, v21
    v_mul_f32 v58, v58, v21
    v_mul_f32 v59, v59, v21
    v_cvt_pk_bf16_f32 v30, v56, v57
    v_cvt_pk_bf16_f32 v31, v58, v59
    v_accvgpr_read_b32 v60, a4
    v_accvgpr_read_b32 v61, a5
    v_accvgpr_read_b32 v62, a6
    v_accvgpr_read_b32 v63, a7
    v_mul_f32 v60, v60, v22
    v_mul_f32 v61, v61, v22
    v_mul_f32 v62, v62, v22
    v_mul_f32 v63, v63, v22
    v_cvt_pk_bf16_f32 v32, v60, v61
    v_cvt_pk_bf16_f32 v33, v62, v63
    v_accvgpr_read_b32 v64, a16
    v_accvgpr_read_b32 v65, a17
    v_accvgpr_read_b32 v66, a18
    v_accvgpr_read_b32 v67, a19
    v_mul_f32 v64, v64, v22
    v_mul_f32 v65, v65, v22
    v_mul_f32 v66, v66, v22
    v_mul_f32 v67, v67, v22
    v_cvt_pk_bf16_f32 v34, v64, v65
    v_cvt_pk_bf16_f32 v35, v66, v67
    v_mfma_f32_16x16x32_bf16 v[228:231], a[244:247], a[180:183], v[228:231]
    ds_read_b64_tr_b16 a[226:227], v18 offset:6144
    s_mov_b32 s52, 0
    v_mfma_f32_16x16x32_bf16 v[232:235], a[248:251], a[160:163], 0
    ds_read_b64_tr_b16 a[228:229], v18 offset:12288
    buffer_store_dwordx4 v[28:31], v20, s[28:31], s52 offen sc1
    v_mfma_f32_16x16x32_bf16 v[232:235], a[252:255], a[172:175], v[232:235]
    ds_read_b64_tr_b16 a[230:231], v18 offset:18432
    s_mov_b32 s52, 0
    v_mfma_f32_16x16x32_bf16 v[236:239], a[248:251], a[164:167], 0
    ds_read_b64_tr_b16 a[232:233], v19 offset:0
    buffer_store_dwordx4 v[32:35], v20, s[28:31], s52 offen offset:1024 sc1
    v_mfma_f32_16x16x32_bf16 v[236:239], a[252:255], a[176:179], v[236:239]
    ds_read_b64_tr_b16 a[234:235], v19 offset:6144
    v_mfma_f32_16x16x32_bf16 v[240:243], a[248:251], a[168:171], 0
    ds_read_b64_tr_b16 a[236:237], v19 offset:12288
    v_mfma_f32_16x16x32_bf16 v[240:243], a[252:255], a[180:183], v[240:243]
    ds_read_b64_tr_b16 a[238:239], v19 offset:18432
    s_waitcnt lgkmcnt(4)
    v_mfma_f32_16x16x32_bf16 v[100:103], a[208:211], a[184:187], v[100:103]
    ds_read_b64_tr_b16 a[240:241], v16 offset:128
    s_mov_b32 m0, s39
    v_mfma_f32_16x16x32_bf16 v[100:103], a[212:215], a[196:199], v[100:103]
    ds_read_b64_tr_b16 a[242:243], v16 offset:6272
    v_accvgpr_read_b32 v68, a8
    v_mfma_f32_16x16x32_bf16 v[104:107], a[208:211], a[188:191], v[104:107]
    ds_read_b64_tr_b16 a[244:245], v16 offset:12416
    v_accvgpr_read_b32 v69, a9
    v_mfma_f32_16x16x32_bf16 v[104:107], a[212:215], a[200:203], v[104:107]
    ds_read_b64_tr_b16 a[246:247], v16 offset:18560
    v_accvgpr_read_b32 v70, a10
    v_mfma_f32_16x16x32_bf16 v[108:111], a[208:211], a[192:195], v[108:111]
    ds_read_b64_tr_b16 a[248:249], v17 offset:128
    v_accvgpr_read_b32 v71, a11
    v_mfma_f32_16x16x32_bf16 v[108:111], a[212:215], a[204:207], v[108:111]
    ds_read_b64_tr_b16 a[250:251], v17 offset:6272
    v_mul_f32 v68, v68, v23
    v_mfma_f32_16x16x32_bf16 v[112:115], a[216:219], a[184:187], v[112:115]
    ds_read_b64_tr_b16 a[252:253], v17 offset:12416
    v_mul_f32 v69, v69, v23
    v_mfma_f32_16x16x32_bf16 v[112:115], a[220:223], a[196:199], v[112:115]
    ds_read_b64_tr_b16 a[254:255], v17 offset:18560
    v_mul_f32 v70, v70, v23
    v_mfma_f32_16x16x32_bf16 v[116:119], a[216:219], a[188:191], v[116:119]
    buffer_load_dwordx4 v247, s[8:11], s32 offen lds
    v_mfma_f32_16x16x32_bf16 v[116:119], a[220:223], a[200:203], v[116:119]
    buffer_load_dwordx4 v248, s[8:11], s32 offen offset:1024 lds
    v_mfma_f32_16x16x32_bf16 v[120:123], a[216:219], a[192:195], v[120:123]
    buffer_load_dwordx4 v249, s[8:11], s32 offen offset:2048 lds
    v_mfma_f32_16x16x32_bf16 v[120:123], a[220:223], a[204:207], v[120:123]
    s_add_u32 s49, s32, 196608
    s_waitcnt lgkmcnt(7)
    v_mfma_f32_16x16x32_bf16 v[124:127], a[224:227], a[184:187], v[124:127]
    ds_read_b64_tr_b16 a[208:209], v18 offset:128
    s_add_u32 m0, s39, 3072
    v_mfma_f32_16x16x32_bf16 v[124:127], a[228:231], a[196:199], v[124:127]
    ds_read_b64_tr_b16 a[210:211], v18 offset:6272
    v_mul_f32 v71, v71, v23
    v_mfma_f32_16x16x32_bf16 v[128:131], a[224:227], a[188:191], v[128:131]
    ds_read_b64_tr_b16 a[212:213], v18 offset:12416
    v_cvt_pk_bf16_f32 v36, v68, v69
    v_mfma_f32_16x16x32_bf16 v[128:131], a[228:231], a[200:203], v[128:131]
    ds_read_b64_tr_b16 a[214:215], v18 offset:18560
    v_cvt_pk_bf16_f32 v37, v70, v71
    v_mfma_f32_16x16x32_bf16 v[132:135], a[224:227], a[192:195], v[132:135]
    ds_read_b64_tr_b16 a[216:217], v19 offset:128
    v_accvgpr_read_b32 v72, a20
    v_mfma_f32_16x16x32_bf16 v[132:135], a[228:231], a[204:207], v[132:135]
    ds_read_b64_tr_b16 a[218:219], v19 offset:6272
    v_accvgpr_read_b32 v73, a21
    v_mfma_f32_16x16x32_bf16 v[136:139], a[232:235], a[184:187], v[136:139]
    ds_read_b64_tr_b16 a[220:221], v19 offset:12416
    v_accvgpr_read_b32 v74, a22
    v_mfma_f32_16x16x32_bf16 v[136:139], a[236:239], a[196:199], v[136:139]
    ds_read_b64_tr_b16 a[222:223], v19 offset:18560
    v_accvgpr_read_b32 v75, a23
    v_mfma_f32_16x16x32_bf16 v[140:143], a[232:235], a[188:191], v[140:143]
    s_cmp_eq_u32 s43, 49152
    s_cselect_b32 s45, s48, s47
    v_mfma_f32_16x16x32_bf16 v[140:143], a[236:239], a[200:203], v[140:143]
    s_add_u32 s43, s43, s45
    v_mul_f32 v72, v72, v23
    v_mfma_f32_16x16x32_bf16 v[144:147], a[232:235], a[192:195], v[144:147]
    buffer_load_dwordx4 v247, s[8:11], s49 offen lds
    v_mfma_f32_16x16x32_bf16 v[144:147], a[236:239], a[204:207], v[144:147]
    v_mul_f32 v73, v73, v23
    s_waitcnt lgkmcnt(7)
    v_mfma_f32_16x16x32_bf16 v[148:151], a[240:243], a[184:187], v[148:151]
    ds_read_b64_tr_b16 a[224:225], v16 offset:256
    v_mul_f32 v74, v74, v23
    v_mfma_f32_16x16x32_bf16 v[148:151], a[244:247], a[196:199], v[148:151]
    ds_read_b64_tr_b16 a[226:227], v16 offset:6400
    v_mul_f32 v75, v75, v23
    v_mfma_f32_16x16x32_bf16 v[152:155], a[240:243], a[188:191], v[152:155]
    ds_read_b64_tr_b16 a[228:229], v16 offset:12544
    v_cvt_pk_bf16_f32 v38, v72, v73
    v_mfma_f32_16x16x32_bf16 v[152:155], a[244:247], a[200:203], v[152:155]
    ds_read_b64_tr_b16 a[230:231], v16 offset:18688
    v_cvt_pk_bf16_f32 v39, v74, v75
    v_mfma_f32_16x16x32_bf16 v[156:159], a[240:243], a[192:195], v[156:159]
    ds_read_b64_tr_b16 a[232:233], v17 offset:256
    v_accvgpr_read_b32 v52, a24
    v_mfma_f32_16x16x32_bf16 v[156:159], a[244:247], a[204:207], v[156:159]
    ds_read_b64_tr_b16 a[234:235], v17 offset:6400
    v_accvgpr_read_b32 v53, a25
    v_mfma_f32_16x16x32_bf16 v[160:163], a[248:251], a[184:187], v[160:163]
    ds_read_b64_tr_b16 a[236:237], v17 offset:12544
    v_accvgpr_read_b32 v54, a26
    v_mfma_f32_16x16x32_bf16 v[160:163], a[252:255], a[196:199], v[160:163]
    ds_read_b64_tr_b16 a[238:239], v17 offset:18688
    v_accvgpr_read_b32 v55, a27
    v_mfma_f32_16x16x32_bf16 v[164:167], a[248:251], a[188:191], v[164:167]
    buffer_load_dwordx4 v248, s[8:11], s49 offen offset:1024 lds
    v_mfma_f32_16x16x32_bf16 v[164:167], a[252:255], a[200:203], v[164:167]
    buffer_load_dwordx4 v249, s[8:11], s49 offen offset:2048 lds
    v_mfma_f32_16x16x32_bf16 v[168:171], a[248:251], a[192:195], v[168:171]
    s_add_u32 s32, s32, 786432
    v_mul_f32 v52, v52, v21
    v_mfma_f32_16x16x32_bf16 v[168:171], a[252:255], a[204:207], v[168:171]
    v_mul_f32 v53, v53, v21
    s_waitcnt lgkmcnt(7)
    v_mfma_f32_16x16x32_bf16 v[172:175], a[208:211], a[184:187], v[172:175]
    ds_read_b64_tr_b16 a[240:241], v18 offset:256
    v_mul_f32 v54, v54, v21
    v_mfma_f32_16x16x32_bf16 v[172:175], a[212:215], a[196:199], v[172:175]
    ds_read_b64_tr_b16 a[242:243], v18 offset:6400
    v_mul_f32 v55, v55, v21
    v_mfma_f32_16x16x32_bf16 v[176:179], a[208:211], a[188:191], v[176:179]
    ds_read_b64_tr_b16 a[244:245], v18 offset:12544
    v_cvt_pk_bf16_f32 v40, v52, v53
    v_mfma_f32_16x16x32_bf16 v[176:179], a[212:215], a[200:203], v[176:179]
    ds_read_b64_tr_b16 a[246:247], v18 offset:18688
    v_cvt_pk_bf16_f32 v41, v54, v55
    v_mfma_f32_16x16x32_bf16 v[180:183], a[208:211], a[192:195], v[180:183]
    ds_read_b64_tr_b16 a[248:249], v19 offset:256
    v_accvgpr_read_b32 v56, a36
    v_mfma_f32_16x16x32_bf16 v[180:183], a[212:215], a[204:207], v[180:183]
    ds_read_b64_tr_b16 a[250:251], v19 offset:6400
    v_accvgpr_read_b32 v57, a37
    v_mfma_f32_16x16x32_bf16 v[184:187], a[216:219], a[184:187], v[184:187]
    ds_read_b64_tr_b16 a[252:253], v19 offset:12544
    v_accvgpr_read_b32 v58, a38
    v_mfma_f32_16x16x32_bf16 v[184:187], a[220:223], a[196:199], v[184:187]
    ds_read_b64_tr_b16 a[254:255], v19 offset:18688
    v_accvgpr_read_b32 v59, a39
    v_mfma_f32_16x16x32_bf16 v[188:191], a[216:219], a[188:191], v[188:191]
    s_cmp_eq_u32 s39, s41
    s_cselect_b32 s51, s48, s47
    v_mfma_f32_16x16x32_bf16 v[188:191], a[220:223], a[200:203], v[188:191]
    s_add_u32 s39, s39, s51
    s_mov_b32 m0, s40
    v_mfma_f32_16x16x32_bf16 v[192:195], a[216:219], a[192:195], v[192:195]
    v_add_u32 v16, s45, v16
    v_add_u32 v17, s45, v17
    v_mfma_f32_16x16x32_bf16 v[192:195], a[220:223], a[204:207], v[192:195]
    v_add_u32 v18, s45, v18
    s_waitcnt lgkmcnt(7)
    v_mfma_f32_16x16x32_bf16 v[196:199], a[224:227], a[184:187], v[196:199]
    v_add_u32 v19, s45, v19
    v_add_u32 v14, s45, v14
    v_mfma_f32_16x16x32_bf16 v[196:199], a[228:231], a[196:199], v[196:199]
    s_waitcnt vmcnt(9) lgkmcnt(0)
    s_barrier
    v_mfma_f32_16x16x32_bf16 v[200:203], a[224:227], a[188:191], v[200:203]
    ds_read_b64_tr_b16 a[208:209], v16 offset:0
    buffer_load_dwordx4 v244, s[12:15], s33 offen lds
    v_mfma_f32_16x16x32_bf16 v[200:203], a[228:231], a[200:203], v[200:203]
    ds_read_b64_tr_b16 a[210:211], v16 offset:6144
    buffer_load_dwordx4 v245, s[12:15], s33 offen offset:1024 lds
    v_mfma_f32_16x16x32_bf16 v[204:207], a[224:227], a[192:195], v[204:207]
    ds_read_b64_tr_b16 a[212:213], v16 offset:12288
    buffer_load_dwordx4 v246, s[12:15], s33 offen offset:2048 lds
    v_mfma_f32_16x16x32_bf16 v[204:207], a[228:231], a[204:207], v[204:207]
    ds_read_b64_tr_b16 a[214:215], v16 offset:18432
    s_add_u32 s50, s33, 64
    v_mfma_f32_16x16x32_bf16 v[208:211], a[232:235], a[184:187], v[208:211]
    ds_read_b64_tr_b16 a[216:217], v17 offset:0
    s_add_u32 m0, s40, 3072
    v_mfma_f32_16x16x32_bf16 v[208:211], a[236:239], a[196:199], v[208:211]
    ds_read_b64_tr_b16 a[218:219], v17 offset:6144
    buffer_load_dwordx4 v244, s[12:15], s50 offen lds
    v_mfma_f32_16x16x32_bf16 v[212:215], a[232:235], a[188:191], v[212:215]
    ds_read_b64_tr_b16 a[220:221], v17 offset:12288
    buffer_load_dwordx4 v245, s[12:15], s50 offen offset:1024 lds
    v_mfma_f32_16x16x32_bf16 v[212:215], a[236:239], a[200:203], v[212:215]
    ds_read_b64_tr_b16 a[222:223], v17 offset:18432
    buffer_load_dwordx4 v246, s[12:15], s50 offen offset:2048 lds
    v_mfma_f32_16x16x32_bf16 v[216:219], a[232:235], a[192:195], v[216:219]
    ds_read_b128 a[160:163], v14 offset:0
    s_add_u32 s33, s33, 128
    v_mfma_f32_16x16x32_bf16 v[216:219], a[236:239], a[204:207], v[216:219]
    ds_read_b128 a[164:167], v14 offset:1024
    s_cmp_eq_u32 s40, s42
    s_cselect_b32 s51, s48, s47
    v_mfma_f32_16x16x32_bf16 v[220:223], a[240:243], a[184:187], v[220:223]
    ds_read_b128 a[168:171], v14 offset:2048
    s_add_u32 s40, s40, s51
    v_mfma_f32_16x16x32_bf16 v[220:223], a[244:247], a[196:199], v[220:223]
    ds_read_b128 a[172:175], v14 offset:3072
    buffer_load_dword v254, v255, s[72:75], s76 offen sc1
    v_mfma_f32_16x16x32_bf16 v[224:227], a[240:243], a[188:191], v[224:227]
    ds_read_b128 a[176:179], v14 offset:4096
    s_add_u32 s76, s76, s77
    v_mfma_f32_16x16x32_bf16 v[224:227], a[244:247], a[200:203], v[224:227]
    ds_read_b128 a[180:183], v14 offset:5120
    s_waitcnt lgkmcnt(7)
    v_mfma_f32_16x16x32_bf16 v[228:231], a[240:243], a[192:195], v[228:231]
    ds_read_b64_tr_b16 a[224:225], v18 offset:0
    v_mul_f32 v56, v56, v21
    v_mul_f32 v57, v57, v21
    v_mul_f32 v58, v58, v21
    v_mul_f32 v59, v59, v21
    v_cvt_pk_bf16_f32 v42, v56, v57
    v_cvt_pk_bf16_f32 v43, v58, v59
    v_mfma_f32_16x16x32_bf16 v[228:231], a[244:247], a[204:207], v[228:231]
    ds_read_b64_tr_b16 a[226:227], v18 offset:6144
    s_mov_b32 s52, 0
    v_mfma_f32_16x16x32_bf16 v[232:235], a[248:251], a[184:187], v[232:235]
    ds_read_b64_tr_b16 a[228:229], v18 offset:12288
    buffer_store_dwordx4 v[36:39], v20, s[28:31], s52 offen offset:2048 sc1
    v_mfma_f32_16x16x32_bf16 v[232:235], a[252:255], a[196:199], v[232:235]
    ds_read_b64_tr_b16 a[230:231], v18 offset:18432
    s_mov_b32 s52, 0
    v_mfma_f32_16x16x32_bf16 v[236:239], a[248:251], a[188:191], v[236:239]
    ds_read_b64_tr_b16 a[232:233], v19 offset:0
    buffer_store_dwordx4 v[40:43], v20, s[28:31], s52 offen offset:3072 sc1
    v_mfma_f32_16x16x32_bf16 v[236:239], a[252:255], a[200:203], v[236:239]
    ds_read_b64_tr_b16 a[234:235], v19 offset:6144
    v_mfma_f32_16x16x32_bf16 v[240:243], a[248:251], a[192:195], v[240:243]
    ds_read_b64_tr_b16 a[236:237], v19 offset:12288
    v_mfma_f32_16x16x32_bf16 v[240:243], a[252:255], a[204:207], v[240:243]
    ds_read_b64_tr_b16 a[238:239], v19 offset:18432
    s_waitcnt lgkmcnt(4)
    v_mfma_f32_16x16x32_bf16 v[100:103], a[208:211], a[160:163], v[100:103]
    ds_read_b64_tr_b16 a[240:241], v16 offset:128
    s_mov_b32 m0, s39
    v_mfma_f32_16x16x32_bf16 v[100:103], a[212:215], a[172:175], v[100:103]
    ds_read_b64_tr_b16 a[242:243], v16 offset:6272
    v_accvgpr_read_b32 v60, a28
    v_mfma_f32_16x16x32_bf16 v[104:107], a[208:211], a[164:167], v[104:107]
    ds_read_b64_tr_b16 a[244:245], v16 offset:12416
    v_accvgpr_read_b32 v61, a29
    v_mfma_f32_16x16x32_bf16 v[104:107], a[212:215], a[176:179], v[104:107]
    ds_read_b64_tr_b16 a[246:247], v16 offset:18560
    v_accvgpr_read_b32 v62, a30
    v_mfma_f32_16x16x32_bf16 v[108:111], a[208:211], a[168:171], v[108:111]
    ds_read_b64_tr_b16 a[248:249], v17 offset:128
    v_accvgpr_read_b32 v63, a31
    v_mfma_f32_16x16x32_bf16 v[108:111], a[212:215], a[180:183], v[108:111]
    ds_read_b64_tr_b16 a[250:251], v17 offset:6272
    v_mul_f32 v60, v60, v22
    v_mfma_f32_16x16x32_bf16 v[112:115], a[216:219], a[160:163], v[112:115]
    ds_read_b64_tr_b16 a[252:253], v17 offset:12416
    v_mul_f32 v61, v61, v22
    v_mfma_f32_16x16x32_bf16 v[112:115], a[220:223], a[172:175], v[112:115]
    ds_read_b64_tr_b16 a[254:255], v17 offset:18560
    v_mul_f32 v62, v62, v22
    v_mfma_f32_16x16x32_bf16 v[116:119], a[216:219], a[164:167], v[116:119]
    buffer_load_dwordx4 v247, s[8:11], s32 offen lds
    v_mfma_f32_16x16x32_bf16 v[116:119], a[220:223], a[176:179], v[116:119]
    buffer_load_dwordx4 v248, s[8:11], s32 offen offset:1024 lds
    v_mfma_f32_16x16x32_bf16 v[120:123], a[216:219], a[168:171], v[120:123]
    buffer_load_dwordx4 v249, s[8:11], s32 offen offset:2048 lds
    v_mfma_f32_16x16x32_bf16 v[120:123], a[220:223], a[180:183], v[120:123]
    s_add_u32 s49, s32, 196608
    s_waitcnt lgkmcnt(7)
    v_mfma_f32_16x16x32_bf16 v[124:127], a[224:227], a[160:163], v[124:127]
    ds_read_b64_tr_b16 a[208:209], v18 offset:128
    s_add_u32 m0, s39, 3072
    v_mfma_f32_16x16x32_bf16 v[124:127], a[228:231], a[172:175], v[124:127]
    ds_read_b64_tr_b16 a[210:211], v18 offset:6272
    v_mul_f32 v63, v63, v22
    v_mfma_f32_16x16x32_bf16 v[128:131], a[224:227], a[164:167], v[128:131]
    ds_read_b64_tr_b16 a[212:213], v18 offset:12416
    v_cvt_pk_bf16_f32 v44, v60, v61
    v_mfma_f32_16x16x32_bf16 v[128:131], a[228:231], a[176:179], v[128:131]
    ds_read_b64_tr_b16 a[214:215], v18 offset:18560
    v_cvt_pk_bf16_f32 v45, v62, v63
    v_mfma_f32_16x16x32_bf16 v[132:135], a[224:227], a[168:171], v[132:135]
    ds_read_b64_tr_b16 a[216:217], v19 offset:128
    v_accvgpr_read_b32 v64, a40
    v_mfma_f32_16x16x32_bf16 v[132:135], a[228:231], a[180:183], v[132:135]
    ds_read_b64_tr_b16 a[218:219], v19 offset:6272
    v_accvgpr_read_b32 v65, a41
    v_mfma_f32_16x16x32_bf16 v[136:139], a[232:235], a[160:163], v[136:139]
    ds_read_b64_tr_b16 a[220:221], v19 offset:12416
    v_accvgpr_read_b32 v66, a42
    v_mfma_f32_16x16x32_bf16 v[136:139], a[236:239], a[172:175], v[136:139]
    ds_read_b64_tr_b16 a[222:223], v19 offset:18560
    v_accvgpr_read_b32 v67, a43
    v_mfma_f32_16x16x32_bf16 v[140:143], a[232:235], a[164:167], v[140:143]
    s_cmp_eq_u32 s43, 49152
    s_cselect_b32 s45, s48, s47
    v_mfma_f32_16x16x32_bf16 v[140:143], a[236:239], a[176:179], v[140:143]
    s_add_u32 s43, s43, s45
    v_mul_f32 v64, v64, v22
    v_mfma_f32_16x16x32_bf16 v[144:147], a[232:235], a[168:171], v[144:147]
    buffer_load_dwordx4 v247, s[8:11], s49 offen lds
    v_mfma_f32_16x16x32_bf16 v[144:147], a[236:239], a[180:183], v[144:147]
    v_mul_f32 v65, v65, v22
    s_waitcnt lgkmcnt(7)
    v_mfma_f32_16x16x32_bf16 v[148:151], a[240:243], a[160:163], v[148:151]
    ds_read_b64_tr_b16 a[224:225], v16 offset:256
    v_mul_f32 v66, v66, v22
    v_mfma_f32_16x16x32_bf16 v[148:151], a[244:247], a[172:175], v[148:151]
    ds_read_b64_tr_b16 a[226:227], v16 offset:6400
    v_mul_f32 v67, v67, v22
    v_mfma_f32_16x16x32_bf16 v[152:155], a[240:243], a[164:167], v[152:155]
    ds_read_b64_tr_b16 a[228:229], v16 offset:12544
    v_cvt_pk_bf16_f32 v46, v64, v65
    v_mfma_f32_16x16x32_bf16 v[152:155], a[244:247], a[176:179], v[152:155]
    ds_read_b64_tr_b16 a[230:231], v16 offset:18688
    v_cvt_pk_bf16_f32 v47, v66, v67
    v_mfma_f32_16x16x32_bf16 v[156:159], a[240:243], a[168:171], v[156:159]
    ds_read_b64_tr_b16 a[232:233], v17 offset:256
    v_accvgpr_read_b32 v68, a32
    v_mfma_f32_16x16x32_bf16 v[156:159], a[244:247], a[180:183], v[156:159]
    ds_read_b64_tr_b16 a[234:235], v17 offset:6400
    v_accvgpr_read_b32 v69, a33
    v_mfma_f32_16x16x32_bf16 v[160:163], a[248:251], a[160:163], v[160:163]
    ds_read_b64_tr_b16 a[236:237], v17 offset:12544
    v_accvgpr_read_b32 v70, a34
    v_mfma_f32_16x16x32_bf16 v[160:163], a[252:255], a[172:175], v[160:163]
    ds_read_b64_tr_b16 a[238:239], v17 offset:18688
    v_accvgpr_read_b32 v71, a35
    v_mfma_f32_16x16x32_bf16 v[164:167], a[248:251], a[164:167], v[164:167]
    buffer_load_dwordx4 v248, s[8:11], s49 offen offset:1024 lds
    v_mfma_f32_16x16x32_bf16 v[164:167], a[252:255], a[176:179], v[164:167]
    buffer_load_dwordx4 v249, s[8:11], s49 offen offset:2048 lds
    v_mfma_f32_16x16x32_bf16 v[168:171], a[248:251], a[168:171], v[168:171]
    s_add_u32 s32, s32, 786432
    v_mul_f32 v68, v68, v23
    v_mfma_f32_16x16x32_bf16 v[168:171], a[252:255], a[180:183], v[168:171]
    v_mul_f32 v69, v69, v23
    s_waitcnt lgkmcnt(7)
    v_mfma_f32_16x16x32_bf16 v[172:175], a[208:211], a[160:163], v[172:175]
    ds_read_b64_tr_b16 a[240:241], v18 offset:256
    v_mul_f32 v70, v70, v23
    v_mfma_f32_16x16x32_bf16 v[172:175], a[212:215], a[172:175], v[172:175]
    ds_read_b64_tr_b16 a[242:243], v18 offset:6400
    v_mul_f32 v71, v71, v23
    v_mfma_f32_16x16x32_bf16 v[176:179], a[208:211], a[164:167], v[176:179]
    ds_read_b64_tr_b16 a[244:245], v18 offset:12544
    v_cvt_pk_bf16_f32 v48, v68, v69
    v_mfma_f32_16x16x32_bf16 v[176:179], a[212:215], a[176:179], v[176:179]
    ds_read_b64_tr_b16 a[246:247], v18 offset:18688
    v_cvt_pk_bf16_f32 v49, v70, v71
    v_mfma_f32_16x16x32_bf16 v[180:183], a[208:211], a[168:171], v[180:183]
    ds_read_b64_tr_b16 a[248:249], v19 offset:256
    v_accvgpr_read_b32 v72, a44
    v_mfma_f32_16x16x32_bf16 v[180:183], a[212:215], a[180:183], v[180:183]
    ds_read_b64_tr_b16 a[250:251], v19 offset:6400
    v_accvgpr_read_b32 v73, a45
    v_mfma_f32_16x16x32_bf16 v[184:187], a[216:219], a[160:163], v[184:187]
    ds_read_b64_tr_b16 a[252:253], v19 offset:12544
    v_accvgpr_read_b32 v74, a46
    v_mfma_f32_16x16x32_bf16 v[184:187], a[220:223], a[172:175], v[184:187]
    ds_read_b64_tr_b16 a[254:255], v19 offset:18688
    v_accvgpr_read_b32 v75, a47
    v_mfma_f32_16x16x32_bf16 v[188:191], a[216:219], a[164:167], v[188:191]
    s_cmp_eq_u32 s39, s41
    s_cselect_b32 s51, s48, s47
    v_mfma_f32_16x16x32_bf16 v[188:191], a[220:223], a[176:179], v[188:191]
    s_add_u32 s39, s39, s51
    s_mov_b32 m0, s40
    v_mfma_f32_16x16x32_bf16 v[192:195], a[216:219], a[168:171], v[192:195]
    v_add_u32 v16, s45, v16
    v_add_u32 v17, s45, v17
    v_mfma_f32_16x16x32_bf16 v[192:195], a[220:223], a[180:183], v[192:195]
    v_add_u32 v18, s45, v18
    s_waitcnt lgkmcnt(7)
    v_mfma_f32_16x16x32_bf16 v[196:199], a[224:227], a[160:163], v[196:199]
    v_add_u32 v19, s45, v19
    v_add_u32 v14, s45, v14
    v_mfma_f32_16x16x32_bf16 v[196:199], a[228:231], a[172:175], v[196:199]
    s_waitcnt vmcnt(9) lgkmcnt(0)
    s_barrier
    v_mfma_f32_16x16x32_bf16 v[200:203], a[224:227], a[164:167], v[200:203]
    ds_read_b64_tr_b16 a[208:209], v16 offset:0
    buffer_load_dwordx4 v244, s[12:15], s33 offen lds
    v_mfma_f32_16x16x32_bf16 v[200:203], a[228:231], a[176:179], v[200:203]
    ds_read_b64_tr_b16 a[210:211], v16 offset:6144
    buffer_load_dwordx4 v245, s[12:15], s33 offen offset:1024 lds
    v_mfma_f32_16x16x32_bf16 v[204:207], a[224:227], a[168:171], v[204:207]
    ds_read_b64_tr_b16 a[212:213], v16 offset:12288
    buffer_load_dwordx4 v246, s[12:15], s33 offen offset:2048 lds
    v_mfma_f32_16x16x32_bf16 v[204:207], a[228:231], a[180:183], v[204:207]
    ds_read_b64_tr_b16 a[214:215], v16 offset:18432
    s_add_u32 s50, s33, 64
    v_mfma_f32_16x16x32_bf16 v[208:211], a[232:235], a[160:163], v[208:211]
    ds_read_b64_tr_b16 a[216:217], v17 offset:0
    s_add_u32 m0, s40, 3072
    v_mfma_f32_16x16x32_bf16 v[208:211], a[236:239], a[172:175], v[208:211]
    ds_read_b64_tr_b16 a[218:219], v17 offset:6144
    buffer_load_dwordx4 v244, s[12:15], s50 offen lds
    v_mfma_f32_16x16x32_bf16 v[212:215], a[232:235], a[164:167], v[212:215]
    ds_read_b64_tr_b16 a[220:221], v17 offset:12288
    buffer_load_dwordx4 v245, s[12:15], s50 offen offset:1024 lds
    v_mfma_f32_16x16x32_bf16 v[212:215], a[236:239], a[176:179], v[212:215]
    ds_read_b64_tr_b16 a[222:223], v17 offset:18432
    buffer_load_dwordx4 v246, s[12:15], s50 offen offset:2048 lds
    v_mfma_f32_16x16x32_bf16 v[216:219], a[232:235], a[168:171], v[216:219]
    ds_read_b128 a[184:187], v14 offset:0
    s_add_u32 s33, s33, 128
    v_mfma_f32_16x16x32_bf16 v[216:219], a[236:239], a[180:183], v[216:219]
    ds_read_b128 a[188:191], v14 offset:1024
    s_cmp_eq_u32 s40, s42
    s_cselect_b32 s51, s48, s47
    v_mfma_f32_16x16x32_bf16 v[220:223], a[240:243], a[160:163], v[220:223]
    ds_read_b128 a[192:195], v14 offset:2048
    s_add_u32 s40, s40, s51
    v_mfma_f32_16x16x32_bf16 v[220:223], a[244:247], a[172:175], v[220:223]
    ds_read_b128 a[196:199], v14 offset:3072
    buffer_load_dword v254, v255, s[72:75], s76 offen sc1
    v_mfma_f32_16x16x32_bf16 v[224:227], a[240:243], a[164:167], v[224:227]
    ds_read_b128 a[200:203], v14 offset:4096
    s_add_u32 s76, s76, s77
    v_mfma_f32_16x16x32_bf16 v[224:227], a[244:247], a[176:179], v[224:227]
    ds_read_b128 a[204:207], v14 offset:5120
    s_waitcnt lgkmcnt(7)
    v_mfma_f32_16x16x32_bf16 v[228:231], a[240:243], a[168:171], v[228:231]
    ds_read_b64_tr_b16 a[224:225], v18 offset:0
    v_mul_f32 v72, v72, v23
    v_mul_f32 v73, v73, v23
    v_mul_f32 v74, v74, v23
    v_mul_f32 v75, v75, v23
    v_cvt_pk_bf16_f32 v50, v72, v73
    v_cvt_pk_bf16_f32 v51, v74, v75
    v_mfma_f32_16x16x32_bf16 v[228:231], a[244:247], a[180:183], v[228:231]
    ds_read_b64_tr_b16 a[226:227], v18 offset:6144
    s_mov_b32 s52, 4096
    v_mfma_f32_16x16x32_bf16 v[232:235], a[248:251], a[160:163], v[232:235]
    ds_read_b64_tr_b16 a[228:229], v18 offset:12288
    buffer_store_dwordx4 v[44:47], v20, s[28:31], s52 offen sc1
    v_mfma_f32_16x16x32_bf16 v[232:235], a[252:255], a[172:175], v[232:235]
    ds_read_b64_tr_b16 a[230:231], v18 offset:18432
    s_mov_b32 s52, 4096
    v_mfma_f32_16x16x32_bf16 v[236:239], a[248:251], a[164:167], v[236:239]
    ds_read_b64_tr_b16 a[232:233], v19 offset:0
    buffer_store_dwordx4 v[48:51], v20, s[28:31], s52 offen offset:1024 sc1
    v_mfma_f32_16x16x32_bf16 v[236:239], a[252:255], a[176:179], v[236:239]
    ds_read_b64_tr_b16 a[234:235], v19 offset:6144
    v_mfma_f32_16x16x32_bf16 v[240:243], a[248:251], a[168:171], v[240:243]
    ds_read_b64_tr_b16 a[236:237], v19 offset:12288
    v_mfma_f32_16x16x32_bf16 v[240:243], a[252:255], a[180:183], v[240:243]
    ds_read_b64_tr_b16 a[238:239], v19 offset:18432
    s_waitcnt lgkmcnt(4)
    v_mfma_f32_16x16x32_bf16 v[100:103], a[208:211], a[184:187], v[100:103]
    ds_read_b64_tr_b16 a[240:241], v16 offset:128
    s_mov_b32 m0, s39
    v_mfma_f32_16x16x32_bf16 v[100:103], a[212:215], a[196:199], v[100:103]
    ds_read_b64_tr_b16 a[242:243], v16 offset:6272
    v_accvgpr_read_b32 v52, a48
    v_mfma_f32_16x16x32_bf16 v[104:107], a[208:211], a[188:191], v[104:107]
    ds_read_b64_tr_b16 a[244:245], v16 offset:12416
    v_accvgpr_read_b32 v53, a49
    v_mfma_f32_16x16x32_bf16 v[104:107], a[212:215], a[200:203], v[104:107]
    ds_read_b64_tr_b16 a[246:247], v16 offset:18560
    v_accvgpr_read_b32 v54, a50
    v_mfma_f32_16x16x32_bf16 v[108:111], a[208:211], a[192:195], v[108:111]
    ds_read_b64_tr_b16 a[248:249], v17 offset:128
    v_accvgpr_read_b32 v55, a51
    v_mfma_f32_16x16x32_bf16 v[108:111], a[212:215], a[204:207], v[108:111]
    ds_read_b64_tr_b16 a[250:251], v17 offset:6272
    v_mul_f32 v52, v52, v21
    v_mfma_f32_16x16x32_bf16 v[112:115], a[216:219], a[184:187], v[112:115]
    ds_read_b64_tr_b16 a[252:253], v17 offset:12416
    v_mul_f32 v53, v53, v21
    v_mfma_f32_16x16x32_bf16 v[112:115], a[220:223], a[196:199], v[112:115]
    ds_read_b64_tr_b16 a[254:255], v17 offset:18560
    v_mul_f32 v54, v54, v21
    v_mfma_f32_16x16x32_bf16 v[116:119], a[216:219], a[188:191], v[116:119]
    buffer_load_dwordx4 v247, s[8:11], s32 offen lds
    v_mfma_f32_16x16x32_bf16 v[116:119], a[220:223], a[200:203], v[116:119]
    buffer_load_dwordx4 v248, s[8:11], s32 offen offset:1024 lds
    v_mfma_f32_16x16x32_bf16 v[120:123], a[216:219], a[192:195], v[120:123]
    buffer_load_dwordx4 v249, s[8:11], s32 offen offset:2048 lds
    v_mfma_f32_16x16x32_bf16 v[120:123], a[220:223], a[204:207], v[120:123]
    s_add_u32 s49, s32, 196608
    s_waitcnt lgkmcnt(7)
    v_mfma_f32_16x16x32_bf16 v[124:127], a[224:227], a[184:187], v[124:127]
    ds_read_b64_tr_b16 a[208:209], v18 offset:128
    s_add_u32 m0, s39, 3072
    v_mfma_f32_16x16x32_bf16 v[124:127], a[228:231], a[196:199], v[124:127]
    ds_read_b64_tr_b16 a[210:211], v18 offset:6272
    v_mul_f32 v55, v55, v21
    v_mfma_f32_16x16x32_bf16 v[128:131], a[224:227], a[188:191], v[128:131]
    ds_read_b64_tr_b16 a[212:213], v18 offset:12416
    v_cvt_pk_bf16_f32 v28, v52, v53
    v_mfma_f32_16x16x32_bf16 v[128:131], a[228:231], a[200:203], v[128:131]
    ds_read_b64_tr_b16 a[214:215], v18 offset:18560
    v_cvt_pk_bf16_f32 v29, v54, v55
    v_mfma_f32_16x16x32_bf16 v[132:135], a[224:227], a[192:195], v[132:135]
    ds_read_b64_tr_b16 a[216:217], v19 offset:128
    v_accvgpr_read_b32 v56, a60
    v_mfma_f32_16x16x32_bf16 v[132:135], a[228:231], a[204:207], v[132:135]
    ds_read_b64_tr_b16 a[218:219], v19 offset:6272
    v_accvgpr_read_b32 v57, a61
    v_mfma_f32_16x16x32_bf16 v[136:139], a[232:235], a[184:187], v[136:139]
    ds_read_b64_tr_b16 a[220:221], v19 offset:12416
    v_accvgpr_read_b32 v58, a62
    v_mfma_f32_16x16x32_bf16 v[136:139], a[236:239], a[196:199], v[136:139]
    ds_read_b64_tr_b16 a[222:223], v19 offset:18560
    v_accvgpr_read_b32 v59, a63
    v_mfma_f32_16x16x32_bf16 v[140:143], a[232:235], a[188:191], v[140:143]
    s_cmp_eq_u32 s43, 49152
    s_cselect_b32 s45, s48, s47
    v_mfma_f32_16x16x32_bf16 v[140:143], a[236:239], a[200:203], v[140:143]
    s_add_u32 s43, s43, s45
    v_mul_f32 v56, v56, v21
    v_mfma_f32_16x16x32_bf16 v[144:147], a[232:235], a[192:195], v[144:147]
    buffer_load_dwordx4 v247, s[8:11], s49 offen lds
    v_mfma_f32_16x16x32_bf16 v[144:147], a[236:239], a[204:207], v[144:147]
    v_mul_f32 v57, v57, v21
    s_waitcnt lgkmcnt(7)
    v_mfma_f32_16x16x32_bf16 v[148:151], a[240:243], a[184:187], v[148:151]
    ds_read_b64_tr_b16 a[224:225], v16 offset:256
    v_mul_f32 v58, v58, v21
    v_mfma_f32_16x16x32_bf16 v[148:151], a[244:247], a[196:199], v[148:151]
    ds_read_b64_tr_b16 a[226:227], v16 offset:6400
    v_mul_f32 v59, v59, v21
    v_mfma_f32_16x16x32_bf16 v[152:155], a[240:243], a[188:191], v[152:155]
    ds_read_b64_tr_b16 a[228:229], v16 offset:12544
    v_cvt_pk_bf16_f32 v30, v56, v57
    v_mfma_f32_16x16x32_bf16 v[152:155], a[244:247], a[200:203], v[152:155]
    ds_read_b64_tr_b16 a[230:231], v16 offset:18688
    v_cvt_pk_bf16_f32 v31, v58, v59
    v_mfma_f32_16x16x32_bf16 v[156:159], a[240:243], a[192:195], v[156:159]
    ds_read_b64_tr_b16 a[232:233], v17 offset:256
    v_accvgpr_read_b32 v60, a52
    v_mfma_f32_16x16x32_bf16 v[156:159], a[244:247], a[204:207], v[156:159]
    ds_read_b64_tr_b16 a[234:235], v17 offset:6400
    v_accvgpr_read_b32 v61, a53
    v_mfma_f32_16x16x32_bf16 v[160:163], a[248:251], a[184:187], v[160:163]
    ds_read_b64_tr_b16 a[236:237], v17 offset:12544
    v_accvgpr_read_b32 v62, a54
    v_mfma_f32_16x16x32_bf16 v[160:163], a[252:255], a[196:199], v[160:163]
    ds_read_b64_tr_b16 a[238:239], v17 offset:18688
    v_accvgpr_read_b32 v63, a55
    v_mfma_f32_16x16x32_bf16 v[164:167], a[248:251], a[188:191], v[164:167]
    buffer_load_dwordx4 v248, s[8:11], s49 offen offset:1024 lds
    v_mfma_f32_16x16x32_bf16 v[164:167], a[252:255], a[200:203], v[164:167]
    buffer_load_dwordx4 v249, s[8:11], s49 offen offset:2048 lds
    v_mfma_f32_16x16x32_bf16 v[168:171], a[248:251], a[192:195], v[168:171]
    s_add_u32 s32, s32, 786432
    v_mul_f32 v60, v60, v22
    v_mfma_f32_16x16x32_bf16 v[168:171], a[252:255], a[204:207], v[168:171]
    v_mul_f32 v61, v61, v22
    s_waitcnt lgkmcnt(7)
    v_mfma_f32_16x16x32_bf16 v[172:175], a[208:211], a[184:187], v[172:175]
    ds_read_b64_tr_b16 a[240:241], v18 offset:256
    v_mul_f32 v62, v62, v22
    v_mfma_f32_16x16x32_bf16 v[172:175], a[212:215], a[196:199], v[172:175]
    ds_read_b64_tr_b16 a[242:243], v18 offset:6400
    v_mul_f32 v63, v63, v22
    v_mfma_f32_16x16x32_bf16 v[176:179], a[208:211], a[188:191], v[176:179]
    ds_read_b64_tr_b16 a[244:245], v18 offset:12544
    v_cvt_pk_bf16_f32 v32, v60, v61
    v_mfma_f32_16x16x32_bf16 v[176:179], a[212:215], a[200:203], v[176:179]
    ds_read_b64_tr_b16 a[246:247], v18 offset:18688
    v_cvt_pk_bf16_f32 v33, v62, v63
    v_mfma_f32_16x16x32_bf16 v[180:183], a[208:211], a[192:195], v[180:183]
    ds_read_b64_tr_b16 a[248:249], v19 offset:256
    v_accvgpr_read_b32 v64, a64
    v_mfma_f32_16x16x32_bf16 v[180:183], a[212:215], a[204:207], v[180:183]
    ds_read_b64_tr_b16 a[250:251], v19 offset:6400
    v_accvgpr_read_b32 v65, a65
    v_mfma_f32_16x16x32_bf16 v[184:187], a[216:219], a[184:187], v[184:187]
    ds_read_b64_tr_b16 a[252:253], v19 offset:12544
    v_accvgpr_read_b32 v66, a66
    v_mfma_f32_16x16x32_bf16 v[184:187], a[220:223], a[196:199], v[184:187]
    ds_read_b64_tr_b16 a[254:255], v19 offset:18688
    v_accvgpr_read_b32 v67, a67
    v_mfma_f32_16x16x32_bf16 v[188:191], a[216:219], a[188:191], v[188:191]
    s_cmp_eq_u32 s39, s41
    s_cselect_b32 s51, s48, s47
    v_mfma_f32_16x16x32_bf16 v[188:191], a[220:223], a[200:203], v[188:191]
    s_add_u32 s39, s39, s51
    s_mov_b32 m0, s40
    v_mfma_f32_16x16x32_bf16 v[192:195], a[216:219], a[192:195], v[192:195]
    v_add_u32 v16, s45, v16
    v_add_u32 v17, s45, v17
    v_mfma_f32_16x16x32_bf16 v[192:195], a[220:223], a[204:207], v[192:195]
    v_add_u32 v18, s45, v18
    s_waitcnt lgkmcnt(7)
    v_mfma_f32_16x16x32_bf16 v[196:199], a[224:227], a[184:187], v[196:199]
    v_add_u32 v19, s45, v19
    v_add_u32 v14, s45, v14
    v_mfma_f32_16x16x32_bf16 v[196:199], a[228:231], a[196:199], v[196:199]
    s_waitcnt vmcnt(9) lgkmcnt(0)
    s_barrier
    v_mfma_f32_16x16x32_bf16 v[200:203], a[224:227], a[188:191], v[200:203]
    ds_read_b64_tr_b16 a[208:209], v16 offset:0
    buffer_load_dwordx4 v244, s[12:15], s33 offen lds
    v_mfma_f32_16x16x32_bf16 v[200:203], a[228:231], a[200:203], v[200:203]
    ds_read_b64_tr_b16 a[210:211], v16 offset:6144
    buffer_load_dwordx4 v245, s[12:15], s33 offen offset:1024 lds
    v_mfma_f32_16x16x32_bf16 v[204:207], a[224:227], a[192:195], v[204:207]
    ds_read_b64_tr_b16 a[212:213], v16 offset:12288
    buffer_load_dwordx4 v246, s[12:15], s33 offen offset:2048 lds
    v_mfma_f32_16x16x32_bf16 v[204:207], a[228:231], a[204:207], v[204:207]
    ds_read_b64_tr_b16 a[214:215], v16 offset:18432
    s_add_u32 s50, s33, 64
    v_mfma_f32_16x16x32_bf16 v[208:211], a[232:235], a[184:187], v[208:211]
    ds_read_b64_tr_b16 a[216:217], v17 offset:0
    s_add_u32 m0, s40, 3072
    v_mfma_f32_16x16x32_bf16 v[208:211], a[236:239], a[196:199], v[208:211]
    ds_read_b64_tr_b16 a[218:219], v17 offset:6144
    buffer_load_dwordx4 v244, s[12:15], s50 offen lds
    v_mfma_f32_16x16x32_bf16 v[212:215], a[232:235], a[188:191], v[212:215]
    ds_read_b64_tr_b16 a[220:221], v17 offset:12288
    buffer_load_dwordx4 v245, s[12:15], s50 offen offset:1024 lds
    v_mfma_f32_16x16x32_bf16 v[212:215], a[236:239], a[200:203], v[212:215]
    ds_read_b64_tr_b16 a[222:223], v17 offset:18432
    buffer_load_dwordx4 v246, s[12:15], s50 offen offset:2048 lds
    v_mfma_f32_16x16x32_bf16 v[216:219], a[232:235], a[192:195], v[216:219]
    ds_read_b128 a[160:163], v14 offset:0
    s_add_u32 s33, s33, 128
    v_mfma_f32_16x16x32_bf16 v[216:219], a[236:239], a[204:207], v[216:219]
    ds_read_b128 a[164:167], v14 offset:1024
    s_cmp_eq_u32 s40, s42
    s_cselect_b32 s51, s48, s47
    v_mfma_f32_16x16x32_bf16 v[220:223], a[240:243], a[184:187], v[220:223]
    ds_read_b128 a[168:171], v14 offset:2048
    s_add_u32 s40, s40, s51
    v_mfma_f32_16x16x32_bf16 v[220:223], a[244:247], a[196:199], v[220:223]
    ds_read_b128 a[172:175], v14 offset:3072
    buffer_load_dword v254, v255, s[72:75], s76 offen sc1
    v_mfma_f32_16x16x32_bf16 v[224:227], a[240:243], a[188:191], v[224:227]
    ds_read_b128 a[176:179], v14 offset:4096
    s_add_u32 s76, s76, s77
    v_mfma_f32_16x16x32_bf16 v[224:227], a[244:247], a[200:203], v[224:227]
    ds_read_b128 a[180:183], v14 offset:5120
    s_waitcnt lgkmcnt(7)
    v_mfma_f32_16x16x32_bf16 v[228:231], a[240:243], a[192:195], v[228:231]
    ds_read_b64_tr_b16 a[224:225], v18 offset:0
    v_mul_f32 v64, v64, v22
    v_mul_f32 v65, v65, v22
    v_mul_f32 v66, v66, v22
    v_mul_f32 v67, v67, v22
    v_cvt_pk_bf16_f32 v34, v64, v65
    v_cvt_pk_bf16_f32 v35, v66, v67
    v_mfma_f32_16x16x32_bf16 v[228:231], a[244:247], a[204:207], v[228:231]
    ds_read_b64_tr_b16 a[226:227], v18 offset:6144
    s_mov_b32 s52, 4096
    v_mfma_f32_16x16x32_bf16 v[232:235], a[248:251], a[184:187], v[232:235]
    ds_read_b64_tr_b16 a[228:229], v18 offset:12288
    buffer_store_dwordx4 v[28:31], v20, s[28:31], s52 offen offset:2048 sc1
    v_mfma_f32_16x16x32_bf16 v[232:235], a[252:255], a[196:199], v[232:235]
    ds_read_b64_tr_b16 a[230:231], v18 offset:18432
    s_mov_b32 s52, 4096
    v_mfma_f32_16x16x32_bf16 v[236:239], a[248:251], a[188:191], v[236:239]
    ds_read_b64_tr_b16 a[232:233], v19 offset:0
    buffer_store_dwordx4 v[32:35], v20, s[28:31], s52 offen offset:3072 sc1
    v_mfma_f32_16x16x32_bf16 v[236:239], a[252:255], a[200:203], v[236:239]
    ds_read_b64_tr_b16 a[234:235], v19 offset:6144
    v_mfma_f32_16x16x32_bf16 v[240:243], a[248:251], a[192:195], v[240:243]
    ds_read_b64_tr_b16 a[236:237], v19 offset:12288
    v_mfma_f32_16x16x32_bf16 v[240:243], a[252:255], a[204:207], v[240:243]
    ds_read_b64_tr_b16 a[238:239], v19 offset:18432
    s_waitcnt lgkmcnt(4)
    v_mfma_f32_16x16x32_bf16 v[100:103], a[208:211], a[160:163], v[100:103]
    ds_read_b64_tr_b16 a[240:241], v16 offset:128
    s_mov_b32 m0, s39
    v_mfma_f32_16x16x32_bf16 v[100:103], a[212:215], a[172:175], v[100:103]
    ds_read_b64_tr_b16 a[242:243], v16 offset:6272
    v_accvgpr_read_b32 v68, a56
    v_mfma_f32_16x16x32_bf16 v[104:107], a[208:211], a[164:167], v[104:107]
    ds_read_b64_tr_b16 a[244:245], v16 offset:12416
    v_accvgpr_read_b32 v69, a57
    v_mfma_f32_16x16x32_bf16 v[104:107], a[212:215], a[176:179], v[104:107]
    ds_read_b64_tr_b16 a[246:247], v16 offset:18560
    v_accvgpr_read_b32 v70, a58
    v_mfma_f32_16x16x32_bf16 v[108:111], a[208:211], a[168:171], v[108:111]
    ds_read_b64_tr_b16 a[248:249], v17 offset:128
    v_accvgpr_read_b32 v71, a59
    v_mfma_f32_16x16x32_bf16 v[108:111], a[212:215], a[180:183], v[108:111]
    ds_read_b64_tr_b16 a[250:251], v17 offset:6272
    v_mul_f32 v68, v68, v23
    v_mfma_f32_16x16x32_bf16 v[112:115], a[216:219], a[160:163], v[112:115]
    ds_read_b64_tr_b16 a[252:253], v17 offset:12416
    v_mul_f32 v69, v69, v23
    v_mfma_f32_16x16x32_bf16 v[112:115], a[220:223], a[172:175], v[112:115]
    ds_read_b64_tr_b16 a[254:255], v17 offset:18560
    v_mul_f32 v70, v70, v23
    v_mfma_f32_16x16x32_bf16 v[116:119], a[216:219], a[164:167], v[116:119]
    buffer_load_dwordx4 v247, s[8:11], s32 offen lds
    v_mfma_f32_16x16x32_bf16 v[116:119], a[220:223], a[176:179], v[116:119]
    buffer_load_dwordx4 v248, s[8:11], s32 offen offset:1024 lds
    v_mfma_f32_16x16x32_bf16 v[120:123], a[216:219], a[168:171], v[120:123]
    buffer_load_dwordx4 v249, s[8:11], s32 offen offset:2048 lds
    v_mfma_f32_16x16x32_bf16 v[120:123], a[220:223], a[180:183], v[120:123]
    s_add_u32 s49, s32, 196608
    s_waitcnt lgkmcnt(7)
    v_mfma_f32_16x16x32_bf16 v[124:127], a[224:227], a[160:163], v[124:127]
    ds_read_b64_tr_b16 a[208:209], v18 offset:128
    s_add_u32 m0, s39, 3072
    v_mfma_f32_16x16x32_bf16 v[124:127], a[228:231], a[172:175], v[124:127]
    ds_read_b64_tr_b16 a[210:211], v18 offset:6272
    v_mul_f32 v71, v71, v23
    v_mfma_f32_16x16x32_bf16 v[128:131], a[224:227], a[164:167], v[128:131]
    ds_read_b64_tr_b16 a[212:213], v18 offset:12416
    v_cvt_pk_bf16_f32 v36, v68, v69
    v_mfma_f32_16x16x32_bf16 v[128:131], a[228:231], a[176:179], v[128:131]
    ds_read_b64_tr_b16 a[214:215], v18 offset:18560
    v_cvt_pk_bf16_f32 v37, v70, v71
    v_mfma_f32_16x16x32_bf16 v[132:135], a[224:227], a[168:171], v[132:135]
    ds_read_b64_tr_b16 a[216:217], v19 offset:128
    v_accvgpr_read_b32 v72, a68
    v_mfma_f32_16x16x32_bf16 v[132:135], a[228:231], a[180:183], v[132:135]
    ds_read_b64_tr_b16 a[218:219], v19 offset:6272
    v_accvgpr_read_b32 v73, a69
    v_mfma_f32_16x16x32_bf16 v[136:139], a[232:235], a[160:163], v[136:139]
    ds_read_b64_tr_b16 a[220:221], v19 offset:12416
    v_accvgpr_read_b32 v74, a70
    v_mfma_f32_16x16x32_bf16 v[136:139], a[236:239], a[172:175], v[136:139]
    ds_read_b64_tr_b16 a[222:223], v19 offset:18560
    v_accvgpr_read_b32 v75, a71
    v_mfma_f32_16x16x32_bf16 v[140:143], a[232:235], a[164:167], v[140:143]
    s_cmp_eq_u32 s43, 49152
    s_cselect_b32 s45, s48, s47
    v_mfma_f32_16x16x32_bf16 v[140:143], a[236:239], a[176:179], v[140:143]
    s_add_u32 s43, s43, s45
    v_mul_f32 v72, v72, v23
    v_mfma_f32_16x16x32_bf16 v[144:147], a[232:235], a[168:171], v[144:147]
    buffer_load_dwordx4 v247, s[8:11], s49 offen lds
    v_mfma_f32_16x16x32_bf16 v[144:147], a[236:239], a[180:183], v[144:147]
    v_mul_f32 v73, v73, v23
    s_waitcnt lgkmcnt(7)
    v_mfma_f32_16x16x32_bf16 v[148:151], a[240:243], a[160:163], v[148:151]
    ds_read_b64_tr_b16 a[224:225], v16 offset:256
    v_mul_f32 v74, v74, v23
    v_mfma_f32_16x16x32_bf16 v[148:151], a[244:247], a[172:175], v[148:151]
    ds_read_b64_tr_b16 a[226:227], v16 offset:6400
    v_mul_f32 v75, v75, v23
    v_mfma_f32_16x16x32_bf16 v[152:155], a[240:243], a[164:167], v[152:155]
    ds_read_b64_tr_b16 a[228:229], v16 offset:12544
    v_cvt_pk_bf16_f32 v38, v72, v73
    v_mfma_f32_16x16x32_bf16 v[152:155], a[244:247], a[176:179], v[152:155]
    ds_read_b64_tr_b16 a[230:231], v16 offset:18688
    v_cvt_pk_bf16_f32 v39, v74, v75
    v_mfma_f32_16x16x32_bf16 v[156:159], a[240:243], a[168:171], v[156:159]
    ds_read_b64_tr_b16 a[232:233], v17 offset:256
    v_accvgpr_read_b32 v52, a72
    v_mfma_f32_16x16x32_bf16 v[156:159], a[244:247], a[180:183], v[156:159]
    ds_read_b64_tr_b16 a[234:235], v17 offset:6400
    v_accvgpr_read_b32 v53, a73
    v_mfma_f32_16x16x32_bf16 v[160:163], a[248:251], a[160:163], v[160:163]
    ds_read_b64_tr_b16 a[236:237], v17 offset:12544
    v_accvgpr_read_b32 v54, a74
    v_mfma_f32_16x16x32_bf16 v[160:163], a[252:255], a[172:175], v[160:163]
    ds_read_b64_tr_b16 a[238:239], v17 offset:18688
    v_accvgpr_read_b32 v55, a75
    v_mfma_f32_16x16x32_bf16 v[164:167], a[248:251], a[164:167], v[164:167]
    buffer_load_dwordx4 v248, s[8:11], s49 offen offset:1024 lds
    v_mfma_f32_16x16x32_bf16 v[164:167], a[252:255], a[176:179], v[164:167]
    buffer_load_dwordx4 v249, s[8:11], s49 offen offset:2048 lds
    v_mfma_f32_16x16x32_bf16 v[168:171], a[248:251], a[168:171], v[168:171]
    s_add_u32 s32, s32, 786432
    v_mul_f32 v52, v52, v21
    v_mfma_f32_16x16x32_bf16 v[168:171], a[252:255], a[180:183], v[168:171]
    v_mul_f32 v53, v53, v21
    s_waitcnt lgkmcnt(7)
    v_mfma_f32_16x16x32_bf16 v[172:175], a[208:211], a[160:163], v[172:175]
    ds_read_b64_tr_b16 a[240:241], v18 offset:256
    v_mul_f32 v54, v54, v21
    v_mfma_f32_16x16x32_bf16 v[172:175], a[212:215], a[172:175], v[172:175]
    ds_read_b64_tr_b16 a[242:243], v18 offset:6400
    v_mul_f32 v55, v55, v21
    v_mfma_f32_16x16x32_bf16 v[176:179], a[208:211], a[164:167], v[176:179]
    ds_read_b64_tr_b16 a[244:245], v18 offset:12544
    v_cvt_pk_bf16_f32 v40, v52, v53
    v_mfma_f32_16x16x32_bf16 v[176:179], a[212:215], a[176:179], v[176:179]
    ds_read_b64_tr_b16 a[246:247], v18 offset:18688
    v_cvt_pk_bf16_f32 v41, v54, v55
    v_mfma_f32_16x16x32_bf16 v[180:183], a[208:211], a[168:171], v[180:183]
    ds_read_b64_tr_b16 a[248:249], v19 offset:256
    v_accvgpr_read_b32 v56, a84
    v_mfma_f32_16x16x32_bf16 v[180:183], a[212:215], a[180:183], v[180:183]
    ds_read_b64_tr_b16 a[250:251], v19 offset:6400
    v_accvgpr_read_b32 v57, a85
    v_mfma_f32_16x16x32_bf16 v[184:187], a[216:219], a[160:163], v[184:187]
    ds_read_b64_tr_b16 a[252:253], v19 offset:12544
    v_accvgpr_read_b32 v58, a86
    v_mfma_f32_16x16x32_bf16 v[184:187], a[220:223], a[172:175], v[184:187]
    ds_read_b64_tr_b16 a[254:255], v19 offset:18688
    v_accvgpr_read_b32 v59, a87
    v_mfma_f32_16x16x32_bf16 v[188:191], a[216:219], a[164:167], v[188:191]
    s_cmp_eq_u32 s39, s41
    s_cselect_b32 s51, s48, s47
    v_mfma_f32_16x16x32_bf16 v[188:191], a[220:223], a[176:179], v[188:191]
    s_add_u32 s39, s39, s51
    s_mov_b32 m0, s40
    v_mfma_f32_16x16x32_bf16 v[192:195], a[216:219], a[168:171], v[192:195]
    v_add_u32 v16, s45, v16
    v_add_u32 v17, s45, v17
    v_mfma_f32_16x16x32_bf16 v[192:195], a[220:223], a[180:183], v[192:195]
    v_add_u32 v18, s45, v18
    s_waitcnt lgkmcnt(7)
    v_mfma_f32_16x16x32_bf16 v[196:199], a[224:227], a[160:163], v[196:199]
    v_add_u32 v19, s45, v19
    v_add_u32 v14, s45, v14
    v_mfma_f32_16x16x32_bf16 v[196:199], a[228:231], a[172:175], v[196:199]
    s_waitcnt vmcnt(9) lgkmcnt(0)
    s_barrier
    v_mfma_f32_16x16x32_bf16 v[200:203], a[224:227], a[164:167], v[200:203]
    ds_read_b64_tr_b16 a[208:209], v16 offset:0
    buffer_load_dwordx4 v244, s[12:15], s33 offen lds
    v_mfma_f32_16x16x32_bf16 v[200:203], a[228:231], a[176:179], v[200:203]
    ds_read_b64_tr_b16 a[210:211], v16 offset:6144
    buffer_load_dwordx4 v245, s[12:15], s33 offen offset:1024 lds
    v_mfma_f32_16x16x32_bf16 v[204:207], a[224:227], a[168:171], v[204:207]
    ds_read_b64_tr_b16 a[212:213], v16 offset:12288
    buffer_load_dwordx4 v246, s[12:15], s33 offen offset:2048 lds
    v_mfma_f32_16x16x32_bf16 v[204:207], a[228:231], a[180:183], v[204:207]
    ds_read_b64_tr_b16 a[214:215], v16 offset:18432
    s_add_u32 s50, s33, 64
    v_mfma_f32_16x16x32_bf16 v[208:211], a[232:235], a[160:163], v[208:211]
    ds_read_b64_tr_b16 a[216:217], v17 offset:0
    s_add_u32 m0, s40, 3072
    v_mfma_f32_16x16x32_bf16 v[208:211], a[236:239], a[172:175], v[208:211]
    ds_read_b64_tr_b16 a[218:219], v17 offset:6144
    buffer_load_dwordx4 v244, s[12:15], s50 offen lds
    v_mfma_f32_16x16x32_bf16 v[212:215], a[232:235], a[164:167], v[212:215]
    ds_read_b64_tr_b16 a[220:221], v17 offset:12288
    buffer_load_dwordx4 v245, s[12:15], s50 offen offset:1024 lds
    v_mfma_f32_16x16x32_bf16 v[212:215], a[236:239], a[176:179], v[212:215]
    ds_read_b64_tr_b16 a[222:223], v17 offset:18432
    buffer_load_dwordx4 v246, s[12:15], s50 offen offset:2048 lds
    v_mfma_f32_16x16x32_bf16 v[216:219], a[232:235], a[168:171], v[216:219]
    ds_read_b128 a[184:187], v14 offset:0
    s_add_u32 s33, s33, 128
    v_mfma_f32_16x16x32_bf16 v[216:219], a[236:239], a[180:183], v[216:219]
    ds_read_b128 a[188:191], v14 offset:1024
    s_cmp_eq_u32 s40, s42
    s_cselect_b32 s51, s48, s47
    v_mfma_f32_16x16x32_bf16 v[220:223], a[240:243], a[160:163], v[220:223]
    ds_read_b128 a[192:195], v14 offset:2048
    s_add_u32 s40, s40, s51
    v_mfma_f32_16x16x32_bf16 v[220:223], a[244:247], a[172:175], v[220:223]
    ds_read_b128 a[196:199], v14 offset:3072
    buffer_load_dword v254, v255, s[72:75], s76 offen sc1
    v_mfma_f32_16x16x32_bf16 v[224:227], a[240:243], a[164:167], v[224:227]
    ds_read_b128 a[200:203], v14 offset:4096
    s_add_u32 s76, s76, s77
    v_mfma_f32_16x16x32_bf16 v[224:227], a[244:247], a[176:179], v[224:227]
    ds_read_b128 a[204:207], v14 offset:5120
    s_waitcnt lgkmcnt(7)
    v_mfma_f32_16x16x32_bf16 v[228:231], a[240:243], a[168:171], v[228:231]
    ds_read_b64_tr_b16 a[224:225], v18 offset:0
    v_mul_f32 v56, v56, v21
    v_mul_f32 v57, v57, v21
    v_mul_f32 v58, v58, v21
    v_mul_f32 v59, v59, v21
    v_cvt_pk_bf16_f32 v42, v56, v57
    v_cvt_pk_bf16_f32 v43, v58, v59
    v_mfma_f32_16x16x32_bf16 v[228:231], a[244:247], a[180:183], v[228:231]
    ds_read_b64_tr_b16 a[226:227], v18 offset:6144
    s_mov_b32 s52, 8192
    v_mfma_f32_16x16x32_bf16 v[232:235], a[248:251], a[160:163], v[232:235]
    ds_read_b64_tr_b16 a[228:229], v18 offset:12288
    buffer_store_dwordx4 v[36:39], v20, s[28:31], s52 offen sc1
    v_mfma_f32_16x16x32_bf16 v[232:235], a[252:255], a[172:175], v[232:235]
    ds_read_b64_tr_b16 a[230:231], v18 offset:18432
    s_mov_b32 s52, 8192
    v_mfma_f32_16x16x32_bf16 v[236:239], a[248:251], a[164:167], v[236:239]
    ds_read_b64_tr_b16 a[232:233], v19 offset:0
    buffer_store_dwordx4 v[40:43], v20, s[28:31], s52 offen offset:1024 sc1
    v_mfma_f32_16x16x32_bf16 v[236:239], a[252:255], a[176:179], v[236:239]
    ds_read_b64_tr_b16 a[234:235], v19 offset:6144
    v_mfma_f32_16x16x32_bf16 v[240:243], a[248:251], a[168:171], v[240:243]
    ds_read_b64_tr_b16 a[236:237], v19 offset:12288
    v_mfma_f32_16x16x32_bf16 v[240:243], a[252:255], a[180:183], v[240:243]
    ds_read_b64_tr_b16 a[238:239], v19 offset:18432
    s_waitcnt lgkmcnt(4)
    v_mfma_f32_16x16x32_bf16 v[100:103], a[208:211], a[184:187], v[100:103]
    ds_read_b64_tr_b16 a[240:241], v16 offset:128
    s_mov_b32 m0, s39
    v_mfma_f32_16x16x32_bf16 v[100:103], a[212:215], a[196:199], v[100:103]
    ds_read_b64_tr_b16 a[242:243], v16 offset:6272
    v_accvgpr_read_b32 v60, a76
    v_mfma_f32_16x16x32_bf16 v[104:107], a[208:211], a[188:191], v[104:107]
    ds_read_b64_tr_b16 a[244:245], v16 offset:12416
    v_accvgpr_read_b32 v61, a77
    v_mfma_f32_16x16x32_bf16 v[104:107], a[212:215], a[200:203], v[104:107]
    ds_read_b64_tr_b16 a[246:247], v16 offset:18560
    v_accvgpr_read_b32 v62, a78
    v_mfma_f32_16x16x32_bf16 v[108:111], a[208:211], a[192:195], v[108:111]
    ds_read_b64_tr_b16 a[248:249], v17 offset:128
    v_accvgpr_read_b32 v63, a79
    v_mfma_f32_16x16x32_bf16 v[108:111], a[212:215], a[204:207], v[108:111]
    ds_read_b64_tr_b16 a[250:251], v17 offset:6272
    v_mul_f32 v60, v60, v22
    v_mfma_f32_16x16x32_bf16 v[112:115], a[216:219], a[184:187], v[112:115]
    ds_read_b64_tr_b16 a[252:253], v17 offset:12416
    v_mul_f32 v61, v61, v22
    v_mfma_f32_16x16x32_bf16 v[112:115], a[220:223], a[196:199], v[112:115]
    ds_read_b64_tr_b16 a[254:255], v17 offset:18560
    v_mul_f32 v62, v62, v22
    v_mfma_f32_16x16x32_bf16 v[116:119], a[216:219], a[188:191], v[116:119]
    buffer_load_dwordx4 v247, s[8:11], s32 offen lds
    v_mfma_f32_16x16x32_bf16 v[116:119], a[220:223], a[200:203], v[116:119]
    buffer_load_dwordx4 v248, s[8:11], s32 offen offset:1024 lds
    v_mfma_f32_16x16x32_bf16 v[120:123], a[216:219], a[192:195], v[120:123]
    buffer_load_dwordx4 v249, s[8:11], s32 offen offset:2048 lds
    v_mfma_f32_16x16x32_bf16 v[120:123], a[220:223], a[204:207], v[120:123]
    s_add_u32 s49, s32, 196608
    s_waitcnt lgkmcnt(7)
    v_mfma_f32_16x16x32_bf16 v[124:127], a[224:227], a[184:187], v[124:127]
    ds_read_b64_tr_b16 a[208:209], v18 offset:128
    s_add_u32 m0, s39, 3072
    v_mfma_f32_16x16x32_bf16 v[124:127], a[228:231], a[196:199], v[124:127]
    ds_read_b64_tr_b16 a[210:211], v18 offset:6272
    v_mul_f32 v63, v63, v22
    v_mfma_f32_16x16x32_bf16 v[128:131], a[224:227], a[188:191], v[128:131]
    ds_read_b64_tr_b16 a[212:213], v18 offset:12416
    v_cvt_pk_bf16_f32 v44, v60, v61
    v_mfma_f32_16x16x32_bf16 v[128:131], a[228:231], a[200:203], v[128:131]
    ds_read_b64_tr_b16 a[214:215], v18 offset:18560
    v_cvt_pk_bf16_f32 v45, v62, v63
    v_mfma_f32_16x16x32_bf16 v[132:135], a[224:227], a[192:195], v[132:135]
    ds_read_b64_tr_b16 a[216:217], v19 offset:128
    v_accvgpr_read_b32 v64, a88
    v_mfma_f32_16x16x32_bf16 v[132:135], a[228:231], a[204:207], v[132:135]
    ds_read_b64_tr_b16 a[218:219], v19 offset:6272
    v_accvgpr_read_b32 v65, a89
    v_mfma_f32_16x16x32_bf16 v[136:139], a[232:235], a[184:187], v[136:139]
    ds_read_b64_tr_b16 a[220:221], v19 offset:12416
    v_accvgpr_read_b32 v66, a90
    v_mfma_f32_16x16x32_bf16 v[136:139], a[236:239], a[196:199], v[136:139]
    ds_read_b64_tr_b16 a[222:223], v19 offset:18560
    v_accvgpr_read_b32 v67, a91
    v_mfma_f32_16x16x32_bf16 v[140:143], a[232:235], a[188:191], v[140:143]
    s_cmp_eq_u32 s43, 49152
    s_cselect_b32 s45, s48, s47
    v_mfma_f32_16x16x32_bf16 v[140:143], a[236:239], a[200:203], v[140:143]
    s_add_u32 s43, s43, s45
    v_mul_f32 v64, v64, v22
    v_mfma_f32_16x16x32_bf16 v[144:147], a[232:235], a[192:195], v[144:147]
    buffer_load_dwordx4 v247, s[8:11], s49 offen lds
    v_mfma_f32_16x16x32_bf16 v[144:147], a[236:239], a[204:207], v[144:147]
    v_mul_f32 v65, v65, v22
    s_waitcnt lgkmcnt(7)
    v_mfma_f32_16x16x32_bf16 v[148:151], a[240:243], a[184:187], v[148:151]
    ds_read_b64_tr_b16 a[224:225], v16 offset:256
    v_mul_f32 v66, v66, v22
    v_mfma_f32_16x16x32_bf16 v[148:151], a[244:247], a[196:199], v[148:151]
    ds_read_b64_tr_b16 a[226:227], v16 offset:6400
    v_mul_f32 v67, v67, v22
    v_mfma_f32_16x16x32_bf16 v[152:155], a[240:243], a[188:191], v[152:155]
    ds_read_b64_tr_b16 a[228:229], v16 offset:12544
    v_cvt_pk_bf16_f32 v46, v64, v65
    v_mfma_f32_16x16x32_bf16 v[152:155], a[244:247], a[200:203], v[152:155]
    ds_read_b64_tr_b16 a[230:231], v16 offset:18688
    v_cvt_pk_bf16_f32 v47, v66, v67
    v_mfma_f32_16x16x32_bf16 v[156:159], a[240:243], a[192:195], v[156:159]
    ds_read_b64_tr_b16 a[232:233], v17 offset:256
    v_accvgpr_read_b32 v68, a80
    v_mfma_f32_16x16x32_bf16 v[156:159], a[244:247], a[204:207], v[156:159]
    ds_read_b64_tr_b16 a[234:235], v17 offset:6400
    v_accvgpr_read_b32 v69, a81
    v_mfma_f32_16x16x32_bf16 v[160:163], a[248:251], a[184:187], v[160:163]
    ds_read_b64_tr_b16 a[236:237], v17 offset:12544
    v_accvgpr_read_b32 v70, a82
    v_mfma_f32_16x16x32_bf16 v[160:163], a[252:255], a[196:199], v[160:163]
    ds_read_b64_tr_b16 a[238:239], v17 offset:18688
    v_accvgpr_read_b32 v71, a83
    v_mfma_f32_16x16x32_bf16 v[164:167], a[248:251], a[188:191], v[164:167]
    buffer_load_dwordx4 v248, s[8:11], s49 offen offset:1024 lds
    v_mfma_f32_16x16x32_bf16 v[164:167], a[252:255], a[200:203], v[164:167]
    buffer_load_dwordx4 v249, s[8:11], s49 offen offset:2048 lds
    v_mfma_f32_16x16x32_bf16 v[168:171], a[248:251], a[192:195], v[168:171]
    s_add_u32 s32, s32, 786432
    v_mul_f32 v68, v68, v23
    v_mfma_f32_16x16x32_bf16 v[168:171], a[252:255], a[204:207], v[168:171]
    v_mul_f32 v69, v69, v23
    s_waitcnt lgkmcnt(7)
    v_mfma_f32_16x16x32_bf16 v[172:175], a[208:211], a[184:187], v[172:175]
    ds_read_b64_tr_b16 a[240:241], v18 offset:256
    v_mul_f32 v70, v70, v23
    v_mfma_f32_16x16x32_bf16 v[172:175], a[212:215], a[196:199], v[172:175]
    ds_read_b64_tr_b16 a[242:243], v18 offset:6400
    v_mul_f32 v71, v71, v23
    v_mfma_f32_16x16x32_bf16 v[176:179], a[208:211], a[188:191], v[176:179]
    ds_read_b64_tr_b16 a[244:245], v18 offset:12544
    v_cvt_pk_bf16_f32 v48, v68, v69
    v_mfma_f32_16x16x32_bf16 v[176:179], a[212:215], a[200:203], v[176:179]
    ds_read_b64_tr_b16 a[246:247], v18 offset:18688
    v_cvt_pk_bf16_f32 v49, v70, v71
    v_mfma_f32_16x16x32_bf16 v[180:183], a[208:211], a[192:195], v[180:183]
    ds_read_b64_tr_b16 a[248:249], v19 offset:256
    v_accvgpr_read_b32 v72, a92
    v_mfma_f32_16x16x32_bf16 v[180:183], a[212:215], a[204:207], v[180:183]
    ds_read_b64_tr_b16 a[250:251], v19 offset:6400
    v_accvgpr_read_b32 v73, a93
    v_mfma_f32_16x16x32_bf16 v[184:187], a[216:219], a[184:187], v[184:187]
    ds_read_b64_tr_b16 a[252:253], v19 offset:12544
    v_accvgpr_read_b32 v74, a94
    v_mfma_f32_16x16x32_bf16 v[184:187], a[220:223], a[196:199], v[184:187]
    ds_read_b64_tr_b16 a[254:255], v19 offset:18688
    v_accvgpr_read_b32 v75, a95
    v_mfma_f32_16x16x32_bf16 v[188:191], a[216:219], a[188:191], v[188:191]
    s_cmp_eq_u32 s39, s41
    s_cselect_b32 s51, s48, s47
    v_mfma_f32_16x16x32_bf16 v[188:191], a[220:223], a[200:203], v[188:191]
    s_add_u32 s39, s39, s51
    s_mov_b32 m0, s40
    v_mfma_f32_16x16x32_bf16 v[192:195], a[216:219], a[192:195], v[192:195]
    v_add_u32 v16, s45, v16
    v_add_u32 v17, s45, v17
    v_mfma_f32_16x16x32_bf16 v[192:195], a[220:223], a[204:207], v[192:195]
    v_add_u32 v18, s45, v18
    s_waitcnt lgkmcnt(7)
    v_mfma_f32_16x16x32_bf16 v[196:199], a[224:227], a[184:187], v[196:199]
    v_add_u32 v19, s45, v19
    v_add_u32 v14, s45, v14
    v_mfma_f32_16x16x32_bf16 v[196:199], a[228:231], a[196:199], v[196:199]
    s_waitcnt vmcnt(9) lgkmcnt(0)
    s_barrier
    v_mfma_f32_16x16x32_bf16 v[200:203], a[224:227], a[188:191], v[200:203]
    ds_read_b64_tr_b16 a[208:209], v16 offset:0
    buffer_load_dwordx4 v244, s[12:15], s33 offen lds
    v_mfma_f32_16x16x32_bf16 v[200:203], a[228:231], a[200:203], v[200:203]
    ds_read_b64_tr_b16 a[210:211], v16 offset:6144
    buffer_load_dwordx4 v245, s[12:15], s33 offen offset:1024 lds
    v_mfma_f32_16x16x32_bf16 v[204:207], a[224:227], a[192:195], v[204:207]
    ds_read_b64_tr_b16 a[212:213], v16 offset:12288
    buffer_load_dwordx4 v246, s[12:15], s33 offen offset:2048 lds
    v_mfma_f32_16x16x32_bf16 v[204:207], a[228:231], a[204:207], v[204:207]
    ds_read_b64_tr_b16 a[214:215], v16 offset:18432
    s_add_u32 s50, s33, 64
    v_mfma_f32_16x16x32_bf16 v[208:211], a[232:235], a[184:187], v[208:211]
    ds_read_b64_tr_b16 a[216:217], v17 offset:0
    s_add_u32 m0, s40, 3072
    v_mfma_f32_16x16x32_bf16 v[208:211], a[236:239], a[196:199], v[208:211]
    ds_read_b64_tr_b16 a[218:219], v17 offset:6144
    buffer_load_dwordx4 v244, s[12:15], s50 offen lds
    v_mfma_f32_16x16x32_bf16 v[212:215], a[232:235], a[188:191], v[212:215]
    ds_read_b64_tr_b16 a[220:221], v17 offset:12288
    buffer_load_dwordx4 v245, s[12:15], s50 offen offset:1024 lds
    v_mfma_f32_16x16x32_bf16 v[212:215], a[236:239], a[200:203], v[212:215]
    ds_read_b64_tr_b16 a[222:223], v17 offset:18432
    buffer_load_dwordx4 v246, s[12:15], s50 offen offset:2048 lds
    v_mfma_f32_16x16x32_bf16 v[216:219], a[232:235], a[192:195], v[216:219]
    ds_read_b128 a[160:163], v14 offset:0
    s_add_u32 s33, s33, 128
    v_mfma_f32_16x16x32_bf16 v[216:219], a[236:239], a[204:207], v[216:219]
    ds_read_b128 a[164:167], v14 offset:1024
    s_cmp_eq_u32 s40, s42
    s_cselect_b32 s51, s48, s47
    v_mfma_f32_16x16x32_bf16 v[220:223], a[240:243], a[184:187], v[220:223]
    ds_read_b128 a[168:171], v14 offset:2048
    s_add_u32 s40, s40, s51
    v_mfma_f32_16x16x32_bf16 v[220:223], a[244:247], a[196:199], v[220:223]
    ds_read_b128 a[172:175], v14 offset:3072
    buffer_load_dword v254, v255, s[72:75], s76 offen sc1
    v_mfma_f32_16x16x32_bf16 v[224:227], a[240:243], a[188:191], v[224:227]
    ds_read_b128 a[176:179], v14 offset:4096
    s_add_u32 s76, s76, s77
    v_mfma_f32_16x16x32_bf16 v[224:227], a[244:247], a[200:203], v[224:227]
    ds_read_b128 a[180:183], v14 offset:5120
    s_waitcnt lgkmcnt(7)
    v_mfma_f32_16x16x32_bf16 v[228:231], a[240:243], a[192:195], v[228:231]
    ds_read_b64_tr_b16 a[224:225], v18 offset:0
    v_mul_f32 v72, v72, v23
    v_mul_f32 v73, v73, v23
    v_mul_f32 v74, v74, v23
    v_mul_f32 v75, v75, v23
    v_cvt_pk_bf16_f32 v50, v72, v73
    v_cvt_pk_bf16_f32 v51, v74, v75
    v_accvgpr_read_b32 v52, a96
    v_accvgpr_read_b32 v53, a97
    v_accvgpr_read_b32 v54, a98
    v_accvgpr_read_b32 v55, a99
    v_mul_f32 v52, v52, v21
    v_mul_f32 v53, v53, v21
    v_mul_f32 v54, v54, v21
    v_mul_f32 v55, v55, v21
    v_cvt_pk_bf16_f32 v28, v52, v53
    v_cvt_pk_bf16_f32 v29, v54, v55
    v_accvgpr_read_b32 v56, a108
    v_accvgpr_read_b32 v57, a109
    v_accvgpr_read_b32 v58, a110
    v_accvgpr_read_b32 v59, a111
    v_mul_f32 v56, v56, v21
    v_mul_f32 v57, v57, v21
    v_mul_f32 v58, v58, v21
    v_mul_f32 v59, v59, v21
    v_cvt_pk_bf16_f32 v30, v56, v57
    v_cvt_pk_bf16_f32 v31, v58, v59
    v_mfma_f32_16x16x32_bf16 v[228:231], a[244:247], a[204:207], v[228:231]
    ds_read_b64_tr_b16 a[226:227], v18 offset:6144
    s_mov_b32 s52, 8192
    v_mfma_f32_16x16x32_bf16 v[232:235], a[248:251], a[184:187], v[232:235]
    ds_read_b64_tr_b16 a[228:229], v18 offset:12288
    buffer_store_dwordx4 v[44:47], v20, s[28:31], s52 offen offset:2048 sc1
    v_mfma_f32_16x16x32_bf16 v[232:235], a[252:255], a[196:199], v[232:235]
    ds_read_b64_tr_b16 a[230:231], v18 offset:18432
    s_mov_b32 s52, 8192
    v_mfma_f32_16x16x32_bf16 v[236:239], a[248:251], a[188:191], v[236:239]
    ds_read_b64_tr_b16 a[232:233], v19 offset:0
    buffer_store_dwordx4 v[48:51], v20, s[28:31], s52 offen offset:3072 sc1
    v_mfma_f32_16x16x32_bf16 v[236:239], a[252:255], a[200:203], v[236:239]
    ds_read_b64_tr_b16 a[234:235], v19 offset:6144
    s_mov_b32 s52, 12288
    v_mfma_f32_16x16x32_bf16 v[240:243], a[248:251], a[192:195], v[240:243]
    ds_read_b64_tr_b16 a[236:237], v19 offset:12288
    buffer_store_dwordx4 v[28:31], v20, s[28:31], s52 offen sc1
    v_mfma_f32_16x16x32_bf16 v[240:243], a[252:255], a[204:207], v[240:243]
    ds_read_b64_tr_b16 a[238:239], v19 offset:18432
    s_waitcnt lgkmcnt(4)
    v_mfma_f32_16x16x32_bf16 v[100:103], a[208:211], a[160:163], v[100:103]
    ds_read_b64_tr_b16 a[240:241], v16 offset:128
    s_mov_b32 m0, s39
    v_mfma_f32_16x16x32_bf16 v[100:103], a[212:215], a[172:175], v[100:103]
    ds_read_b64_tr_b16 a[242:243], v16 offset:6272
    v_accvgpr_read_b32 v60, a100
    v_mfma_f32_16x16x32_bf16 v[104:107], a[208:211], a[164:167], v[104:107]
    ds_read_b64_tr_b16 a[244:245], v16 offset:12416
    v_accvgpr_read_b32 v61, a101
    v_mfma_f32_16x16x32_bf16 v[104:107], a[212:215], a[176:179], v[104:107]
    ds_read_b64_tr_b16 a[246:247], v16 offset:18560
    v_accvgpr_read_b32 v62, a102
    v_mfma_f32_16x16x32_bf16 v[108:111], a[208:211], a[168:171], v[108:111]
    ds_read_b64_tr_b16 a[248:249], v17 offset:128
    v_accvgpr_read_b32 v63, a103
    v_mfma_f32_16x16x32_bf16 v[108:111], a[212:215], a[180:183], v[108:111]
    ds_read_b64_tr_b16 a[250:251], v17 offset:6272
    v_mul_f32 v60, v60, v22
    v_mfma_f32_16x16x32_bf16 v[112:115], a[216:219], a[160:163], v[112:115]
    ds_read_b64_tr_b16 a[252:253], v17 offset:12416
    v_mul_f32 v61, v61, v22
    v_mfma_f32_16x16x32_bf16 v[112:115], a[220:223], a[172:175], v[112:115]
    ds_read_b64_tr_b16 a[254:255], v17 offset:18560
    v_mul_f32 v62, v62, v22
    v_mfma_f32_16x16x32_bf16 v[116:119], a[216:219], a[164:167], v[116:119]
    buffer_load_dwordx4 v247, s[8:11], s32 offen lds
    v_mfma_f32_16x16x32_bf16 v[116:119], a[220:223], a[176:179], v[116:119]
    buffer_load_dwordx4 v248, s[8:11], s32 offen offset:1024 lds
    v_mfma_f32_16x16x32_bf16 v[120:123], a[216:219], a[168:171], v[120:123]
    buffer_load_dwordx4 v249, s[8:11], s32 offen offset:2048 lds
    v_mfma_f32_16x16x32_bf16 v[120:123], a[220:223], a[180:183], v[120:123]
    s_add_u32 s49, s32, 196608
    s_waitcnt lgkmcnt(7)
    v_mfma_f32_16x16x32_bf16 v[124:127], a[224:227], a[160:163], v[124:127]
    ds_read_b64_tr_b16 a[208:209], v18 offset:128
    s_add_u32 m0, s39, 3072
    v_mfma_f32_16x16x32_bf16 v[124:127], a[228:231], a[172:175], v[124:127]
    ds_read_b64_tr_b16 a[210:211], v18 offset:6272
    v_mul_f32 v63, v63, v22
    v_mfma_f32_16x16x32_bf16 v[128:131], a[224:227], a[164:167], v[128:131]
    ds_read_b64_tr_b16 a[212:213], v18 offset:12416
    v_cvt_pk_bf16_f32 v32, v60, v61
    v_mfma_f32_16x16x32_bf16 v[128:131], a[228:231], a[176:179], v[128:131]
    ds_read_b64_tr_b16 a[214:215], v18 offset:18560
    v_cvt_pk_bf16_f32 v33, v62, v63
    v_mfma_f32_16x16x32_bf16 v[132:135], a[224:227], a[168:171], v[132:135]
    ds_read_b64_tr_b16 a[216:217], v19 offset:128
    v_accvgpr_read_b32 v64, a112
    v_mfma_f32_16x16x32_bf16 v[132:135], a[228:231], a[180:183], v[132:135]
    ds_read_b64_tr_b16 a[218:219], v19 offset:6272
    v_accvgpr_read_b32 v65, a113
    v_mfma_f32_16x16x32_bf16 v[136:139], a[232:235], a[160:163], v[136:139]
    ds_read_b64_tr_b16 a[220:221], v19 offset:12416
    v_accvgpr_read_b32 v66, a114
    v_mfma_f32_16x16x32_bf16 v[136:139], a[236:239], a[172:175], v[136:139]
    ds_read_b64_tr_b16 a[222:223], v19 offset:18560
    v_accvgpr_read_b32 v67, a115
    v_mfma_f32_16x16x32_bf16 v[140:143], a[232:235], a[164:167], v[140:143]
    s_cmp_eq_u32 s43, 49152
    s_cselect_b32 s45, s48, s47
    v_mfma_f32_16x16x32_bf16 v[140:143], a[236:239], a[176:179], v[140:143]
    s_add_u32 s43, s43, s45
    v_mul_f32 v64, v64, v22
    v_mfma_f32_16x16x32_bf16 v[144:147], a[232:235], a[168:171], v[144:147]
    buffer_load_dwordx4 v247, s[8:11], s49 offen lds
    v_mfma_f32_16x16x32_bf16 v[144:147], a[236:239], a[180:183], v[144:147]
    v_mul_f32 v65, v65, v22
    s_waitcnt lgkmcnt(7)
    v_mfma_f32_16x16x32_bf16 v[148:151], a[240:243], a[160:163], v[148:151]
    ds_read_b64_tr_b16 a[224:225], v16 offset:256
    v_mul_f32 v66, v66, v22
    v_mfma_f32_16x16x32_bf16 v[148:151], a[244:247], a[172:175], v[148:151]
    ds_read_b64_tr_b16 a[226:227], v16 offset:6400
    v_mul_f32 v67, v67, v22
    v_mfma_f32_16x16x32_bf16 v[152:155], a[240:243], a[164:167], v[152:155]
    ds_read_b64_tr_b16 a[228:229], v16 offset:12544
    v_cvt_pk_bf16_f32 v34, v64, v65
    v_mfma_f32_16x16x32_bf16 v[152:155], a[244:247], a[176:179], v[152:155]
    ds_read_b64_tr_b16 a[230:231], v16 offset:18688
    v_cvt_pk_bf16_f32 v35, v66, v67
    v_mfma_f32_16x16x32_bf16 v[156:159], a[240:243], a[168:171], v[156:159]
    ds_read_b64_tr_b16 a[232:233], v17 offset:256
    v_accvgpr_read_b32 v68, a104
    v_mfma_f32_16x16x32_bf16 v[156:159], a[244:247], a[180:183], v[156:159]
    ds_read_b64_tr_b16 a[234:235], v17 offset:6400
    v_accvgpr_read_b32 v69, a105
    v_mfma_f32_16x16x32_bf16 v[160:163], a[248:251], a[160:163], v[160:163]
    ds_read_b64_tr_b16 a[236:237], v17 offset:12544
    v_accvgpr_read_b32 v70, a106
    v_mfma_f32_16x16x32_bf16 v[160:163], a[252:255], a[172:175], v[160:163]
    ds_read_b64_tr_b16 a[238:239], v17 offset:18688
    v_accvgpr_read_b32 v71, a107
    v_mfma_f32_16x16x32_bf16 v[164:167], a[248:251], a[164:167], v[164:167]
    buffer_load_dwordx4 v248, s[8:11], s49 offen offset:1024 lds
    v_mfma_f32_16x16x32_bf16 v[164:167], a[252:255], a[176:179], v[164:167]
    buffer_load_dwordx4 v249, s[8:11], s49 offen offset:2048 lds
    v_mfma_f32_16x16x32_bf16 v[168:171], a[248:251], a[168:171], v[168:171]
    s_add_u32 s32, s32, 786432
    v_mul_f32 v68, v68, v23
    v_mfma_f32_16x16x32_bf16 v[168:171], a[252:255], a[180:183], v[168:171]
    v_mul_f32 v69, v69, v23
    s_waitcnt lgkmcnt(7)
    v_mfma_f32_16x16x32_bf16 v[172:175], a[208:211], a[160:163], v[172:175]
    ds_read_b64_tr_b16 a[240:241], v18 offset:256
    v_mul_f32 v70, v70, v23
    v_mfma_f32_16x16x32_bf16 v[172:175], a[212:215], a[172:175], v[172:175]
    ds_read_b64_tr_b16 a[242:243], v18 offset:6400
    v_mul_f32 v71, v71, v23
    v_mfma_f32_16x16x32_bf16 v[176:179], a[208:211], a[164:167], v[176:179]
    ds_read_b64_tr_b16 a[244:245], v18 offset:12544
    v_cvt_pk_bf16_f32 v36, v68, v69
    v_mfma_f32_16x16x32_bf16 v[176:179], a[212:215], a[176:179], v[176:179]
    ds_read_b64_tr_b16 a[246:247], v18 offset:18688
    v_cvt_pk_bf16_f32 v37, v70, v71
    v_mfma_f32_16x16x32_bf16 v[180:183], a[208:211], a[168:171], v[180:183]
    ds_read_b64_tr_b16 a[248:249], v19 offset:256
    v_accvgpr_read_b32 v72, a116
    v_mfma_f32_16x16x32_bf16 v[180:183], a[212:215], a[180:183], v[180:183]
    ds_read_b64_tr_b16 a[250:251], v19 offset:6400
    v_accvgpr_read_b32 v73, a117
    v_mfma_f32_16x16x32_bf16 v[184:187], a[216:219], a[160:163], v[184:187]
    ds_read_b64_tr_b16 a[252:253], v19 offset:12544
    v_accvgpr_read_b32 v74, a118
    v_mfma_f32_16x16x32_bf16 v[184:187], a[220:223], a[172:175], v[184:187]
    ds_read_b64_tr_b16 a[254:255], v19 offset:18688
    v_accvgpr_read_b32 v75, a119
    v_mfma_f32_16x16x32_bf16 v[188:191], a[216:219], a[164:167], v[188:191]
    s_cmp_eq_u32 s39, s41
    s_cselect_b32 s51, s48, s47
    v_mfma_f32_16x16x32_bf16 v[188:191], a[220:223], a[176:179], v[188:191]
    s_add_u32 s39, s39, s51
    s_mov_b32 m0, s40
    v_mfma_f32_16x16x32_bf16 v[192:195], a[216:219], a[168:171], v[192:195]
    v_add_u32 v16, s45, v16
    v_add_u32 v17, s45, v17
    v_mfma_f32_16x16x32_bf16 v[192:195], a[220:223], a[180:183], v[192:195]
    v_add_u32 v18, s45, v18
    s_waitcnt lgkmcnt(7)
    v_mfma_f32_16x16x32_bf16 v[196:199], a[224:227], a[160:163], v[196:199]
    v_add_u32 v19, s45, v19
    v_add_u32 v14, s45, v14
    v_mfma_f32_16x16x32_bf16 v[196:199], a[228:231], a[172:175], v[196:199]
    s_waitcnt vmcnt(10) lgkmcnt(0)
    s_barrier
    v_mfma_f32_16x16x32_bf16 v[200:203], a[224:227], a[164:167], v[200:203]
    ds_read_b64_tr_b16 a[208:209], v16 offset:0
    buffer_load_dwordx4 v244, s[12:15], s33 offen lds
    v_mfma_f32_16x16x32_bf16 v[200:203], a[228:231], a[176:179], v[200:203]
    ds_read_b64_tr_b16 a[210:211], v16 offset:6144
    buffer_load_dwordx4 v245, s[12:15], s33 offen offset:1024 lds
    v_mfma_f32_16x16x32_bf16 v[204:207], a[224:227], a[168:171], v[204:207]
    ds_read_b64_tr_b16 a[212:213], v16 offset:12288
    buffer_load_dwordx4 v246, s[12:15], s33 offen offset:2048 lds
    v_mfma_f32_16x16x32_bf16 v[204:207], a[228:231], a[180:183], v[204:207]
    ds_read_b64_tr_b16 a[214:215], v16 offset:18432
    s_add_u32 s50, s33, 64
    v_mfma_f32_16x16x32_bf16 v[208:211], a[232:235], a[160:163], v[208:211]
    ds_read_b64_tr_b16 a[216:217], v17 offset:0
    s_add_u32 m0, s40, 3072
    v_mfma_f32_16x16x32_bf16 v[208:211], a[236:239], a[172:175], v[208:211]
    ds_read_b64_tr_b16 a[218:219], v17 offset:6144
    buffer_load_dwordx4 v244, s[12:15], s50 offen lds
    v_mfma_f32_16x16x32_bf16 v[212:215], a[232:235], a[164:167], v[212:215]
    ds_read_b64_tr_b16 a[220:221], v17 offset:12288
    buffer_load_dwordx4 v245, s[12:15], s50 offen offset:1024 lds
    v_mfma_f32_16x16x32_bf16 v[212:215], a[236:239], a[176:179], v[212:215]
    ds_read_b64_tr_b16 a[222:223], v17 offset:18432
    buffer_load_dwordx4 v246, s[12:15], s50 offen offset:2048 lds
    v_mfma_f32_16x16x32_bf16 v[216:219], a[232:235], a[168:171], v[216:219]
    ds_read_b128 a[184:187], v14 offset:0
    s_add_u32 s33, s33, 128
    v_mfma_f32_16x16x32_bf16 v[216:219], a[236:239], a[180:183], v[216:219]
    ds_read_b128 a[188:191], v14 offset:1024
    s_cmp_eq_u32 s40, s42
    s_cselect_b32 s51, s48, s47
    v_mfma_f32_16x16x32_bf16 v[220:223], a[240:243], a[160:163], v[220:223]
    ds_read_b128 a[192:195], v14 offset:2048
    s_add_u32 s40, s40, s51
    v_mfma_f32_16x16x32_bf16 v[220:223], a[244:247], a[172:175], v[220:223]
    ds_read_b128 a[196:199], v14 offset:3072
    v_mul_f32 v72, v72, v23
    v_mfma_f32_16x16x32_bf16 v[224:227], a[240:243], a[164:167], v[224:227]
    ds_read_b128 a[200:203], v14 offset:4096
    v_mul_f32 v73, v73, v23
    v_mfma_f32_16x16x32_bf16 v[224:227], a[244:247], a[176:179], v[224:227]
    ds_read_b128 a[204:207], v14 offset:5120
    s_waitcnt lgkmcnt(7)
    v_mfma_f32_16x16x32_bf16 v[228:231], a[240:243], a[168:171], v[228:231]
    ds_read_b64_tr_b16 a[224:225], v18 offset:0
    v_mul_f32 v74, v74, v23
    v_mul_f32 v75, v75, v23
    v_cvt_pk_bf16_f32 v38, v72, v73
    v_cvt_pk_bf16_f32 v39, v74, v75
    v_accvgpr_read_b32 v52, a120
    v_accvgpr_read_b32 v53, a121
    v_accvgpr_read_b32 v54, a122
    v_accvgpr_read_b32 v55, a123
    v_mul_f32 v52, v52, v21
    v_mul_f32 v53, v53, v21
    v_mul_f32 v54, v54, v21
    v_mul_f32 v55, v55, v21
    v_cvt_pk_bf16_f32 v40, v52, v53
    v_cvt_pk_bf16_f32 v41, v54, v55
    v_accvgpr_read_b32 v56, a132
    v_accvgpr_read_b32 v57, a133
    v_accvgpr_read_b32 v58, a134
    v_accvgpr_read_b32 v59, a135
    v_mul_f32 v56, v56, v21
    v_mul_f32 v57, v57, v21
    v_mul_f32 v58, v58, v21
    v_mul_f32 v59, v59, v21
    v_cvt_pk_bf16_f32 v42, v56, v57
    v_cvt_pk_bf16_f32 v43, v58, v59
    v_mfma_f32_16x16x32_bf16 v[228:231], a[244:247], a[180:183], v[228:231]
    ds_read_b64_tr_b16 a[226:227], v18 offset:6144
    s_mov_b32 s52, 12288
    v_mfma_f32_16x16x32_bf16 v[232:235], a[248:251], a[160:163], v[232:235]
    ds_read_b64_tr_b16 a[228:229], v18 offset:12288
    buffer_store_dwordx4 v[32:35], v20, s[28:31], s52 offen offset:1024 sc1
    v_mfma_f32_16x16x32_bf16 v[232:235], a[252:255], a[172:175], v[232:235]
    ds_read_b64_tr_b16 a[230:231], v18 offset:18432
    s_mov_b32 s52, 12288
    v_mfma_f32_16x16x32_bf16 v[236:239], a[248:251], a[164:167], v[236:239]
    ds_read_b64_tr_b16 a[232:233], v19 offset:0
    buffer_store_dwordx4 v[36:39], v20, s[28:31], s52 offen offset:2048 sc1
    v_mfma_f32_16x16x32_bf16 v[236:239], a[252:255], a[176:179], v[236:239]
    ds_read_b64_tr_b16 a[234:235], v19 offset:6144
    s_mov_b32 s52, 12288
    v_mfma_f32_16x16x32_bf16 v[240:243], a[248:251], a[168:171], v[240:243]
    ds_read_b64_tr_b16 a[236:237], v19 offset:12288
    buffer_store_dwordx4 v[40:43], v20, s[28:31], s52 offen offset:3072 sc1
    v_mfma_f32_16x16x32_bf16 v[240:243], a[252:255], a[180:183], v[240:243]
    ds_read_b64_tr_b16 a[238:239], v19 offset:18432
    s_waitcnt lgkmcnt(4)
    v_mfma_f32_16x16x32_bf16 v[100:103], a[208:211], a[184:187], v[100:103]
    ds_read_b64_tr_b16 a[240:241], v16 offset:128
    s_mov_b32 m0, s39
    v_mfma_f32_16x16x32_bf16 v[100:103], a[212:215], a[196:199], v[100:103]
    ds_read_b64_tr_b16 a[242:243], v16 offset:6272
    v_accvgpr_read_b32 v60, a124
    v_mfma_f32_16x16x32_bf16 v[104:107], a[208:211], a[188:191], v[104:107]
    ds_read_b64_tr_b16 a[244:245], v16 offset:12416
    v_accvgpr_read_b32 v61, a125
    v_mfma_f32_16x16x32_bf16 v[104:107], a[212:215], a[200:203], v[104:107]
    ds_read_b64_tr_b16 a[246:247], v16 offset:18560
    v_accvgpr_read_b32 v62, a126
    v_mfma_f32_16x16x32_bf16 v[108:111], a[208:211], a[192:195], v[108:111]
    ds_read_b64_tr_b16 a[248:249], v17 offset:128
    v_accvgpr_read_b32 v63, a127
    v_mfma_f32_16x16x32_bf16 v[108:111], a[212:215], a[204:207], v[108:111]
    ds_read_b64_tr_b16 a[250:251], v17 offset:6272
    v_mul_f32 v60, v60, v22
    v_mfma_f32_16x16x32_bf16 v[112:115], a[216:219], a[184:187], v[112:115]
    ds_read_b64_tr_b16 a[252:253], v17 offset:12416
    v_mul_f32 v61, v61, v22
    v_mfma_f32_16x16x32_bf16 v[112:115], a[220:223], a[196:199], v[112:115]
    ds_read_b64_tr_b16 a[254:255], v17 offset:18560
    v_mul_f32 v62, v62, v22
    v_mfma_f32_16x16x32_bf16 v[116:119], a[216:219], a[188:191], v[116:119]
    buffer_load_dwordx4 v247, s[8:11], s32 offen lds
    v_mfma_f32_16x16x32_bf16 v[116:119], a[220:223], a[200:203], v[116:119]
    buffer_load_dwordx4 v248, s[8:11], s32 offen offset:1024 lds
    v_mfma_f32_16x16x32_bf16 v[120:123], a[216:219], a[192:195], v[120:123]
    buffer_load_dwordx4 v249, s[8:11], s32 offen offset:2048 lds
    v_mfma_f32_16x16x32_bf16 v[120:123], a[220:223], a[204:207], v[120:123]
    s_add_u32 s49, s32, 196608
    s_waitcnt lgkmcnt(7)
    v_mfma_f32_16x16x32_bf16 v[124:127], a[224:227], a[184:187], v[124:127]
    ds_read_b64_tr_b16 a[208:209], v18 offset:128
    s_add_u32 m0, s39, 3072
    v_mfma_f32_16x16x32_bf16 v[124:127], a[228:231], a[196:199], v[124:127]
    ds_read_b64_tr_b16 a[210:211], v18 offset:6272
    v_mul_f32 v63, v63, v22
    v_mfma_f32_16x16x32_bf16 v[128:131], a[224:227], a[188:191], v[128:131]
    ds_read_b64_tr_b16 a[212:213], v18 offset:12416
    v_cvt_pk_bf16_f32 v44, v60, v61
    v_mfma_f32_16x16x32_bf16 v[128:131], a[228:231], a[200:203], v[128:131]
    ds_read_b64_tr_b16 a[214:215], v18 offset:18560
    v_cvt_pk_bf16_f32 v45, v62, v63
    v_mfma_f32_16x16x32_bf16 v[132:135], a[224:227], a[192:195], v[132:135]
    ds_read_b64_tr_b16 a[216:217], v19 offset:128
    v_accvgpr_read_b32 v64, a136
    v_mfma_f32_16x16x32_bf16 v[132:135], a[228:231], a[204:207], v[132:135]
    ds_read_b64_tr_b16 a[218:219], v19 offset:6272
    v_accvgpr_read_b32 v65, a137
    v_mfma_f32_16x16x32_bf16 v[136:139], a[232:235], a[184:187], v[136:139]
    ds_read_b64_tr_b16 a[220:221], v19 offset:12416
    v_accvgpr_read_b32 v66, a138
    v_mfma_f32_16x16x32_bf16 v[136:139], a[236:239], a[196:199], v[136:139]
    ds_read_b64_tr_b16 a[222:223], v19 offset:18560
    v_accvgpr_read_b32 v67, a139
    v_mfma_f32_16x16x32_bf16 v[140:143], a[232:235], a[188:191], v[140:143]
    s_cmp_eq_u32 s43, 49152
    s_cselect_b32 s45, s48, s47
    v_mfma_f32_16x16x32_bf16 v[140:143], a[236:239], a[200:203], v[140:143]
    s_add_u32 s43, s43, s45
    v_mul_f32 v64, v64, v22
    v_mfma_f32_16x16x32_bf16 v[144:147], a[232:235], a[192:195], v[144:147]
    buffer_load_dwordx4 v247, s[8:11], s49 offen lds
    v_mfma_f32_16x16x32_bf16 v[144:147], a[236:239], a[204:207], v[144:147]
    v_mul_f32 v65, v65, v22
    s_waitcnt lgkmcnt(7)
    v_mfma_f32_16x16x32_bf16 v[148:151], a[240:243], a[184:187], v[148:151]
    ds_read_b64_tr_b16 a[224:225], v16 offset:256
    v_mul_f32 v66, v66, v22
    v_mfma_f32_16x16x32_bf16 v[148:151], a[244:247], a[196:199], v[148:151]
    ds_read_b64_tr_b16 a[226:227], v16 offset:6400
    v_mul_f32 v67, v67, v22
    v_mfma_f32_16x16x32_bf16 v[152:155], a[240:243], a[188:191], v[152:155]
    ds_read_b64_tr_b16 a[228:229], v16 offset:12544
    v_cvt_pk_bf16_f32 v46, v64, v65
    v_mfma_f32_16x16x32_bf16 v[152:155], a[244:247], a[200:203], v[152:155]
    ds_read_b64_tr_b16 a[230:231], v16 offset:18688
    v_cvt_pk_bf16_f32 v47, v66, v67
    v_mfma_f32_16x16x32_bf16 v[156:159], a[240:243], a[192:195], v[156:159]
    ds_read_b64_tr_b16 a[232:233], v17 offset:256
    v_accvgpr_read_b32 v68, a128
    v_mfma_f32_16x16x32_bf16 v[156:159], a[244:247], a[204:207], v[156:159]
    ds_read_b64_tr_b16 a[234:235], v17 offset:6400
    v_accvgpr_read_b32 v69, a129
    v_mfma_f32_16x16x32_bf16 v[160:163], a[248:251], a[184:187], v[160:163]
    ds_read_b64_tr_b16 a[236:237], v17 offset:12544
    v_accvgpr_read_b32 v70, a130
    v_mfma_f32_16x16x32_bf16 v[160:163], a[252:255], a[196:199], v[160:163]
    ds_read_b64_tr_b16 a[238:239], v17 offset:18688
    v_accvgpr_read_b32 v71, a131
    v_mfma_f32_16x16x32_bf16 v[164:167], a[248:251], a[188:191], v[164:167]
    buffer_load_dwordx4 v248, s[8:11], s49 offen offset:1024 lds
    v_mfma_f32_16x16x32_bf16 v[164:167], a[252:255], a[200:203], v[164:167]
    buffer_load_dwordx4 v249, s[8:11], s49 offen offset:2048 lds
    v_mfma_f32_16x16x32_bf16 v[168:171], a[248:251], a[192:195], v[168:171]
    s_add_u32 s32, s32, 786432
    v_mul_f32 v68, v68, v23
    v_mfma_f32_16x16x32_bf16 v[168:171], a[252:255], a[204:207], v[168:171]
    v_mul_f32 v69, v69, v23
    s_waitcnt lgkmcnt(7)
    v_mfma_f32_16x16x32_bf16 v[172:175], a[208:211], a[184:187], v[172:175]
    ds_read_b64_tr_b16 a[240:241], v18 offset:256
    v_mul_f32 v70, v70, v23
    v_mfma_f32_16x16x32_bf16 v[172:175], a[212:215], a[196:199], v[172:175]
    ds_read_b64_tr_b16 a[242:243], v18 offset:6400
    v_mul_f32 v71, v71, v23
    v_mfma_f32_16x16x32_bf16 v[176:179], a[208:211], a[188:191], v[176:179]
    ds_read_b64_tr_b16 a[244:245], v18 offset:12544
    v_cvt_pk_bf16_f32 v48, v68, v69
    v_mfma_f32_16x16x32_bf16 v[176:179], a[212:215], a[200:203], v[176:179]
    ds_read_b64_tr_b16 a[246:247], v18 offset:18688
    v_cvt_pk_bf16_f32 v49, v70, v71
    v_mfma_f32_16x16x32_bf16 v[180:183], a[208:211], a[192:195], v[180:183]
    ds_read_b64_tr_b16 a[248:249], v19 offset:256
    v_accvgpr_read_b32 v72, a140
    v_mfma_f32_16x16x32_bf16 v[180:183], a[212:215], a[204:207], v[180:183]
    ds_read_b64_tr_b16 a[250:251], v19 offset:6400
    v_accvgpr_read_b32 v73, a141
    v_mfma_f32_16x16x32_bf16 v[184:187], a[216:219], a[184:187], v[184:187]
    ds_read_b64_tr_b16 a[252:253], v19 offset:12544
    v_accvgpr_read_b32 v74, a142
    v_mfma_f32_16x16x32_bf16 v[184:187], a[220:223], a[196:199], v[184:187]
    ds_read_b64_tr_b16 a[254:255], v19 offset:18688
    v_accvgpr_read_b32 v75, a143
    v_mfma_f32_16x16x32_bf16 v[188:191], a[216:219], a[188:191], v[188:191]
    s_cmp_eq_u32 s39, s41
    s_cselect_b32 s51, s48, s47
    v_mfma_f32_16x16x32_bf16 v[188:191], a[220:223], a[200:203], v[188:191]
    s_add_u32 s39, s39, s51
    s_mov_b32 m0, s40
    v_mfma_f32_16x16x32_bf16 v[192:195], a[216:219], a[192:195], v[192:195]
    v_add_u32 v16, s45, v16
    v_add_u32 v17, s45, v17
    v_mfma_f32_16x16x32_bf16 v[192:195], a[220:223], a[204:207], v[192:195]
    v_add_u32 v18, s45, v18
    s_waitcnt lgkmcnt(7)
    v_mfma_f32_16x16x32_bf16 v[196:199], a[224:227], a[184:187], v[196:199]
    v_add_u32 v19, s45, v19
    v_add_u32 v14, s45, v14
    v_mfma_f32_16x16x32_bf16 v[196:199], a[228:231], a[196:199], v[196:199]
    s_waitcnt vmcnt(9) lgkmcnt(0)
    s_barrier
    v_mfma_f32_16x16x32_bf16 v[200:203], a[224:227], a[188:191], v[200:203]
    ds_read_b64_tr_b16 a[208:209], v16 offset:0
    buffer_load_dwordx4 v244, s[12:15], s33 offen lds
    v_mfma_f32_16x16x32_bf16 v[200:203], a[228:231], a[200:203], v[200:203]
    ds_read_b64_tr_b16 a[210:211], v16 offset:6144
    buffer_load_dwordx4 v245, s[12:15], s33 offen offset:1024 lds
    v_mfma_f32_16x16x32_bf16 v[204:207], a[224:227], a[192:195], v[204:207]
    ds_read_b64_tr_b16 a[212:213], v16 offset:12288
    buffer_load_dwordx4 v246, s[12:15], s33 offen offset:2048 lds
    v_mfma_f32_16x16x32_bf16 v[204:207], a[228:231], a[204:207], v[204:207]
    ds_read_b64_tr_b16 a[214:215], v16 offset:18432
    s_add_u32 s50, s33, 64
    v_mfma_f32_16x16x32_bf16 v[208:211], a[232:235], a[184:187], v[208:211]
    ds_read_b64_tr_b16 a[216:217], v17 offset:0
    s_add_u32 m0, s40, 3072
    v_mfma_f32_16x16x32_bf16 v[208:211], a[236:239], a[196:199], v[208:211]
    ds_read_b64_tr_b16 a[218:219], v17 offset:6144
    buffer_load_dwordx4 v244, s[12:15], s50 offen lds
    v_mfma_f32_16x16x32_bf16 v[212:215], a[232:235], a[188:191], v[212:215]
    ds_read_b64_tr_b16 a[220:221], v17 offset:12288
    buffer_load_dwordx4 v245, s[12:15], s50 offen offset:1024 lds
    v_mfma_f32_16x16x32_bf16 v[212:215], a[236:239], a[200:203], v[212:215]
    ds_read_b64_tr_b16 a[222:223], v17 offset:18432
    buffer_load_dwordx4 v246, s[12:15], s50 offen offset:2048 lds
    v_mfma_f32_16x16x32_bf16 v[216:219], a[232:235], a[192:195], v[216:219]
    ds_read_b128 a[160:163], v14 offset:0
    s_add_u32 s33, s33, 128
    v_mfma_f32_16x16x32_bf16 v[216:219], a[236:239], a[204:207], v[216:219]
    ds_read_b128 a[164:167], v14 offset:1024
    s_cmp_eq_u32 s40, s42
    s_cselect_b32 s51, s48, s47
    v_mfma_f32_16x16x32_bf16 v[220:223], a[240:243], a[184:187], v[220:223]
    ds_read_b128 a[168:171], v14 offset:2048
    s_add_u32 s40, s40, s51
    v_mfma_f32_16x16x32_bf16 v[220:223], a[244:247], a[196:199], v[220:223]
    ds_read_b128 a[172:175], v14 offset:3072
    v_mul_f32 v72, v72, v23
    v_mfma_f32_16x16x32_bf16 v[224:227], a[240:243], a[188:191], v[224:227]
    ds_read_b128 a[176:179], v14 offset:4096
    v_mul_f32 v73, v73, v23
    v_mfma_f32_16x16x32_bf16 v[224:227], a[244:247], a[200:203], v[224:227]
    ds_read_b128 a[180:183], v14 offset:5120
    s_waitcnt lgkmcnt(7)
    v_mfma_f32_16x16x32_bf16 v[228:231], a[240:243], a[192:195], v[228:231]
    ds_read_b64_tr_b16 a[224:225], v18 offset:0
    v_mul_f32 v74, v74, v23
    v_mul_f32 v75, v75, v23
    v_cvt_pk_bf16_f32 v50, v72, v73
    v_cvt_pk_bf16_f32 v51, v74, v75
    v_mfma_f32_16x16x32_bf16 v[228:231], a[244:247], a[204:207], v[228:231]
    ds_read_b64_tr_b16 a[226:227], v18 offset:6144
    s_mov_b32 s52, 16384
    v_mfma_f32_16x16x32_bf16 v[232:235], a[248:251], a[184:187], v[232:235]
    ds_read_b64_tr_b16 a[228:229], v18 offset:12288
    buffer_store_dwordx4 v[44:47], v20, s[28:31], s52 offen sc1
    v_mfma_f32_16x16x32_bf16 v[232:235], a[252:255], a[196:199], v[232:235]
    ds_read_b64_tr_b16 a[230:231], v18 offset:18432
    s_mov_b32 s52, 16384
    v_mfma_f32_16x16x32_bf16 v[236:239], a[248:251], a[188:191], v[236:239]
    ds_read_b64_tr_b16 a[232:233], v19 offset:0
    buffer_store_dwordx4 v[48:51], v20, s[28:31], s52 offen offset:1024 sc1
    v_mfma_f32_16x16x32_bf16 v[236:239], a[252:255], a[200:203], v[236:239]
    ds_read_b64_tr_b16 a[234:235], v19 offset:6144
    v_mfma_f32_16x16x32_bf16 v[240:243], a[248:251], a[192:195], v[240:243]
    ds_read_b64_tr_b16 a[236:237], v19 offset:12288
    v_mfma_f32_16x16x32_bf16 v[240:243], a[252:255], a[204:207], v[240:243]
    ds_read_b64_tr_b16 a[238:239], v19 offset:18432
    s_cmp_eq_u32 s54, 0
    s_cbranch_scc1 K1_pq0
    s_cmp_lg_u64 s[60:61], 0
    s_cselect_b32 s49, 1, 0
    s_or_b32 s55, s55, s49
    s_mov_b64 s[60:61], 0
    s_mul_i32 s49, s92, 18432
    s_add_u32 s28, s90, s49
    s_addc_u32 s29, s91, 0
    s_and_b32 s29, s29, 65535
    s_mov_b32 s30, 1787904
    s_branch K1_pq1
K1_pq0:
    s_mov_b64 s[60:61], 0
    s_lshl_b32 s49, s2, 8
    v_mov_b32 v2, 0
    buffer_store_dword v2, v2, s[96:99], s49 offen sc1
    s_mul_i32 s49, s92, 18432
    s_add_u32 s28, s90, s49
    s_addc_u32 s29, s91, 0
    s_and_b32 s29, s29, 65535
    s_mov_b32 s30, 1787904
K1_pq1:
    s_cmp_eq_u32 s56, 0
    s_cbranch_scc1 K1_pq2
    s_sub_u32 s49, s92, s82
    s_lshr_b32 s49, s49, 2
    s_lshl_b32 s49, 1, s49
    s_and_b32 s49, s49, s80
    s_cselect_b32 s30, 0, s30
K1_pq2:
    s_waitcnt lgkmcnt(4)
    v_mfma_f32_16x16x32_bf16 v[100:103], a[208:211], a[160:163], v[100:103]
    ds_read_b64_tr_b16 a[240:241], v16 offset:128
    s_mov_b32 m0, s39
    v_mfma_f32_16x16x32_bf16 v[100:103], a[212:215], a[172:175], v[100:103]
    ds_read_b64_tr_b16 a[242:243], v16 offset:6272
    v_accvgpr_write_b32 a0, 0
    v_mfma_f32_16x16x32_bf16 v[104:107], a[208:211], a[164:167], v[104:107]
    ds_read_b64_tr_b16 a[244:245], v16 offset:12416
    v_accvgpr_write_b32 a1, 0
    v_mfma_f32_16x16x32_bf16 v[104:107], a[212:215], a[176:179], v[104:107]
    ds_read_b64_tr_b16 a[246:247], v16 offset:18560
    v_accvgpr_write_b32 a2, 0
    v_mfma_f32_16x16x32_bf16 v[108:111], a[208:211], a[168:171], v[108:111]
    ds_read_b64_tr_b16 a[248:249], v17 offset:128
    v_accvgpr_write_b32 a3, 0
    v_mfma_f32_16x16x32_bf16 v[108:111], a[212:215], a[180:183], v[108:111]
    ds_read_b64_tr_b16 a[250:251], v17 offset:6272
    v_accvgpr_write_b32 a4, 0
    v_mfma_f32_16x16x32_bf16 v[112:115], a[216:219], a[160:163], v[112:115]
    ds_read_b64_tr_b16 a[252:253], v17 offset:12416
    v_accvgpr_write_b32 a5, 0
    v_mfma_f32_16x16x32_bf16 v[112:115], a[220:223], a[172:175], v[112:115]
    ds_read_b64_tr_b16 a[254:255], v17 offset:18560
    v_accvgpr_write_b32 a6, 0
    v_mfma_f32_16x16x32_bf16 v[116:119], a[216:219], a[164:167], v[116:119]
    buffer_load_dwordx4 v8, s[16:19], s34 offen nt lds
    v_mfma_f32_16x16x32_bf16 v[116:119], a[220:223], a[176:179], v[116:119]
    v_accvgpr_write_b32 a7, 0
    v_accvgpr_write_b32 a8, 0
    v_mfma_f32_16x16x32_bf16 v[120:123], a[216:219], a[168:171], v[120:123]
    buffer_load_dwordx4 v9, s[16:19], s34 offen offset:1024 nt lds
    v_mfma_f32_16x16x32_bf16 v[120:123], a[220:223], a[180:183], v[120:123]
    v_accvgpr_write_b32 a9, 0
    s_waitcnt lgkmcnt(7)
    v_mfma_f32_16x16x32_bf16 v[124:127], a[224:227], a[160:163], v[124:127]
    ds_read_b64_tr_b16 a[208:209], v18 offset:128
    v_accvgpr_write_b32 a10, 0
    v_mfma_f32_16x16x32_bf16 v[124:127], a[228:231], a[172:175], v[124:127]
    ds_read_b64_tr_b16 a[210:211], v18 offset:6272
    v_accvgpr_write_b32 a11, 0
    v_mfma_f32_16x16x32_bf16 v[128:131], a[224:227], a[164:167], v[128:131]
    ds_read_b64_tr_b16 a[212:213], v18 offset:12416
    v_accvgpr_write_b32 a12, 0
    v_mfma_f32_16x16x32_bf16 v[128:131], a[228:231], a[176:179], v[128:131]
    ds_read_b64_tr_b16 a[214:215], v18 offset:18560
    v_accvgpr_write_b32 a13, 0
    v_mfma_f32_16x16x32_bf16 v[132:135], a[224:227], a[168:171], v[132:135]
    ds_read_b64_tr_b16 a[216:217], v19 offset:128
    v_accvgpr_write_b32 a14, 0
    v_mfma_f32_16x16x32_bf16 v[132:135], a[228:231], a[180:183], v[132:135]
    ds_read_b64_tr_b16 a[218:219], v19 offset:6272
    v_accvgpr_write_b32 a15, 0
    v_mfma_f32_16x16x32_bf16 v[136:139], a[232:235], a[160:163], v[136:139]
    ds_read_b64_tr_b16 a[220:221], v19 offset:12416
    v_accvgpr_write_b32 a16, 0
    v_mfma_f32_16x16x32_bf16 v[136:139], a[236:239], a[172:175], v[136:139]
    ds_read_b64_tr_b16 a[222:223], v19 offset:18560
    v_accvgpr_write_b32 a17, 0
    v_mfma_f32_16x16x32_bf16 v[140:143], a[232:235], a[164:167], v[140:143]
    s_cmp_eq_u32 s43, 49152
    s_cselect_b32 s45, s48, s47
    v_mfma_f32_16x16x32_bf16 v[140:143], a[236:239], a[176:179], v[140:143]
    s_add_u32 s43, s43, s45
    v_accvgpr_write_b32 a18, 0
    v_mfma_f32_16x16x32_bf16 v[144:147], a[232:235], a[168:171], v[144:147]
    buffer_load_dwordx4 v10, s[16:19], s34 offen offset:2048 nt lds
    v_mfma_f32_16x16x32_bf16 v[144:147], a[236:239], a[180:183], v[144:147]
    s_add_u32 s49, s34, 3072
    s_waitcnt lgkmcnt(7)
    v_mfma_f32_16x16x32_bf16 v[148:151], a[240:243], a[160:163], v[148:151]
    ds_read_b64_tr_b16 a[224:225], v16 offset:256
    v_accvgpr_write_b32 a19, 0
    v_mfma_f32_16x16x32_bf16 v[148:151], a[244:247], a[172:175], v[148:151]
    ds_read_b64_tr_b16 a[226:227], v16 offset:6400
    s_add_u32 m0, s39, 3072
    v_mfma_f32_16x16x32_bf16 v[152:155], a[240:243], a[164:167], v[152:155]
    ds_read_b64_tr_b16 a[228:229], v16 offset:12544
    v_accvgpr_write_b32 a20, 0
    v_mfma_f32_16x16x32_bf16 v[152:155], a[244:247], a[176:179], v[152:155]
    ds_read_b64_tr_b16 a[230:231], v16 offset:18688
    v_accvgpr_write_b32 a21, 0
    v_mfma_f32_16x16x32_bf16 v[156:159], a[240:243], a[168:171], v[156:159]
    ds_read_b64_tr_b16 a[232:233], v17 offset:256
    v_accvgpr_write_b32 a22, 0
    v_mfma_f32_16x16x32_bf16 v[156:159], a[244:247], a[180:183], v[156:159]
    ds_read_b64_tr_b16 a[234:235], v17 offset:6400
    v_accvgpr_write_b32 a23, 0
    v_mfma_f32_16x16x32_bf16 v[160:163], a[248:251], a[160:163], v[160:163]
    ds_read_b64_tr_b16 a[236:237], v17 offset:12544
    v_accvgpr_write_b32 a24, 0
    v_mfma_f32_16x16x32_bf16 v[160:163], a[252:255], a[172:175], v[160:163]
    ds_read_b64_tr_b16 a[238:239], v17 offset:18688
    v_accvgpr_write_b32 a25, 0
    v_mfma_f32_16x16x32_bf16 v[164:167], a[248:251], a[164:167], v[164:167]
    buffer_load_dwordx4 v8, s[16:19], s49 offen nt lds
    v_mfma_f32_16x16x32_bf16 v[164:167], a[252:255], a[176:179], v[164:167]
    v_accvgpr_write_b32 a26, 0
    v_accvgpr_write_b32 a27, 0
    v_mfma_f32_16x16x32_bf16 v[168:171], a[248:251], a[168:171], v[168:171]
    v_accvgpr_write_b32 a28, 0
    v_accvgpr_write_b32 a29, 0
    v_mfma_f32_16x16x32_bf16 v[168:171], a[252:255], a[180:183], v[168:171]
    v_accvgpr_write_b32 a30, 0
    s_waitcnt lgkmcnt(7)
    v_mfma_f32_16x16x32_bf16 v[172:175], a[208:211], a[160:163], v[172:175]
    ds_read_b64_tr_b16 a[240:241], v18 offset:256
    v_accvgpr_write_b32 a31, 0
    v_mfma_f32_16x16x32_bf16 v[172:175], a[212:215], a[172:175], v[172:175]
    ds_read_b64_tr_b16 a[242:243], v18 offset:6400
    v_accvgpr_write_b32 a32, 0
    v_mfma_f32_16x16x32_bf16 v[176:179], a[208:211], a[164:167], v[176:179]
    ds_read_b64_tr_b16 a[244:245], v18 offset:12544
    v_accvgpr_write_b32 a33, 0
    v_mfma_f32_16x16x32_bf16 v[176:179], a[212:215], a[176:179], v[176:179]
    ds_read_b64_tr_b16 a[246:247], v18 offset:18688
    v_accvgpr_write_b32 a34, 0
    v_mfma_f32_16x16x32_bf16 v[180:183], a[208:211], a[168:171], v[180:183]
    ds_read_b64_tr_b16 a[248:249], v19 offset:256
    v_accvgpr_write_b32 a35, 0
    v_mfma_f32_16x16x32_bf16 v[180:183], a[212:215], a[180:183], v[180:183]
    ds_read_b64_tr_b16 a[250:251], v19 offset:6400
    v_accvgpr_write_b32 a36, 0
    v_mfma_f32_16x16x32_bf16 v[184:187], a[216:219], a[160:163], v[184:187]
    ds_read_b64_tr_b16 a[252:253], v19 offset:12544
    v_accvgpr_write_b32 a37, 0
    v_mfma_f32_16x16x32_bf16 v[184:187], a[220:223], a[172:175], v[184:187]
    ds_read_b64_tr_b16 a[254:255], v19 offset:18688
    v_accvgpr_write_b32 a38, 0
    v_mfma_f32_16x16x32_bf16 v[188:191], a[216:219], a[164:167], v[188:191]
    buffer_load_dwordx4 v9, s[16:19], s49 offen offset:1024 nt lds
    v_mfma_f32_16x16x32_bf16 v[188:191], a[220:223], a[176:179], v[188:191]
    buffer_load_dwordx4 v10, s[16:19], s49 offen offset:2048 nt lds
    v_mfma_f32_16x16x32_bf16 v[192:195], a[216:219], a[168:171], v[192:195]
    v_add_u32 v16, s45, v16
    v_add_u32 v17, s45, v17
    v_mfma_f32_16x16x32_bf16 v[192:195], a[220:223], a[180:183], v[192:195]
    v_add_u32 v18, s45, v18
    s_waitcnt lgkmcnt(7)
    v_mfma_f32_16x16x32_bf16 v[196:199], a[224:227], a[160:163], v[196:199]
    v_add_u32 v19, s45, v19
    v_add_u32 v14, s45, v14
    v_mfma_f32_16x16x32_bf16 v[196:199], a[228:231], a[172:175], v[196:199]
    s_waitcnt vmcnt(8) lgkmcnt(0)
    s_barrier
    v_mfma_f32_16x16x32_bf16 v[200:203], a[224:227], a[164:167], v[200:203]
    ds_read_b64_tr_b16 a[208:209], v16 offset:0
    s_add_u32 s34, s34, 24576
    v_mfma_f32_16x16x32_bf16 v[200:203], a[228:231], a[176:179], v[200:203]
    ds_read_b64_tr_b16 a[210:211], v16 offset:6144
    s_cmp_eq_u32 s39, s41
    s_cselect_b32 s51, s48, s47
    v_mfma_f32_16x16x32_bf16 v[204:207], a[224:227], a[168:171], v[204:207]
    ds_read_b64_tr_b16 a[212:213], v16 offset:12288
    s_add_u32 s39, s39, s51
    v_mfma_f32_16x16x32_bf16 v[204:207], a[228:231], a[180:183], v[204:207]
    ds_read_b64_tr_b16 a[214:215], v16 offset:18432
    v_accvgpr_write_b32 a39, 0
    v_mfma_f32_16x16x32_bf16 v[208:211], a[232:235], a[160:163], v[208:211]
    ds_read_b64_tr_b16 a[216:217], v17 offset:0
    v_mfma_f32_16x16x32_bf16 v[208:211], a[236:239], a[172:175], v[208:211]
    ds_read_b64_tr_b16 a[218:219], v17 offset:6144
    v_mfma_f32_16x16x32_bf16 v[212:215], a[232:235], a[164:167], v[212:215]
    ds_read_b64_tr_b16 a[220:221], v17 offset:12288
    v_mfma_f32_16x16x32_bf16 v[212:215], a[236:239], a[176:179], v[212:215]
    ds_read_b64_tr_b16 a[222:223], v17 offset:18432
    v_mfma_f32_16x16x32_bf16 v[216:219], a[232:235], a[168:171], v[216:219]
    ds_read_b128 a[184:187], v14 offset:0
    v_mfma_f32_16x16x32_bf16 v[216:219], a[236:239], a[180:183], v[216:219]
    ds_read_b128 a[188:191], v14 offset:1024
    v_mfma_f32_16x16x32_bf16 v[220:223], a[240:243], a[160:163], v[220:223]
    ds_read_b128 a[192:195], v14 offset:2048
    v_mfma_f32_16x16x32_bf16 v[220:223], a[244:247], a[172:175], v[220:223]
    ds_read_b128 a[196:199], v14 offset:3072
    v_mfma_f32_16x16x32_bf16 v[224:227], a[240:243], a[164:167], v[224:227]
    ds_read_b128 a[200:203], v14 offset:4096
    v_mfma_f32_16x16x32_bf16 v[224:227], a[244:247], a[176:179], v[224:227]
    ds_read_b128 a[204:207], v14 offset:5120
    s_waitcnt lgkmcnt(7)
    v_mfma_f32_16x16x32_bf16 v[228:231], a[240:243], a[168:171], v[228:231]
    ds_read_b64_tr_b16 a[224:225], v18 offset:0
    v_mfma_f32_16x16x32_bf16 v[228:231], a[244:247], a[180:183], v[228:231]
    ds_read_b64_tr_b16 a[226:227], v18 offset:6144
    v_mfma_f32_16x16x32_bf16 v[232:235], a[248:251], a[160:163], v[232:235]
    ds_read_b64_tr_b16 a[228:229], v18 offset:12288
    v_mfma_f32_16x16x32_bf16 v[232:235], a[252:255], a[172:175], v[232:235]
    ds_read_b64_tr_b16 a[230:231], v18 offset:18432
    v_mfma_f32_16x16x32_bf16 v[236:239], a[248:251], a[164:167], v[236:239]
    ds_read_b64_tr_b16 a[232:233], v19 offset:0
    v_mfma_f32_16x16x32_bf16 v[236:239], a[252:255], a[176:179], v[236:239]
    ds_read_b64_tr_b16 a[234:235], v19 offset:6144
    v_mfma_f32_16x16x32_bf16 v[240:243], a[248:251], a[168:171], v[240:243]
    ds_read_b64_tr_b16 a[236:237], v19 offset:12288
    v_mfma_f32_16x16x32_bf16 v[240:243], a[252:255], a[180:183], v[240:243]
    ds_read_b64_tr_b16 a[238:239], v19 offset:18432
    s_waitcnt lgkmcnt(4)
    v_mfma_f32_16x16x32_bf16 v[100:103], a[208:211], a[184:187], v[100:103]
    ds_read_b64_tr_b16 a[240:241], v16 offset:128
    s_mov_b32 m0, s39
    v_mfma_f32_16x16x32_bf16 v[100:103], a[212:215], a[196:199], v[100:103]
    ds_read_b64_tr_b16 a[242:243], v16 offset:6272
    v_accvgpr_write_b32 a40, 0
    v_mfma_f32_16x16x32_bf16 v[104:107], a[208:211], a[188:191], v[104:107]
    ds_read_b64_tr_b16 a[244:245], v16 offset:12416
    v_accvgpr_write_b32 a41, 0
    v_mfma_f32_16x16x32_bf16 v[104:107], a[212:215], a[200:203], v[104:107]
    ds_read_b64_tr_b16 a[246:247], v16 offset:18560
    v_accvgpr_write_b32 a42, 0
    v_mfma_f32_16x16x32_bf16 v[108:111], a[208:211], a[192:195], v[108:111]
    ds_read_b64_tr_b16 a[248:249], v17 offset:128
    v_accvgpr_write_b32 a43, 0
    v_mfma_f32_16x16x32_bf16 v[108:111], a[212:215], a[204:207], v[108:111]
    ds_read_b64_tr_b16 a[250:251], v17 offset:6272
    v_accvgpr_write_b32 a44, 0
    v_mfma_f32_16x16x32_bf16 v[112:115], a[216:219], a[184:187], v[112:115]
    ds_read_b64_tr_b16 a[252:253], v17 offset:12416
    v_accvgpr_write_b32 a45, 0
    v_mfma_f32_16x16x32_bf16 v[112:115], a[220:223], a[196:199], v[112:115]
    ds_read_b64_tr_b16 a[254:255], v17 offset:18560
    v_accvgpr_write_b32 a46, 0
    v_mfma_f32_16x16x32_bf16 v[116:119], a[216:219], a[188:191], v[116:119]
    buffer_load_dwordx4 v8, s[16:19], s34 offen nt lds
    v_mfma_f32_16x16x32_bf16 v[116:119], a[220:223], a[200:203], v[116:119]
    buffer_load_dwordx4 v9, s[16:19], s34 offen offset:1024 nt lds
    v_mfma_f32_16x16x32_bf16 v[120:123], a[216:219], a[192:195], v[120:123]
    buffer_load_dwordx4 v10, s[16:19], s34 offen offset:2048 nt lds
    v_mfma_f32_16x16x32_bf16 v[120:123], a[220:223], a[204:207], v[120:123]
    s_add_u32 s49, s34, 3072
    s_waitcnt lgkmcnt(7)
    v_mfma_f32_16x16x32_bf16 v[124:127], a[224:227], a[184:187], v[124:127]
    ds_read_b64_tr_b16 a[208:209], v18 offset:128
    s_add_u32 m0, s39, 3072
    v_mfma_f32_16x16x32_bf16 v[124:127], a[228:231], a[196:199], v[124:127]
    ds_read_b64_tr_b16 a[210:211], v18 offset:6272
    v_accvgpr_write_b32 a47, 0
    v_mfma_f32_16x16x32_bf16 v[128:131], a[224:227], a[188:191], v[128:131]
    ds_read_b64_tr_b16 a[212:213], v18 offset:12416
    v_accvgpr_write_b32 a48, 0
    v_mfma_f32_16x16x32_bf16 v[128:131], a[228:231], a[200:203], v[128:131]
    ds_read_b64_tr_b16 a[214:215], v18 offset:18560
    v_accvgpr_write_b32 a49, 0
    v_mfma_f32_16x16x32_bf16 v[132:135], a[224:227], a[192:195], v[132:135]
    ds_read_b64_tr_b16 a[216:217], v19 offset:128
    v_accvgpr_write_b32 a50, 0
    v_mfma_f32_16x16x32_bf16 v[132:135], a[228:231], a[204:207], v[132:135]
    ds_read_b64_tr_b16 a[218:219], v19 offset:6272
    v_accvgpr_write_b32 a51, 0
    v_mfma_f32_16x16x32_bf16 v[136:139], a[232:235], a[184:187], v[136:139]
    ds_read_b64_tr_b16 a[220:221], v19 offset:12416
    v_accvgpr_write_b32 a52, 0
    v_mfma_f32_16x16x32_bf16 v[136:139], a[236:239], a[196:199], v[136:139]
    ds_read_b64_tr_b16 a[222:223], v19 offset:18560
    v_accvgpr_write_b32 a53, 0
    v_mfma_f32_16x16x32_bf16 v[140:143], a[232:235], a[188:191], v[140:143]
    s_cmp_eq_u32 s43, 49152
    s_cselect_b32 s45, s48, s47
    v_mfma_f32_16x16x32_bf16 v[140:143], a[236:239], a[200:203], v[140:143]
    s_add_u32 s43, s43, s45
    v_accvgpr_write_b32 a54, 0
    v_mfma_f32_16x16x32_bf16 v[144:147], a[232:235], a[192:195], v[144:147]
    buffer_load_dwordx4 v8, s[16:19], s49 offen nt lds
    v_mfma_f32_16x16x32_bf16 v[144:147], a[236:239], a[204:207], v[144:147]
    v_accvgpr_write_b32 a55, 0
    s_waitcnt lgkmcnt(7)
    v_mfma_f32_16x16x32_bf16 v[148:151], a[240:243], a[184:187], v[148:151]
    ds_read_b64_tr_b16 a[224:225], v16 offset:256
    v_accvgpr_write_b32 a56, 0
    v_mfma_f32_16x16x32_bf16 v[148:151], a[244:247], a[196:199], v[148:151]
    ds_read_b64_tr_b16 a[226:227], v16 offset:6400
    v_accvgpr_write_b32 a57, 0
    v_mfma_f32_16x16x32_bf16 v[152:155], a[240:243], a[188:191], v[152:155]
    ds_read_b64_tr_b16 a[228:229], v16 offset:12544
    v_accvgpr_write_b32 a58, 0
    v_mfma_f32_16x16x32_bf16 v[152:155], a[244:247], a[200:203], v[152:155]
    ds_read_b64_tr_b16 a[230:231], v16 offset:18688
    v_accvgpr_write_b32 a59, 0
    v_mfma_f32_16x16x32_bf16 v[156:159], a[240:243], a[192:195], v[156:159]
    ds_read_b64_tr_b16 a[232:233], v17 offset:256
    v_accvgpr_write_b32 a60, 0
    v_mfma_f32_16x16x32_bf16 v[156:159], a[244:247], a[204:207], v[156:159]
    ds_read_b64_tr_b16 a[234:235], v17 offset:6400
    v_accvgpr_write_b32 a61, 0
    v_mfma_f32_16x16x32_bf16 v[160:163], a[248:251], a[184:187], v[160:163]
    ds_read_b64_tr_b16 a[236:237], v17 offset:12544
    v_accvgpr_write_b32 a62, 0
    v_mfma_f32_16x16x32_bf16 v[160:163], a[252:255], a[196:199], v[160:163]
    ds_read_b64_tr_b16 a[238:239], v17 offset:18688
    v_accvgpr_write_b32 a63, 0
    v_mfma_f32_16x16x32_bf16 v[164:167], a[248:251], a[188:191], v[164:167]
    buffer_load_dwordx4 v9, s[16:19], s49 offen offset:1024 nt lds
    v_mfma_f32_16x16x32_bf16 v[164:167], a[252:255], a[200:203], v[164:167]
    buffer_load_dwordx4 v10, s[16:19], s49 offen offset:2048 nt lds
    v_mfma_f32_16x16x32_bf16 v[168:171], a[248:251], a[192:195], v[168:171]
    s_add_u32 s34, s34, 24576
    v_accvgpr_write_b32 a64, 0
    v_mfma_f32_16x16x32_bf16 v[168:171], a[252:255], a[204:207], v[168:171]
    v_accvgpr_write_b32 a65, 0
    s_waitcnt lgkmcnt(7)
    v_mfma_f32_16x16x32_bf16 v[172:175], a[208:211], a[184:187], v[172:175]
    ds_read_b64_tr_b16 a[240:241], v18 offset:256
    v_accvgpr_write_b32 a66, 0
    v_mfma_f32_16x16x32_bf16 v[172:175], a[212:215], a[196:199], v[172:175]
    ds_read_b64_tr_b16 a[242:243], v18 offset:6400
    v_accvgpr_write_b32 a67, 0
    v_mfma_f32_16x16x32_bf16 v[176:179], a[208:211], a[188:191], v[176:179]
    ds_read_b64_tr_b16 a[244:245], v18 offset:12544
    v_accvgpr_write_b32 a68, 0
    v_mfma_f32_16x16x32_bf16 v[176:179], a[212:215], a[200:203], v[176:179]
    ds_read_b64_tr_b16 a[246:247], v18 offset:18688
    v_accvgpr_write_b32 a69, 0
    v_mfma_f32_16x16x32_bf16 v[180:183], a[208:211], a[192:195], v[180:183]
    ds_read_b64_tr_b16 a[248:249], v19 offset:256
    v_accvgpr_write_b32 a70, 0
    v_mfma_f32_16x16x32_bf16 v[180:183], a[212:215], a[204:207], v[180:183]
    ds_read_b64_tr_b16 a[250:251], v19 offset:6400
    v_accvgpr_write_b32 a71, 0
    v_mfma_f32_16x16x32_bf16 v[184:187], a[216:219], a[184:187], v[184:187]
    ds_read_b64_tr_b16 a[252:253], v19 offset:12544
    v_accvgpr_write_b32 a72, 0
    v_mfma_f32_16x16x32_bf16 v[184:187], a[220:223], a[196:199], v[184:187]
    ds_read_b64_tr_b16 a[254:255], v19 offset:18688
    v_accvgpr_write_b32 a73, 0
    v_mfma_f32_16x16x32_bf16 v[188:191], a[216:219], a[188:191], v[188:191]
    s_cmp_eq_u32 s39, s41
    s_cselect_b32 s51, s48, s47
    v_mfma_f32_16x16x32_bf16 v[188:191], a[220:223], a[200:203], v[188:191]
    s_add_u32 s39, s39, s51
    s_mov_b32 m0, s40
    v_mfma_f32_16x16x32_bf16 v[192:195], a[216:219], a[192:195], v[192:195]
    v_add_u32 v14, 24576, v250
    v_xor_b32 v15, 64, v14
    v_mfma_f32_16x16x32_bf16 v[192:195], a[220:223], a[204:207], v[192:195]
    v_add_u32 v16, 98304, v16
    s_waitcnt lgkmcnt(7)
    v_mfma_f32_16x16x32_bf16 v[196:199], a[224:227], a[184:187], v[196:199]
    v_add_u32 v17, 98304, v17
    v_add_u32 v18, 98304, v18
    v_mfma_f32_16x16x32_bf16 v[196:199], a[228:231], a[196:199], v[196:199]
    v_add_u32 v19, 98304, v19
    v_accvgpr_write_b32 a74, 0
    v_mfma_f32_16x16x32_bf16 v[200:203], a[224:227], a[188:191], v[200:203]
    buffer_load_dwordx4 v8, s[20:23], s35 offen nt lds
    v_mfma_f32_16x16x32_bf16 v[200:203], a[228:231], a[200:203], v[200:203]
    buffer_load_dwordx4 v9, s[20:23], s35 offen offset:1024 nt lds
    v_mfma_f32_16x16x32_bf16 v[204:207], a[224:227], a[192:195], v[204:207]
    buffer_load_dwordx4 v10, s[20:23], s35 offen offset:2048 nt lds
    v_mfma_f32_16x16x32_bf16 v[204:207], a[228:231], a[204:207], v[204:207]
    s_add_u32 s50, s35, 3072
    s_add_u32 m0, s40, 3072
    v_mfma_f32_16x16x32_bf16 v[208:211], a[232:235], a[184:187], v[208:211]
    buffer_load_dwordx4 v8, s[20:23], s50 offen nt lds
    v_mfma_f32_16x16x32_bf16 v[208:211], a[236:239], a[196:199], v[208:211]
    buffer_load_dwordx4 v9, s[20:23], s50 offen offset:1024 nt lds
    v_mfma_f32_16x16x32_bf16 v[212:215], a[232:235], a[188:191], v[212:215]
    buffer_load_dwordx4 v10, s[20:23], s50 offen offset:2048 nt lds
    v_mfma_f32_16x16x32_bf16 v[212:215], a[236:239], a[200:203], v[212:215]
    s_add_u32 s35, s35, 24576
    v_accvgpr_write_b32 a75, 0
    v_mfma_f32_16x16x32_bf16 v[216:219], a[232:235], a[192:195], v[216:219]
    s_cmp_eq_u32 s40, s42
    s_cselect_b32 s51, s48, s47
    v_mfma_f32_16x16x32_bf16 v[216:219], a[236:239], a[204:207], v[216:219]
    s_add_u32 s40, s40, s51
    s_waitcnt lgkmcnt(0)
    v_mfma_f32_16x16x32_bf16 v[220:223], a[240:243], a[184:187], v[220:223]
    v_accvgpr_write_b32 a76, 0
    v_accvgpr_write_b32 a77, 0
    v_mfma_f32_16x16x32_bf16 v[220:223], a[244:247], a[196:199], v[220:223]
    v_accvgpr_write_b32 a78, 0
    v_accvgpr_write_b32 a79, 0
    v_mfma_f32_16x16x32_bf16 v[224:227], a[240:243], a[188:191], v[224:227]
    v_mfma_f32_16x16x32_bf16 v[224:227], a[244:247], a[200:203], v[224:227]
    v_mfma_f32_16x16x32_bf16 v[228:231], a[240:243], a[192:195], v[228:231]
    v_mfma_f32_16x16x32_bf16 v[228:231], a[244:247], a[204:207], v[228:231]
    v_mfma_f32_16x16x32_bf16 v[232:235], a[248:251], a[184:187], v[232:235]
    v_mfma_f32_16x16x32_bf16 v[232:235], a[252:255], a[196:199], v[232:235]
    v_mfma_f32_16x16x32_bf16 v[236:239], a[248:251], a[188:191], v[236:239]
    v_mfma_f32_16x16x32_bf16 v[236:239], a[252:255], a[200:203], v[236:239]
    v_mfma_f32_16x16x32_bf16 v[240:243], a[248:251], a[192:195], v[240:243]
    v_mfma_f32_16x16x32_bf16 v[240:243], a[252:255], a[204:207], v[240:243]
    s_cmp_lg_u32 s56, 0
    s_cbranch_scc1 K1_sg0
    s_cmp_eq_u32 s54, 0
    s_cbranch_scc1 K1_sg0
    v_readfirstlane_b32 s49, v27
    s_nop 0
    s_cmp_ge_u32 s49, 256
    s_cbranch_scc1 K1_zok
    s_mov_b32 s24, s62
    s_and_b32 s25, s63, 65535
    s_mov_b32 s26, 4
    s_mov_b32 s27, 131072
    v_mov_b32 v2, 0
K1_zp:
    buffer_load_dword v3, v2, s[24:27], 0 offen sc1
    s_waitcnt vmcnt(0)
    v_readfirstlane_b32 s49, v3
    s_nop 0
    s_cmp_ge_u32 s49, 256
    s_cbranch_scc1 K1_zok
    s_sleep 4
    s_branch K1_zp
K1_zok:
    s_and_b32 s49, s55, 1
    s_cbranch_scc1 K1_sg0
    s_mov_b32 s49, 0
    s_add_u32 s50, s83, s49
    v_mov_b32 v2, 0
    v_mov_b32 v3, 1
    s_mov_b64 exec, 1
    buffer_atomic_add v3, v2, s[96:99], s50 offen sc1
    s_mov_b64 exec, -1
    s_or_b32 s80, s80, 1
K1_sg0:
    s_nop 7
    v_mov_b32 v6, s57
    v_mov_b32 v7, s57
    v_pk_mul_f32 v[100:101], v[100:101], v[6:7]
    v_pk_mul_f32 v[102:103], v[102:103], v[6:7]
    v_pk_mul_f32 v[112:113], v[112:113], v[6:7]
    v_pk_mul_f32 v[114:115], v[114:115], v[6:7]
    v_cvt_pk_bf16_f32 v28, v100, v101
    v_cvt_pk_bf16_f32 v29, v102, v103
    v_cvt_pk_bf16_f32 v30, v112, v113
    v_cvt_pk_bf16_f32 v31, v114, v115
    v_pk_mul_f32 v[124:125], v[124:125], v[6:7]
    v_pk_mul_f32 v[126:127], v[126:127], v[6:7]
    v_pk_mul_f32 v[136:137], v[136:137], v[6:7]
    v_pk_mul_f32 v[138:139], v[138:139], v[6:7]
    v_cvt_pk_bf16_f32 v32, v124, v125
    v_cvt_pk_bf16_f32 v33, v126, v127
    v_cvt_pk_bf16_f32 v34, v136, v137
    v_cvt_pk_bf16_f32 v35, v138, v139
    v_permlane32_swap_b32 v28, v30
    v_permlane32_swap_b32 v29, v31
    v_pk_mul_f32 v[148:149], v[148:149], v[6:7]
    v_pk_mul_f32 v[150:151], v[150:151], v[6:7]
    v_pk_mul_f32 v[160:161], v[160:161], v[6:7]
    v_pk_mul_f32 v[162:163], v[162:163], v[6:7]
    v_cvt_pk_bf16_f32 v36, v148, v149
    v_cvt_pk_bf16_f32 v37, v150, v151
    v_cvt_pk_bf16_f32 v38, v160, v161
    v_cvt_pk_bf16_f32 v39, v162, v163
    v_permlane16_swap_b32 v28, v30
    v_permlane16_swap_b32 v29, v31
    v_permlane32_swap_b32 v32, v34
    v_permlane32_swap_b32 v33, v35
    v_pk_mul_f32 v[172:173], v[172:173], v[6:7]
    v_pk_mul_f32 v[174:175], v[174:175], v[6:7]
    v_pk_mul_f32 v[184:185], v[184:185], v[6:7]
    v_pk_mul_f32 v[186:187], v[186:187], v[6:7]
    v_cvt_pk_bf16_f32 v40, v172, v173
    v_cvt_pk_bf16_f32 v41, v174, v175
    v_cvt_pk_bf16_f32 v42, v184, v185
    v_cvt_pk_bf16_f32 v43, v186, v187
    v_permlane16_swap_b32 v32, v34
    v_permlane16_swap_b32 v33, v35
    v_permlane32_swap_b32 v36, v38
    v_permlane32_swap_b32 v37, v39
    v_pk_mul_f32 v[196:197], v[196:197], v[6:7]
    v_pk_mul_f32 v[198:199], v[198:199], v[6:7]
    v_pk_mul_f32 v[208:209], v[208:209], v[6:7]
    v_pk_mul_f32 v[210:211], v[210:211], v[6:7]
    v_cvt_pk_bf16_f32 v44, v196, v197
    v_cvt_pk_bf16_f32 v45, v198, v199
    v_cvt_pk_bf16_f32 v46, v208, v209
    v_cvt_pk_bf16_f32 v47, v210, v211
    v_permlane16_swap_b32 v36, v38
    v_permlane16_swap_b32 v37, v39
    v_permlane32_swap_b32 v40, v42
    v_permlane32_swap_b32 v41, v43
    v_pk_mul_f32 v[220:221], v[220:221], v[6:7]
    v_pk_mul_f32 v[222:223], v[222:223], v[6:7]
    v_pk_mul_f32 v[232:233], v[232:233], v[6:7]
    v_pk_mul_f32 v[234:235], v[234:235], v[6:7]
    v_cvt_pk_bf16_f32 v48, v220, v221
    v_cvt_pk_bf16_f32 v49, v222, v223
    v_cvt_pk_bf16_f32 v50, v232, v233
    v_cvt_pk_bf16_f32 v51, v234, v235
    v_permlane16_swap_b32 v40, v42
    v_permlane16_swap_b32 v41, v43
    v_permlane32_swap_b32 v44, v46
    v_permlane32_swap_b32 v45, v47
    v_pk_mul_f32 v[104:105], v[104:105], v[6:7]
    v_pk_mul_f32 v[106:107], v[106:107], v[6:7]
    v_pk_mul_f32 v[116:117], v[116:117], v[6:7]
    v_pk_mul_f32 v[118:119], v[118:119], v[6:7]
    v_cvt_pk_bf16_f32 v52, v104, v105
    v_cvt_pk_bf16_f32 v53, v106, v107
    v_cvt_pk_bf16_f32 v54, v116, v117
    v_cvt_pk_bf16_f32 v55, v118, v119
    v_permlane16_swap_b32 v44, v46
    v_permlane16_swap_b32 v45, v47
    v_permlane32_swap_b32 v48, v50
    v_permlane32_swap_b32 v49, v51
    v_pk_mul_f32 v[128:129], v[128:129], v[6:7]
    v_pk_mul_f32 v[130:131], v[130:131], v[6:7]
    v_pk_mul_f32 v[140:141], v[140:141], v[6:7]
    v_pk_mul_f32 v[142:143], v[142:143], v[6:7]
    v_cvt_pk_bf16_f32 v56, v128, v129
    v_cvt_pk_bf16_f32 v57, v130, v131
    v_cvt_pk_bf16_f32 v58, v140, v141
    v_cvt_pk_bf16_f32 v59, v142, v143
    v_permlane16_swap_b32 v48, v50
    v_permlane16_swap_b32 v49, v51
    v_permlane32_swap_b32 v52, v54
    v_permlane32_swap_b32 v53, v55
    v_pk_mul_f32 v[152:153], v[152:153], v[6:7]
    v_pk_mul_f32 v[154:155], v[154:155], v[6:7]
    v_pk_mul_f32 v[164:165], v[164:165], v[6:7]
    v_pk_mul_f32 v[166:167], v[166:167], v[6:7]
    v_cvt_pk_bf16_f32 v60, v152, v153
    v_cvt_pk_bf16_f32 v61, v154, v155
    v_cvt_pk_bf16_f32 v62, v164, v165
    v_cvt_pk_bf16_f32 v63, v166, v167
    v_permlane16_swap_b32 v52, v54
    v_permlane16_swap_b32 v53, v55
    v_permlane32_swap_b32 v56, v58
    v_permlane32_swap_b32 v57, v59
    v_pk_mul_f32 v[176:177], v[176:177], v[6:7]
    v_pk_mul_f32 v[178:179], v[178:179], v[6:7]
    v_pk_mul_f32 v[188:189], v[188:189], v[6:7]
    v_pk_mul_f32 v[190:191], v[190:191], v[6:7]
    v_cvt_pk_bf16_f32 v64, v176, v177
    v_cvt_pk_bf16_f32 v65, v178, v179
    v_cvt_pk_bf16_f32 v66, v188, v189
    v_cvt_pk_bf16_f32 v67, v190, v191
    v_permlane16_swap_b32 v56, v58
    v_permlane16_swap_b32 v57, v59
    v_permlane32_swap_b32 v60, v62
    v_permlane32_swap_b32 v61, v63
    v_pk_mul_f32 v[200:201], v[200:201], v[6:7]
    v_pk_mul_f32 v[202:203], v[202:203], v[6:7]
    v_pk_mul_f32 v[212:213], v[212:213], v[6:7]
    v_pk_mul_f32 v[214:215], v[214:215], v[6:7]
    v_cvt_pk_bf16_f32 v68, v200, v201
    v_cvt_pk_bf16_f32 v69, v202, v203
    v_cvt_pk_bf16_f32 v70, v212, v213
    v_cvt_pk_bf16_f32 v71, v214, v215
    v_permlane16_swap_b32 v60, v62
    v_permlane16_swap_b32 v61, v63
    v_permlane32_swap_b32 v64, v66
    v_permlane32_swap_b32 v65, v67
    v_pk_mul_f32 v[224:225], v[224:225], v[6:7]
    v_pk_mul_f32 v[226:227], v[226:227], v[6:7]
    v_pk_mul_f32 v[236:237], v[236:237], v[6:7]
    v_pk_mul_f32 v[238:239], v[238:239], v[6:7]
    v_cvt_pk_bf16_f32 v72, v224, v225
    v_cvt_pk_bf16_f32 v73, v226, v227
    v_cvt_pk_bf16_f32 v74, v236, v237
    v_cvt_pk_bf16_f32 v75, v238, v239
    v_permlane16_swap_b32 v64, v66
    v_permlane16_swap_b32 v65, v67
    v_permlane32_swap_b32 v68, v70
    v_permlane32_swap_b32 v69, v71
    v_pk_mul_f32 v[108:109], v[108:109], v[6:7]
    v_pk_mul_f32 v[110:111], v[110:111], v[6:7]
    v_pk_mul_f32 v[120:121], v[120:121], v[6:7]
    v_pk_mul_f32 v[122:123], v[122:123], v[6:7]
    v_cvt_pk_bf16_f32 v76, v108, v109
    v_cvt_pk_bf16_f32 v77, v110, v111
    v_cvt_pk_bf16_f32 v78, v120, v121
    v_cvt_pk_bf16_f32 v79, v122, v123
    v_permlane16_swap_b32 v68, v70
    v_permlane16_swap_b32 v69, v71
    v_permlane32_swap_b32 v72, v74
    v_permlane32_swap_b32 v73, v75
    v_pk_mul_f32 v[132:133], v[132:133], v[6:7]
    v_pk_mul_f32 v[134:135], v[134:135], v[6:7]
    v_pk_mul_f32 v[144:145], v[144:145], v[6:7]
    v_pk_mul_f32 v[146:147], v[146:147], v[6:7]
    v_cvt_pk_bf16_f32 v80, v132, v133
    v_cvt_pk_bf16_f32 v81, v134, v135
    v_cvt_pk_bf16_f32 v82, v144, v145
    v_cvt_pk_bf16_f32 v83, v146, v147
    v_permlane16_swap_b32 v72, v74
    v_permlane16_swap_b32 v73, v75
    v_permlane32_swap_b32 v76, v78
    v_permlane32_swap_b32 v77, v79
    v_pk_mul_f32 v[156:157], v[156:157], v[6:7]
    v_pk_mul_f32 v[158:159], v[158:159], v[6:7]
    v_pk_mul_f32 v[168:169], v[168:169], v[6:7]
    v_pk_mul_f32 v[170:171], v[170:171], v[6:7]
    v_cvt_pk_bf16_f32 v84, v156, v157
    v_cvt_pk_bf16_f32 v85, v158, v159
    v_cvt_pk_bf16_f32 v86, v168, v169
    v_cvt_pk_bf16_f32 v87, v170, v171
    v_permlane16_swap_b32 v76, v78
    v_permlane16_swap_b32 v77, v79
    v_permlane32_swap_b32 v80, v82
    v_permlane32_swap_b32 v81, v83
    v_pk_mul_f32 v[180:181], v[180:181], v[6:7]
    v_pk_mul_f32 v[182:183], v[182:183], v[6:7]
    v_pk_mul_f32 v[192:193], v[192:193], v[6:7]
    v_pk_mul_f32 v[194:195], v[194:195], v[6:7]
    v_cvt_pk_bf16_f32 v88, v180, v181
    v_cvt_pk_bf16_f32 v89, v182, v183
    v_cvt_pk_bf16_f32 v90, v192, v193
    v_cvt_pk_bf16_f32 v91, v194, v195
    v_permlane16_swap_b32 v80, v82
    v_permlane16_swap_b32 v81, v83
    v_permlane32_swap_b32 v84, v86
    v_permlane32_swap_b32 v85, v87
    v_pk_mul_f32 v[204:205], v[204:205], v[6:7]
    v_pk_mul_f32 v[206:207], v[206:207], v[6:7]
    v_pk_mul_f32 v[216:217], v[216:217], v[6:7]
    v_pk_mul_f32 v[218:219], v[218:219], v[6:7]
    v_cvt_pk_bf16_f32 v92, v204, v205
    v_cvt_pk_bf16_f32 v93, v206, v207
    v_cvt_pk_bf16_f32 v94, v216, v217
    v_cvt_pk_bf16_f32 v95, v218, v219
    v_permlane16_swap_b32 v84, v86
    v_permlane16_swap_b32 v85, v87
    v_permlane32_swap_b32 v88, v90
    v_permlane32_swap_b32 v89, v91
    v_pk_mul_f32 v[228:229], v[228:229], v[6:7]
    v_pk_mul_f32 v[230:231], v[230:231], v[6:7]
    v_pk_mul_f32 v[240:241], v[240:241], v[6:7]
    v_pk_mul_f32 v[242:243], v[242:243], v[6:7]
    v_cvt_pk_bf16_f32 v96, v228, v229
    v_cvt_pk_bf16_f32 v97, v230, v231
    v_cvt_pk_bf16_f32 v98, v240, v241
    v_cvt_pk_bf16_f32 v99, v242, v243
    v_permlane16_swap_b32 v88, v90
    v_permlane16_swap_b32 v89, v91
    v_permlane32_swap_b32 v92, v94
    v_permlane32_swap_b32 v93, v95
    s_nop 0
    v_permlane16_swap_b32 v92, v94
    v_permlane16_swap_b32 v93, v95
    s_nop 1
    v_permlane32_swap_b32 v96, v98
    v_permlane32_swap_b32 v97, v99
    s_nop 0
    v_permlane16_swap_b32 v96, v98
    v_permlane16_swap_b32 v97, v99
    s_nop 1
    s_cmp_lg_u32 s56, 0
    s_cbranch_scc1 K1_slow
    s_waitcnt vmcnt(12) lgkmcnt(0)
    s_barrier
    ds_read_b128 a[160:163], v14 offset:0
    ds_read_b128 a[164:167], v15 offset:0
    ds_read_b128 a[168:171], v14 offset:128
    ds_read_b128 a[172:175], v15 offset:128
    ds_read_b128 a[176:179], v14 offset:256
    ds_read_b128 a[180:183], v15 offset:256
    s_waitcnt lgkmcnt(0)
    v_mfma_f32_16x16x32_bf16 v[100:103], a[160:163], v[28:31], 0
    ds_read_b128 a[184:187], v14 offset:6144
    s_mov_b32 m0, s39
    v_mfma_f32_16x16x32_bf16 v[100:103], a[164:167], v[32:35], v[100:103]
    ds_read_b128 a[188:191], v15 offset:6144
    v_accvgpr_write_b32 a80, 0
    v_mfma_f32_16x16x32_bf16 v[100:103], a[168:171], v[36:39], v[100:103]
    ds_read_b128 a[192:195], v14 offset:6272
    v_accvgpr_write_b32 a81, 0
    v_mfma_f32_16x16x32_bf16 v[100:103], a[172:175], v[40:43], v[100:103]
    ds_read_b128 a[196:199], v15 offset:6272
    v_accvgpr_write_b32 a82, 0
    v_mfma_f32_16x16x32_bf16 v[100:103], a[176:179], v[44:47], v[100:103]
    ds_read_b128 a[200:203], v14 offset:6400
    v_accvgpr_write_b32 a83, 0
    v_mfma_f32_16x16x32_bf16 v[100:103], a[180:183], v[48:51], v[100:103]
    ds_read_b128 a[204:207], v15 offset:6400
    v_accvgpr_write_b32 a84, 0
    v_mfma_f32_16x16x32_bf16 v[104:107], a[160:163], v[52:55], 0
    s_cmp_eq_u32 s43, 49152
    s_cselect_b32 s45, s48, s47
    v_mfma_f32_16x16x32_bf16 v[104:107], a[164:167], v[56:59], v[104:107]
    s_add_u32 s43, s43, s45
    v_accvgpr_write_b32 a85, 0
    v_mfma_f32_16x16x32_bf16 v[104:107], a[168:171], v[60:63], v[104:107]
    buffer_load_dwordx4 v8, s[16:19], s34 offen nt lds
    v_mfma_f32_16x16x32_bf16 v[104:107], a[172:175], v[64:67], v[104:107]
    buffer_load_dwordx4 v9, s[16:19], s34 offen offset:1024 nt lds
    v_mfma_f32_16x16x32_bf16 v[104:107], a[176:179], v[68:71], v[104:107]
    buffer_load_dwordx4 v10, s[16:19], s34 offen offset:2048 nt lds
    v_mfma_f32_16x16x32_bf16 v[104:107], a[180:183], v[72:75], v[104:107]
    s_add_u32 s49, s34, 3072
    v_accvgpr_write_b32 a86, 0
    v_mfma_f32_16x16x32_bf16 v[108:111], a[160:163], v[76:79], 0
    s_add_u32 m0, s39, 3072
    v_accvgpr_write_b32 a87, 0
    v_mfma_f32_16x16x32_bf16 v[108:111], a[164:167], v[80:83], v[108:111]
    v_accvgpr_write_b32 a88, 0
    v_accvgpr_write_b32 a89, 0
    v_mfma_f32_16x16x32_bf16 v[108:111], a[168:171], v[84:87], v[108:111]
    buffer_load_dwordx4 v8, s[16:19], s49 offen nt lds
    v_mfma_f32_16x16x32_bf16 v[108:111], a[172:175], v[88:91], v[108:111]
    v_accvgpr_write_b32 a90, 0
    v_accvgpr_write_b32 a91, 0
    v_mfma_f32_16x16x32_bf16 v[108:111], a[176:179], v[92:95], v[108:111]
    v_accvgpr_write_b32 a92, 0
    v_accvgpr_write_b32 a93, 0
    v_mfma_f32_16x16x32_bf16 v[108:111], a[180:183], v[96:99], v[108:111]
    v_accvgpr_write_b32 a94, 0
    s_waitcnt lgkmcnt(0)
    v_mfma_f32_16x16x32_bf16 v[112:115], a[184:187], v[28:31], 0
    ds_read_b128 a[160:163], v14 offset:12288
    v_accvgpr_write_b32 a95, 0
    v_mfma_f32_16x16x32_bf16 v[112:115], a[188:191], v[32:35], v[112:115]
    ds_read_b128 a[164:167], v15 offset:12288
    v_accvgpr_write_b32 a96, 0
    v_mfma_f32_16x16x32_bf16 v[112:115], a[192:195], v[36:39], v[112:115]
    ds_read_b128 a[168:171], v14 offset:12416
    v_accvgpr_write_b32 a97, 0
    v_mfma_f32_16x16x32_bf16 v[112:115], a[196:199], v[40:43], v[112:115]
    ds_read_b128 a[172:175], v15 offset:12416
    v_accvgpr_write_b32 a98, 0
    v_mfma_f32_16x16x32_bf16 v[112:115], a[200:203], v[44:47], v[112:115]
    ds_read_b128 a[176:179], v14 offset:12544
    v_accvgpr_write_b32 a99, 0
    v_mfma_f32_16x16x32_bf16 v[112:115], a[204:207], v[48:51], v[112:115]
    ds_read_b128 a[180:183], v15 offset:12544
    v_accvgpr_write_b32 a100, 0
    v_mfma_f32_16x16x32_bf16 v[116:119], a[184:187], v[52:55], 0
    buffer_load_dwordx4 v9, s[16:19], s49 offen offset:1024 nt lds
    v_mfma_f32_16x16x32_bf16 v[116:119], a[188:191], v[56:59], v[116:119]
    buffer_load_dwordx4 v10, s[16:19], s49 offen offset:2048 nt lds
    v_mfma_f32_16x16x32_bf16 v[116:119], a[192:195], v[60:63], v[116:119]
    s_add_u32 s34, s34, 24576
    v_accvgpr_write_b32 a101, 0
    v_mfma_f32_16x16x32_bf16 v[116:119], a[196:199], v[64:67], v[116:119]
    s_cmp_eq_u32 s39, s41
    s_cselect_b32 s51, s48, s47
    v_mfma_f32_16x16x32_bf16 v[116:119], a[200:203], v[68:71], v[116:119]
    s_add_u32 s39, s39, s51
    s_mov_b32 m0, s40
    v_mfma_f32_16x16x32_bf16 v[116:119], a[204:207], v[72:75], v[116:119]
    buffer_load_dwordx4 v8, s[20:23], s35 offen nt lds
    v_mfma_f32_16x16x32_bf16 v[120:123], a[184:187], v[76:79], 0
    buffer_load_dwordx4 v9, s[20:23], s35 offen offset:1024 nt lds
    v_mfma_f32_16x16x32_bf16 v[120:123], a[188:191], v[80:83], v[120:123]
    v_accvgpr_write_b32 a102, 0
    v_accvgpr_write_b32 a103, 0
    v_mfma_f32_16x16x32_bf16 v[120:123], a[192:195], v[84:87], v[120:123]
    v_accvgpr_write_b32 a104, 0
    v_accvgpr_write_b32 a105, 0
    v_mfma_f32_16x16x32_bf16 v[120:123], a[196:199], v[88:91], v[120:123]
    v_accvgpr_write_b32 a106, 0
    v_accvgpr_write_b32 a107, 0
    v_mfma_f32_16x16x32_bf16 v[120:123], a[200:203], v[92:95], v[120:123]
    buffer_load_dwordx4 v10, s[20:23], s35 offen offset:2048 nt lds
    v_mfma_f32_16x16x32_bf16 v[120:123], a[204:207], v[96:99], v[120:123]
    s_add_u32 s50, s35, 3072
    s_waitcnt lgkmcnt(0)
    v_mfma_f32_16x16x32_bf16 v[124:127], a[160:163], v[28:31], 0
    ds_read_b128 a[184:187], v14 offset:18432
    s_add_u32 m0, s40, 3072
    v_mfma_f32_16x16x32_bf16 v[124:127], a[164:167], v[32:35], v[124:127]
    ds_read_b128 a[188:191], v15 offset:18432
    v_accvgpr_write_b32 a108, 0
    v_mfma_f32_16x16x32_bf16 v[124:127], a[168:171], v[36:39], v[124:127]
    ds_read_b128 a[192:195], v14 offset:18560
    v_accvgpr_write_b32 a109, 0
    v_mfma_f32_16x16x32_bf16 v[124:127], a[172:175], v[40:43], v[124:127]
    ds_read_b128 a[196:199], v15 offset:18560
    v_accvgpr_write_b32 a110, 0
    v_mfma_f32_16x16x32_bf16 v[124:127], a[176:179], v[44:47], v[124:127]
    ds_read_b128 a[200:203], v14 offset:18688
    v_accvgpr_write_b32 a111, 0
    v_mfma_f32_16x16x32_bf16 v[124:127], a[180:183], v[48:51], v[124:127]
    ds_read_b128 a[204:207], v15 offset:18688
    v_accvgpr_write_b32 a112, 0
    v_mfma_f32_16x16x32_bf16 v[128:131], a[160:163], v[52:55], 0
    buffer_load_dwordx4 v8, s[20:23], s50 offen nt lds
    v_mfma_f32_16x16x32_bf16 v[128:131], a[164:167], v[56:59], v[128:131]
    buffer_load_dwordx4 v9, s[20:23], s50 offen offset:1024 nt lds
    v_mfma_f32_16x16x32_bf16 v[128:131], a[168:171], v[60:63], v[128:131]
    v_accvgpr_write_b32 a113, 0
    v_accvgpr_write_b32 a114, 0
    v_mfma_f32_16x16x32_bf16 v[128:131], a[172:175], v[64:67], v[128:131]
    v_accvgpr_write_b32 a115, 0
    v_accvgpr_write_b32 a116, 0
    v_mfma_f32_16x16x32_bf16 v[128:131], a[176:179], v[68:71], v[128:131]
    buffer_load_dwordx4 v10, s[20:23], s50 offen offset:2048 nt lds
    v_mfma_f32_16x16x32_bf16 v[128:131], a[180:183], v[72:75], v[128:131]
    s_add_u32 s35, s35, 24576
    v_accvgpr_write_b32 a117, 0
    v_mfma_f32_16x16x32_bf16 v[132:135], a[160:163], v[76:79], 0
    s_cmp_eq_u32 s40, s42
    s_cselect_b32 s51, s48, s47
    v_mfma_f32_16x16x32_bf16 v[132:135], a[164:167], v[80:83], v[132:135]
    s_add_u32 s40, s40, s51
    v_accvgpr_write_b32 a118, 0
    v_mfma_f32_16x16x32_bf16 v[132:135], a[168:171], v[84:87], v[132:135]
    v_add_u32 v14, s45, v14
    v_add_u32 v15, s45, v15
    v_mfma_f32_16x16x32_bf16 v[132:135], a[172:175], v[88:91], v[132:135]
    v_accvgpr_write_b32 a119, 0
    v_accvgpr_write_b32 a120, 0
    v_mfma_f32_16x16x32_bf16 v[132:135], a[176:179], v[92:95], v[132:135]
    v_accvgpr_write_b32 a121, 0
    v_accvgpr_write_b32 a122, 0
    v_mfma_f32_16x16x32_bf16 v[132:135], a[180:183], v[96:99], v[132:135]
    s_waitcnt vmcnt(18) lgkmcnt(0)
    s_barrier
    v_mfma_f32_16x16x32_bf16 v[136:139], a[184:187], v[28:31], 0
    ds_read_b128 a[160:163], v14 offset:0
    v_accvgpr_write_b32 a123, 0
    v_mfma_f32_16x16x32_bf16 v[136:139], a[188:191], v[32:35], v[136:139]
    ds_read_b128 a[164:167], v15 offset:0
    v_accvgpr_write_b32 a124, 0
    v_mfma_f32_16x16x32_bf16 v[136:139], a[192:195], v[36:39], v[136:139]
    ds_read_b128 a[168:171], v14 offset:128
    v_accvgpr_write_b32 a125, 0
    v_mfma_f32_16x16x32_bf16 v[136:139], a[196:199], v[40:43], v[136:139]
    ds_read_b128 a[172:175], v15 offset:128
    v_accvgpr_write_b32 a126, 0
    v_mfma_f32_16x16x32_bf16 v[136:139], a[200:203], v[44:47], v[136:139]
    ds_read_b128 a[176:179], v14 offset:256
    v_accvgpr_write_b32 a127, 0
    v_mfma_f32_16x16x32_bf16 v[136:139], a[204:207], v[48:51], v[136:139]
    ds_read_b128 a[180:183], v15 offset:256
    v_accvgpr_write_b32 a128, 0
    v_mfma_f32_16x16x32_bf16 v[140:143], a[184:187], v[52:55], 0
    v_accvgpr_write_b32 a129, 0
    v_accvgpr_write_b32 a130, 0
    v_mfma_f32_16x16x32_bf16 v[140:143], a[188:191], v[56:59], v[140:143]
    v_accvgpr_write_b32 a131, 0
    v_accvgpr_write_b32 a132, 0
    v_mfma_f32_16x16x32_bf16 v[140:143], a[192:195], v[60:63], v[140:143]
    v_accvgpr_write_b32 a133, 0
    v_accvgpr_write_b32 a134, 0
    v_mfma_f32_16x16x32_bf16 v[140:143], a[196:199], v[64:67], v[140:143]
    v_accvgpr_write_b32 a135, 0
    v_accvgpr_write_b32 a136, 0
    v_mfma_f32_16x16x32_bf16 v[140:143], a[200:203], v[68:71], v[140:143]
    v_accvgpr_write_b32 a137, 0
    v_accvgpr_write_b32 a138, 0
    v_mfma_f32_16x16x32_bf16 v[140:143], a[204:207], v[72:75], v[140:143]
    v_accvgpr_write_b32 a139, 0
    v_accvgpr_write_b32 a140, 0
    v_mfma_f32_16x16x32_bf16 v[144:147], a[184:187], v[76:79], 0
    v_accvgpr_write_b32 a141, 0
    v_accvgpr_write_b32 a142, 0
    v_mfma_f32_16x16x32_bf16 v[144:147], a[188:191], v[80:83], v[144:147]
    v_accvgpr_write_b32 a143, 0
    v_accvgpr_write_b32 a144, 0
    v_mfma_f32_16x16x32_bf16 v[144:147], a[192:195], v[84:87], v[144:147]
    v_accvgpr_write_b32 a145, 0
    v_accvgpr_write_b32 a146, 0
    v_mfma_f32_16x16x32_bf16 v[144:147], a[196:199], v[88:91], v[144:147]
    v_accvgpr_write_b32 a147, 0
    v_accvgpr_write_b32 a148, 0
    v_mfma_f32_16x16x32_bf16 v[144:147], a[200:203], v[92:95], v[144:147]
    v_accvgpr_write_b32 a149, 0
    v_accvgpr_write_b32 a150, 0
    v_mfma_f32_16x16x32_bf16 v[144:147], a[204:207], v[96:99], v[144:147]
    v_accvgpr_write_b32 a151, 0
    v_accvgpr_write_b32 a152, 0
    v_accvgpr_write_b32 a153, 0
    v_accvgpr_write_b32 a154, 0
    v_accvgpr_write_b32 a155, 0
    s_waitcnt lgkmcnt(0)
    v_mfma_f32_16x16x32_bf16 v[148:151], a[160:163], v[28:31], 0
    ds_read_b128 a[184:187], v14 offset:6144
    s_mov_b32 m0, s39
    v_mfma_f32_16x16x32_bf16 v[148:151], a[164:167], v[32:35], v[148:151]
    ds_read_b128 a[188:191], v15 offset:6144
    v_mfma_f32_16x16x32_bf16 v[148:151], a[168:171], v[36:39], v[148:151]
    ds_read_b128 a[192:195], v14 offset:6272
    buffer_load_dwordx4 v8, s[16:19], s34 offen nt lds
    v_mfma_f32_16x16x32_bf16 v[148:151], a[172:175], v[40:43], v[148:151]
    ds_read_b128 a[196:199], v15 offset:6272
    v_mfma_f32_16x16x32_bf16 v[148:151], a[176:179], v[44:47], v[148:151]
    ds_read_b128 a[200:203], v14 offset:6400
    v_mfma_f32_16x16x32_bf16 v[148:151], a[180:183], v[48:51], v[148:151]
    ds_read_b128 a[204:207], v15 offset:6400
    v_mfma_f32_16x16x32_bf16 v[152:155], a[160:163], v[52:55], 0
    s_cmp_eq_u32 s43, 49152
    s_cselect_b32 s45, s48, s47
    v_mfma_f32_16x16x32_bf16 v[152:155], a[164:167], v[56:59], v[152:155]
    s_add_u32 s43, s43, s45
    v_mfma_f32_16x16x32_bf16 v[152:155], a[168:171], v[60:63], v[152:155]
    v_exp_f32 v100, v100
    v_mfma_f32_16x16x32_bf16 v[152:155], a[172:175], v[64:67], v[152:155]
    v_exp_f32 v101, v101
    v_mfma_f32_16x16x32_bf16 v[152:155], a[176:179], v[68:71], v[152:155]
    v_exp_f32 v102, v102
    v_mfma_f32_16x16x32_bf16 v[152:155], a[180:183], v[72:75], v[152:155]
    v_exp_f32 v103, v103
    v_mfma_f32_16x16x32_bf16 v[156:159], a[160:163], v[76:79], 0
    v_exp_f32 v104, v104
    v_mfma_f32_16x16x32_bf16 v[156:159], a[164:167], v[80:83], v[156:159]
    v_exp_f32 v105, v105
    v_mfma_f32_16x16x32_bf16 v[156:159], a[168:171], v[84:87], v[156:159]
    v_exp_f32 v106, v106
    v_mfma_f32_16x16x32_bf16 v[156:159], a[172:175], v[88:91], v[156:159]
    v_exp_f32 v107, v107
    v_mfma_f32_16x16x32_bf16 v[156:159], a[176:179], v[92:95], v[156:159]
    v_exp_f32 v108, v108
    v_mfma_f32_16x16x32_bf16 v[156:159], a[180:183], v[96:99], v[156:159]
    buffer_load_dwordx4 v9, s[16:19], s34 offen offset:1024 nt lds
    s_waitcnt lgkmcnt(0)
    v_mfma_f32_16x16x32_bf16 v[160:163], a[184:187], v[28:31], 0
    ds_read_b128 a[160:163], v14 offset:12288
    v_cvt_pk_bf16_f32 v196, v100, v101
    v_mfma_f32_16x16x32_bf16 v[160:163], a[188:191], v[32:35], v[160:163]
    ds_read_b128 a[164:167], v15 offset:12288
    v_cvt_pk_bf16_f32 v197, v102, v103
    v_mfma_f32_16x16x32_bf16 v[160:163], a[192:195], v[36:39], v[160:163]
    ds_read_b128 a[168:171], v14 offset:12416
    buffer_load_dwordx4 v10, s[16:19], s34 offen offset:2048 nt lds
    v_mfma_f32_16x16x32_bf16 v[160:163], a[196:199], v[40:43], v[160:163]
    ds_read_b128 a[172:175], v15 offset:12416
    s_add_u32 s49, s34, 3072
    v_mfma_f32_16x16x32_bf16 v[160:163], a[200:203], v[44:47], v[160:163]
    ds_read_b128 a[176:179], v14 offset:12544
    v_cvt_pk_bf16_f32 v200, v104, v105
    v_mfma_f32_16x16x32_bf16 v[160:163], a[204:207], v[48:51], v[160:163]
    ds_read_b128 a[180:183], v15 offset:12544
    v_cvt_pk_bf16_f32 v201, v106, v107
    v_mfma_f32_16x16x32_bf16 v[164:167], a[184:187], v[52:55], 0
    v_exp_f32 v109, v109
    v_mfma_f32_16x16x32_bf16 v[164:167], a[188:191], v[56:59], v[164:167]
    v_exp_f32 v110, v110
    v_mfma_f32_16x16x32_bf16 v[164:167], a[192:195], v[60:63], v[164:167]
    v_exp_f32 v111, v111
    v_mfma_f32_16x16x32_bf16 v[164:167], a[196:199], v[64:67], v[164:167]
    v_exp_f32 v112, v112
    v_mfma_f32_16x16x32_bf16 v[164:167], a[200:203], v[68:71], v[164:167]
    v_exp_f32 v113, v113
    v_mfma_f32_16x16x32_bf16 v[164:167], a[204:207], v[72:75], v[164:167]
    v_exp_f32 v114, v114
    v_mfma_f32_16x16x32_bf16 v[168:171], a[184:187], v[76:79], 0
    v_exp_f32 v115, v115
    v_mfma_f32_16x16x32_bf16 v[168:171], a[188:191], v[80:83], v[168:171]
    v_exp_f32 v116, v116
    v_mfma_f32_16x16x32_bf16 v[168:171], a[192:195], v[84:87], v[168:171]
    v_exp_f32 v117, v117
    v_mfma_f32_16x16x32_bf16 v[168:171], a[196:199], v[88:91], v[168:171]
    v_exp_f32 v118, v118
    v_mfma_f32_16x16x32_bf16 v[168:171], a[200:203], v[92:95], v[168:171]
    v_exp_f32 v119, v119
    v_mfma_f32_16x16x32_bf16 v[168:171], a[204:207], v[96:99], v[168:171]
    s_add_u32 m0, s39, 3072
    s_waitcnt lgkmcnt(0)
    v_mfma_f32_16x16x32_bf16 v[172:175], a[160:163], v[28:31], 0
    ds_read_b128 a[184:187], v14 offset:18432
    buffer_load_dwordx4 v8, s[16:19], s49 offen nt lds
    v_mfma_f32_16x16x32_bf16 v[172:175], a[164:167], v[32:35], v[172:175]
    ds_read_b128 a[188:191], v15 offset:18432
    buffer_load_dwordx4 v9, s[16:19], s49 offen offset:1024 nt lds
    v_mfma_f32_16x16x32_bf16 v[172:175], a[168:171], v[36:39], v[172:175]
    ds_read_b128 a[192:195], v14 offset:18560
    v_cvt_pk_bf16_f32 v204, v108, v109
    v_mfma_f32_16x16x32_bf16 v[172:175], a[172:175], v[40:43], v[172:175]
    ds_read_b128 a[196:199], v15 offset:18560
    v_cvt_pk_bf16_f32 v205, v110, v111
    v_mfma_f32_16x16x32_bf16 v[172:175], a[176:179], v[44:47], v[172:175]
    ds_read_b128 a[200:203], v14 offset:18688
    v_cvt_pk_bf16_f32 v198, v112, v113
    v_mfma_f32_16x16x32_bf16 v[172:175], a[180:183], v[48:51], v[172:175]
    ds_read_b128 a[204:207], v15 offset:18688
    v_cvt_pk_bf16_f32 v199, v114, v115
    v_mfma_f32_16x16x32_bf16 v[176:179], a[160:163], v[52:55], 0
    v_exp_f32 v120, v120
    v_mfma_f32_16x16x32_bf16 v[176:179], a[164:167], v[56:59], v[176:179]
    v_exp_f32 v121, v121
    v_mfma_f32_16x16x32_bf16 v[176:179], a[168:171], v[60:63], v[176:179]
    v_exp_f32 v122, v122
    v_mfma_f32_16x16x32_bf16 v[176:179], a[172:175], v[64:67], v[176:179]
    v_exp_f32 v123, v123
    v_mfma_f32_16x16x32_bf16 v[176:179], a[176:179], v[68:71], v[176:179]
    v_exp_f32 v124, v124
    buffer_load_dwordx4 v10, s[16:19], s49 offen offset:2048 nt lds
    v_mfma_f32_16x16x32_bf16 v[176:179], a[180:183], v[72:75], v[176:179]
    v_exp_f32 v125, v125
    s_add_u32 s34, s34, 24576
    v_mfma_f32_16x16x32_bf16 v[180:183], a[160:163], v[76:79], 0
    v_exp_f32 v126, v126
    s_cmp_eq_u32 s39, s41
    s_cselect_b32 s51, s48, s47
    v_mfma_f32_16x16x32_bf16 v[180:183], a[164:167], v[80:83], v[180:183]
    v_exp_f32 v127, v127
    s_add_u32 s39, s39, s51
    v_mfma_f32_16x16x32_bf16 v[180:183], a[168:171], v[84:87], v[180:183]
    v_exp_f32 v128, v128
    v_add_u32 v14, s45, v14
    v_mfma_f32_16x16x32_bf16 v[180:183], a[172:175], v[88:91], v[180:183]
    v_exp_f32 v129, v129
    v_add_u32 v15, s45, v15
    v_mfma_f32_16x16x32_bf16 v[180:183], a[176:179], v[92:95], v[180:183]
    v_exp_f32 v130, v130
    v_mfma_f32_16x16x32_bf16 v[180:183], a[180:183], v[96:99], v[180:183]
    s_waitcnt vmcnt(12) lgkmcnt(0)
    s_barrier
    v_mfma_f32_16x16x32_bf16 v[184:187], a[184:187], v[28:31], 0
    v_exp_f32 v131, v131
    v_mfma_f32_16x16x32_bf16 v[184:187], a[188:191], v[32:35], v[184:187]
    v_exp_f32 v132, v132
    v_mfma_f32_16x16x32_bf16 v[184:187], a[192:195], v[36:39], v[184:187]
    v_exp_f32 v133, v133
    v_mfma_f32_16x16x32_bf16 v[184:187], a[196:199], v[40:43], v[184:187]
    v_exp_f32 v134, v134
    v_mfma_f32_16x16x32_bf16 v[184:187], a[200:203], v[44:47], v[184:187]
    v_exp_f32 v135, v135
    v_mfma_f32_16x16x32_bf16 v[184:187], a[204:207], v[48:51], v[184:187]
    v_exp_f32 v136, v136
    v_mfma_f32_16x16x32_bf16 v[188:191], a[184:187], v[52:55], 0
    v_exp_f32 v137, v137
    v_mfma_f32_16x16x32_bf16 v[188:191], a[188:191], v[56:59], v[188:191]
    v_exp_f32 v138, v138
    v_mfma_f32_16x16x32_bf16 v[188:191], a[192:195], v[60:63], v[188:191]
    v_exp_f32 v139, v139
    v_mfma_f32_16x16x32_bf16 v[188:191], a[196:199], v[64:67], v[188:191]
    v_exp_f32 v140, v140
    v_mfma_f32_16x16x32_bf16 v[188:191], a[200:203], v[68:71], v[188:191]
    v_exp_f32 v141, v141
    v_mfma_f32_16x16x32_bf16 v[188:191], a[204:207], v[72:75], v[188:191]
    v_exp_f32 v142, v142
    v_mfma_f32_16x16x32_bf16 v[192:195], a[184:187], v[76:79], 0
    v_exp_f32 v143, v143
    v_mfma_f32_16x16x32_bf16 v[192:195], a[188:191], v[80:83], v[192:195]
    v_exp_f32 v144, v144
    v_mfma_f32_16x16x32_bf16 v[192:195], a[192:195], v[84:87], v[192:195]
    v_exp_f32 v145, v145
    v_mfma_f32_16x16x32_bf16 v[192:195], a[196:199], v[88:91], v[192:195]
    v_exp_f32 v146, v146
    v_exp_f32 v147, v147
    v_mfma_f32_16x16x32_bf16 v[192:195], a[200:203], v[92:95], v[192:195]
    ds_read_b128 a[160:163], v14 offset:0
    ds_read_b128 a[164:167], v15 offset:0
    ds_read_b128 a[168:171], v14 offset:128
    ds_read_b128 a[172:175], v15 offset:128
    ds_read_b128 a[176:179], v14 offset:256
    ds_read_b128 a[180:183], v15 offset:256
    v_mfma_f32_16x16x32_bf16 v[192:195], a[204:207], v[96:99], v[192:195]
    v_cvt_pk_bf16_f32 v202, v116, v117
    v_cvt_pk_bf16_f32 v203, v118, v119
    v_cvt_pk_bf16_f32 v206, v120, v121
    v_cvt_pk_bf16_f32 v207, v122, v123
    v_cvt_pk_bf16_f32 v208, v124, v125
    v_cvt_pk_bf16_f32 v209, v126, v127
    v_cvt_pk_bf16_f32 v212, v128, v129
    v_cvt_pk_bf16_f32 v213, v130, v131
    v_cvt_pk_bf16_f32 v216, v132, v133
    v_cvt_pk_bf16_f32 v217, v134, v135
    v_cvt_pk_bf16_f32 v210, v136, v137
    v_cvt_pk_bf16_f32 v211, v138, v139
    v_cvt_pk_bf16_f32 v214, v140, v141
    v_cvt_pk_bf16_f32 v215, v142, v143
    v_cvt_pk_bf16_f32 v218, v144, v145
    v_cvt_pk_bf16_f32 v219, v146, v147
    s_cmp_lg_u32 s3, 0
    s_cbranch_scc1 K1_zd1
    s_cmp_lg_u32 s54, 0
    s_cbranch_scc1 K1_zd1
    s_mov_b32 s24, s62
    s_and_b32 s25, s63, 65535
    s_mov_b32 s26, 4
    s_mov_b32 s27, 131072
    v_mov_b32 v2, 0
    v_mov_b32 v3, 1
    s_mov_b64 exec, 1
    buffer_atomic_add v3, v2, s[24:27], 0 offen sc1
    s_mov_b64 exec, -1
K1_zd1:
    s_mov_b32 s24, s16
    s_mov_b32 s25, s17
    s_mov_b32 s26, s18
    s_mov_b32 s36, s34
    s_mov_b32 s37, 3072
    s_mov_b32 s38, 24576
    s_mov_b32 s53, 3
    s_mov_b32 s44, 24576
    v_mov_b32 v11, v8
    v_mov_b32 v12, v9
    v_mov_b32 v13, v10
K1_tl:
    s_waitcnt lgkmcnt(0)
    v_mfma_f32_16x16x32_bf16 v[100:103], a[160:163], v[28:31], 0
    ds_read_b128 a[184:187], v14 offset:6144
    s_mov_b32 m0, s39
    v_mfma_f32_16x16x32_bf16 v[100:103], a[164:167], v[32:35], v[100:103]
    ds_read_b128 a[188:191], v15 offset:6144
    v_mfma_f32_16x16x32_bf16 v[100:103], a[168:171], v[36:39], v[100:103]
    ds_read_b128 a[192:195], v14 offset:6272
    v_mfma_f32_16x16x32_bf16 v[100:103], a[172:175], v[40:43], v[100:103]
    ds_read_b128 a[196:199], v15 offset:6272
    v_mfma_f32_16x16x32_bf16 v[100:103], a[176:179], v[44:47], v[100:103]
    ds_read_b128 a[200:203], v14 offset:6400
    v_mfma_f32_16x16x32_bf16 v[100:103], a[180:183], v[48:51], v[100:103]
    ds_read_b128 a[204:207], v15 offset:6400
    v_mfma_f32_16x16x32_bf16 v[104:107], a[160:163], v[52:55], 0
    s_cmp_eq_u32 s43, 49152
    s_cselect_b32 s45, s48, s47
    v_mfma_f32_16x16x32_bf16 v[104:107], a[164:167], v[56:59], v[104:107]
    s_add_u32 s43, s43, s45
    v_mfma_f32_16x16x32_bf16 v[104:107], a[168:171], v[60:63], v[104:107]
    s_cmp_eq_u32 s44, 49152
    s_cselect_b32 s46, s48, s47
    v_mfma_f32_16x16x32_bf16 v[104:107], a[172:175], v[64:67], v[104:107]
    s_add_u32 s44, s44, s46
    v_mfma_f32_16x16x32_bf16 v[104:107], a[176:179], v[68:71], v[104:107]
    v_exp_f32 v148, v148
    v_mfma_f32_16x16x32_bf16 v[104:107], a[180:183], v[72:75], v[104:107]
    v_exp_f32 v149, v149
    v_mfma_f32_16x16x32_bf16 v[108:111], a[160:163], v[76:79], 0
    v_exp_f32 v150, v150
    v_mfma_f32_16x16x32_bf16 v[108:111], a[164:167], v[80:83], v[108:111]
    v_exp_f32 v151, v151
    v_mfma_f32_16x16x32_bf16 v[108:111], a[168:171], v[84:87], v[108:111]
    v_exp_f32 v152, v152
    v_mfma_f32_16x16x32_bf16 v[108:111], a[172:175], v[88:91], v[108:111]
    v_exp_f32 v153, v153
    v_mfma_f32_16x16x32_bf16 v[108:111], a[176:179], v[92:95], v[108:111]
    buffer_load_dwordx4 v11, s[24:27], s36 offen nt lds
    v_mfma_f32_16x16x32_bf16 v[108:111], a[180:183], v[96:99], v[108:111]
    v_cvt_pk_bf16_f32 v220, v148, v149
    s_waitcnt lgkmcnt(0)
    v_mfma_f32_16x16x32_bf16 v[112:115], a[184:187], v[28:31], 0
    ds_read_b128 a[160:163], v14 offset:12288
    v_cvt_pk_bf16_f32 v221, v150, v151
    v_mfma_f32_16x16x32_bf16 v[112:115], a[188:191], v[32:35], v[112:115]
    ds_read_b128 a[164:167], v15 offset:12288
    v_cvt_pk_bf16_f32 v224, v152, v153
    v_mfma_f32_16x16x32_bf16 v[112:115], a[192:195], v[36:39], v[112:115]
    ds_read_b128 a[168:171], v14 offset:12416
    v_mfma_f32_16x16x32_bf16 v[112:115], a[196:199], v[40:43], v[112:115]
    ds_read_b128 a[172:175], v15 offset:12416
    v_mfma_f32_16x16x32_bf16 v[112:115], a[200:203], v[44:47], v[112:115]
    ds_read_b128 a[176:179], v14 offset:12544
    v_mfma_f32_16x16x32_bf16 v[112:115], a[204:207], v[48:51], v[112:115]
    ds_read_b128 a[180:183], v15 offset:12544
    v_mfma_f32_16x16x32_bf16 v[116:119], a[184:187], v[52:55], 0
    v_exp_f32 v154, v154
    v_mfma_f32_16x16x32_bf16 v[116:119], a[188:191], v[56:59], v[116:119]
    v_exp_f32 v155, v155
    v_mfma_f32_16x16x32_bf16 v[116:119], a[192:195], v[60:63], v[116:119]
    v_exp_f32 v156, v156
    v_mfma_f32_16x16x32_bf16 v[116:119], a[196:199], v[64:67], v[116:119]
    v_exp_f32 v157, v157
    v_mfma_f32_16x16x32_bf16 v[116:119], a[200:203], v[68:71], v[116:119]
    buffer_load_dwordx4 v12, s[24:27], s36 offen offset:1024 nt lds
    v_mfma_f32_16x16x32_bf16 v[116:119], a[204:207], v[72:75], v[116:119]
    v_exp_f32 v158, v158
    v_mfma_f32_16x16x32_bf16 v[120:123], a[184:187], v[76:79], 0
    buffer_load_dwordx4 v13, s[24:27], s36 offen offset:2048 nt lds
    v_mfma_f32_16x16x32_bf16 v[120:123], a[188:191], v[80:83], v[120:123]
    s_add_u32 s49, s36, s37
    s_add_u32 m0, s39, 3072
    v_mfma_f32_16x16x32_bf16 v[120:123], a[192:195], v[84:87], v[120:123]
    v_exp_f32 v159, v159
    v_mfma_f32_16x16x32_bf16 v[120:123], a[196:199], v[88:91], v[120:123]
    buffer_load_dwordx4 v11, s[24:27], s49 offen nt lds
    v_mfma_f32_16x16x32_bf16 v[120:123], a[200:203], v[92:95], v[120:123]
    buffer_load_dwordx4 v12, s[24:27], s49 offen offset:1024 nt lds
    v_mfma_f32_16x16x32_bf16 v[120:123], a[204:207], v[96:99], v[120:123]
    v_cvt_pk_bf16_f32 v225, v154, v155
    s_waitcnt lgkmcnt(0)
    v_mfma_f32_16x16x32_bf16 v[124:127], a[160:163], v[28:31], 0
    ds_read_b128 a[184:187], v14 offset:18432
    v_cvt_pk_bf16_f32 v228, v156, v157
    v_mfma_f32_16x16x32_bf16 v[124:127], a[164:167], v[32:35], v[124:127]
    ds_read_b128 a[188:191], v15 offset:18432
    v_cvt_pk_bf16_f32 v229, v158, v159
    v_mfma_f32_16x16x32_bf16 v[124:127], a[168:171], v[36:39], v[124:127]
    ds_read_b128 a[192:195], v14 offset:18560
    v_mfma_f32_16x16x32_bf16 v[124:127], a[172:175], v[40:43], v[124:127]
    ds_read_b128 a[196:199], v15 offset:18560
    v_mfma_f32_16x16x32_bf16 v[124:127], a[176:179], v[44:47], v[124:127]
    ds_read_b128 a[200:203], v14 offset:18688
    v_mfma_f32_16x16x32_bf16 v[124:127], a[180:183], v[48:51], v[124:127]
    ds_read_b128 a[204:207], v15 offset:18688
    v_mfma_f32_16x16x32_bf16 v[128:131], a[160:163], v[52:55], 0
    v_exp_f32 v160, v160
    v_mfma_f32_16x16x32_bf16 v[128:131], a[164:167], v[56:59], v[128:131]
    v_exp_f32 v161, v161
    v_mfma_f32_16x16x32_bf16 v[128:131], a[168:171], v[60:63], v[128:131]
    v_exp_f32 v162, v162
    v_mfma_f32_16x16x32_bf16 v[128:131], a[172:175], v[64:67], v[128:131]
    v_exp_f32 v163, v163
    v_mfma_f32_16x16x32_bf16 v[128:131], a[176:179], v[68:71], v[128:131]
    buffer_load_dwordx4 v13, s[24:27], s49 offen offset:2048 nt lds
    v_mfma_f32_16x16x32_bf16 v[128:131], a[180:183], v[72:75], v[128:131]
    v_exp_f32 v164, v164
    v_mfma_f32_16x16x32_bf16 v[132:135], a[160:163], v[76:79], 0
    s_add_u32 s36, s36, s38
    v_cvt_pk_bf16_f32 v222, v160, v161
    v_mfma_f32_16x16x32_bf16 v[132:135], a[164:167], v[80:83], v[132:135]
    s_cmp_eq_u32 s39, s41
    s_cselect_b32 s51, s48, s47
    v_mfma_f32_16x16x32_bf16 v[132:135], a[168:171], v[84:87], v[132:135]
    ds_read_b64_tr_b16 a[208:209], v16 offset:0
    v_add_u32 v14, s45, v14
    v_mfma_f32_16x16x32_bf16 v[132:135], a[172:175], v[88:91], v[132:135]
    ds_read_b64_tr_b16 a[210:211], v16 offset:6144
    v_add_u32 v15, s45, v15
    v_mfma_f32_16x16x32_bf16 v[132:135], a[176:179], v[92:95], v[132:135]
    ds_read_b64_tr_b16 a[212:213], v16 offset:12288
    s_add_u32 s39, s39, s51
    v_mfma_f32_16x16x32_bf16 v[132:135], a[180:183], v[96:99], v[132:135]
    ds_read_b64_tr_b16 a[214:215], v16 offset:18432
    s_waitcnt lgkmcnt(4)
    v_mfma_f32_16x16x32_bf16 v[136:139], a[184:187], v[28:31], 0
    ds_read_b64_tr_b16 a[216:217], v17 offset:0
    s_mov_b32 m0, s40
    v_mfma_f32_16x16x32_bf16 v[136:139], a[188:191], v[32:35], v[136:139]
    ds_read_b64_tr_b16 a[218:219], v17 offset:6144
    v_cvt_pk_bf16_f32 v223, v162, v163
    v_mfma_f32_16x16x32_bf16 v[136:139], a[192:195], v[36:39], v[136:139]
    ds_read_b64_tr_b16 a[220:221], v17 offset:12288
    v_mfma_f32_16x16x32_bf16 v[136:139], a[196:199], v[40:43], v[136:139]
    ds_read_b64_tr_b16 a[222:223], v17 offset:18432
    v_mfma_f32_16x16x32_bf16 v[136:139], a[200:203], v[44:47], v[136:139]
    v_exp_f32 v165, v165
    v_mfma_f32_16x16x32_bf16 v[136:139], a[204:207], v[48:51], v[136:139]
    v_exp_f32 v166, v166
    v_mfma_f32_16x16x32_bf16 v[140:143], a[184:187], v[52:55], 0
    ds_read_b64_tr_b16 a[224:225], v18 offset:0
    v_cvt_pk_bf16_f32 v226, v164, v165
    v_mfma_f32_16x16x32_bf16 v[140:143], a[188:191], v[56:59], v[140:143]
    ds_read_b64_tr_b16 a[226:227], v18 offset:6144
    v_mfma_f32_16x16x32_bf16 v[140:143], a[192:195], v[60:63], v[140:143]
    ds_read_b64_tr_b16 a[228:229], v18 offset:12288
    v_mfma_f32_16x16x32_bf16 v[140:143], a[196:199], v[64:67], v[140:143]
    ds_read_b64_tr_b16 a[230:231], v18 offset:18432
    s_waitcnt lgkmcnt(7)
    v_mfma_f32_16x16x32_bf16 v[140:143], a[200:203], v[68:71], v[140:143]
    ds_read_b64_tr_b16 a[232:233], v19 offset:0
    v_mfma_f32_16x16x32_bf16 v[140:143], a[204:207], v[72:75], v[140:143]
    ds_read_b64_tr_b16 a[234:235], v19 offset:6144
    v_mfma_f32_16x16x32_bf16 v[144:147], a[184:187], v[76:79], 0
    ds_read_b64_tr_b16 a[236:237], v19 offset:12288
    v_mfma_f32_16x16x32_bf16 v[144:147], a[188:191], v[80:83], v[144:147]
    ds_read_b64_tr_b16 a[238:239], v19 offset:18432
    v_mfma_f32_16x16x32_bf16 v[144:147], a[192:195], v[84:87], v[144:147]
    v_exp_f32 v167, v167
    v_mfma_f32_16x16x32_bf16 v[144:147], a[196:199], v[88:91], v[144:147]
    v_exp_f32 v168, v168
    v_mfma_f32_16x16x32_bf16 v[144:147], a[200:203], v[92:95], v[144:147]
    v_exp_f32 v169, v169
    v_mfma_f32_16x16x32_bf16 v[144:147], a[204:207], v[96:99], v[144:147]
    v_exp_f32 v170, v170
    v_mfma_f32_16x16x32_bf16 a[144:147], a[156:159], v[196:199], a[144:147]
    v_exp_f32 v171, v171
    v_mfma_f32_16x16x32_bf16 a[144:147], a[156:159], v[208:211], a[144:147]
    v_exp_f32 v172, v172
    v_mfma_f32_16x16x32_bf16 a[148:151], a[156:159], v[200:203], a[148:151]
    v_exp_f32 v173, v173
    v_mfma_f32_16x16x32_bf16 a[148:151], a[156:159], v[212:215], a[148:151]
    buffer_load_dwordx4 v8, s[20:23], s35 offen nt lds
    v_mfma_f32_16x16x32_bf16 a[152:155], a[156:159], v[204:207], a[152:155]
    v_exp_f32 v174, v174
    v_mfma_f32_16x16x32_bf16 a[152:155], a[156:159], v[216:219], a[152:155]
    buffer_load_dwordx4 v9, s[20:23], s35 offen offset:1024 nt lds
    s_waitcnt lgkmcnt(7)
    v_mfma_f32_16x16x32_bf16 a[0:3], a[208:211], v[196:199], a[0:3]
    ds_read_b64_tr_b16 a[240:241], v16 offset:128
    buffer_load_dwordx4 v10, s[20:23], s35 offen offset:2048 nt lds
    v_mfma_f32_16x16x32_bf16 a[0:3], a[212:215], v[208:211], a[0:3]
    ds_read_b64_tr_b16 a[242:243], v16 offset:6272
    s_add_u32 s50, s35, 3072
    v_mfma_f32_16x16x32_bf16 a[4:7], a[208:211], v[200:203], a[4:7]
    ds_read_b64_tr_b16 a[244:245], v16 offset:12416
    s_add_u32 m0, s40, 3072
    v_mfma_f32_16x16x32_bf16 a[4:7], a[212:215], v[212:215], a[4:7]
    ds_read_b64_tr_b16 a[246:247], v16 offset:18560
    buffer_load_dwordx4 v8, s[20:23], s50 offen nt lds
    v_mfma_f32_16x16x32_bf16 a[8:11], a[208:211], v[204:207], a[8:11]
    ds_read_b64_tr_b16 a[248:249], v17 offset:128
    buffer_load_dwordx4 v9, s[20:23], s50 offen offset:1024 nt lds
    v_mfma_f32_16x16x32_bf16 a[8:11], a[212:215], v[216:219], a[8:11]
    ds_read_b64_tr_b16 a[250:251], v17 offset:6272
    buffer_load_dwordx4 v10, s[20:23], s50 offen offset:2048 nt lds
    v_mfma_f32_16x16x32_bf16 a[12:15], a[216:219], v[196:199], a[12:15]
    ds_read_b64_tr_b16 a[252:253], v17 offset:12416
    s_add_u32 s35, s35, 24576
    v_mfma_f32_16x16x32_bf16 a[12:15], a[220:223], v[208:211], a[12:15]
    ds_read_b64_tr_b16 a[254:255], v17 offset:18560
    s_cmp_eq_u32 s40, s42
    s_cselect_b32 s51, s48, s47
    v_mfma_f32_16x16x32_bf16 a[16:19], a[216:219], v[200:203], a[16:19]
    v_exp_f32 v175, v175
    v_mfma_f32_16x16x32_bf16 a[16:19], a[220:223], v[212:215], a[16:19]
    v_exp_f32 v176, v176
    v_mfma_f32_16x16x32_bf16 a[20:23], a[216:219], v[204:207], a[20:23]
    v_exp_f32 v177, v177
    v_mfma_f32_16x16x32_bf16 a[20:23], a[220:223], v[216:219], a[20:23]
    s_add_u32 s40, s40, s51
    s_waitcnt lgkmcnt(7)
    v_mfma_f32_16x16x32_bf16 a[24:27], a[224:227], v[196:199], a[24:27]
    ds_read_b64_tr_b16 a[208:209], v18 offset:128
    v_cvt_pk_bf16_f32 v227, v166, v167
    v_mfma_f32_16x16x32_bf16 a[24:27], a[228:231], v[208:211], a[24:27]
    ds_read_b64_tr_b16 a[210:211], v18 offset:6272
    v_cvt_pk_bf16_f32 v230, v168, v169
    v_mfma_f32_16x16x32_bf16 a[28:31], a[224:227], v[200:203], a[28:31]
    ds_read_b64_tr_b16 a[212:213], v18 offset:12416
    v_cvt_pk_bf16_f32 v231, v170, v171
    v_mfma_f32_16x16x32_bf16 a[28:31], a[228:231], v[212:215], a[28:31]
    ds_read_b64_tr_b16 a[214:215], v18 offset:18560
    v_cvt_pk_bf16_f32 v232, v172, v173
    v_mfma_f32_16x16x32_bf16 a[32:35], a[224:227], v[204:207], a[32:35]
    ds_read_b64_tr_b16 a[216:217], v19 offset:128
    v_cvt_pk_bf16_f32 v233, v174, v175
    v_mfma_f32_16x16x32_bf16 a[32:35], a[228:231], v[216:219], a[32:35]
    ds_read_b64_tr_b16 a[218:219], v19 offset:6272
    v_cvt_pk_bf16_f32 v236, v176, v177
    v_mfma_f32_16x16x32_bf16 a[36:39], a[232:235], v[196:199], a[36:39]
    ds_read_b64_tr_b16 a[220:221], v19 offset:12416
    v_mfma_f32_16x16x32_bf16 a[36:39], a[236:239], v[208:211], a[36:39]
    ds_read_b64_tr_b16 a[222:223], v19 offset:18560
    v_mfma_f32_16x16x32_bf16 a[40:43], a[232:235], v[200:203], a[40:43]
    v_exp_f32 v178, v178
    v_mfma_f32_16x16x32_bf16 a[40:43], a[236:239], v[212:215], a[40:43]
    v_exp_f32 v179, v179
    v_mfma_f32_16x16x32_bf16 a[44:47], a[232:235], v[204:207], a[44:47]
    v_exp_f32 v180, v180
    v_mfma_f32_16x16x32_bf16 a[44:47], a[236:239], v[216:219], a[44:47]
    v_cvt_pk_bf16_f32 v237, v178, v179
    s_waitcnt lgkmcnt(7)
    v_mfma_f32_16x16x32_bf16 a[48:51], a[240:243], v[196:199], a[48:51]
    ds_read_b64_tr_b16 a[224:225], v16 offset:256
    v_mfma_f32_16x16x32_bf16 a[48:51], a[244:247], v[208:211], a[48:51]
    ds_read_b64_tr_b16 a[226:227], v16 offset:6400
    v_mfma_f32_16x16x32_bf16 a[52:55], a[240:243], v[200:203], a[52:55]
    ds_read_b64_tr_b16 a[228:229], v16 offset:12544
    v_mfma_f32_16x16x32_bf16 a[52:55], a[244:247], v[212:215], a[52:55]
    ds_read_b64_tr_b16 a[230:231], v16 offset:18688
    v_mfma_f32_16x16x32_bf16 a[56:59], a[240:243], v[204:207], a[56:59]
    ds_read_b64_tr_b16 a[232:233], v17 offset:256
    v_mfma_f32_16x16x32_bf16 a[56:59], a[244:247], v[216:219], a[56:59]
    ds_read_b64_tr_b16 a[234:235], v17 offset:6400
    v_mfma_f32_16x16x32_bf16 a[60:63], a[248:251], v[196:199], a[60:63]
    ds_read_b64_tr_b16 a[236:237], v17 offset:12544
    v_mfma_f32_16x16x32_bf16 a[60:63], a[252:255], v[208:211], a[60:63]
    ds_read_b64_tr_b16 a[238:239], v17 offset:18688
    v_mfma_f32_16x16x32_bf16 a[64:67], a[248:251], v[200:203], a[64:67]
    v_exp_f32 v181, v181
    v_mfma_f32_16x16x32_bf16 a[64:67], a[252:255], v[212:215], a[64:67]
    v_exp_f32 v182, v182
    v_mfma_f32_16x16x32_bf16 a[68:71], a[248:251], v[204:207], a[68:71]
    v_exp_f32 v183, v183
    v_mfma_f32_16x16x32_bf16 a[68:71], a[252:255], v[216:219], a[68:71]
    v_cvt_pk_bf16_f32 v240, v180, v181
    s_waitcnt lgkmcnt(7)
    v_mfma_f32_16x16x32_bf16 a[72:75], a[208:211], v[196:199], a[72:75]
    ds_read_b64_tr_b16 a[240:241], v18 offset:256
    v_cvt_pk_bf16_f32 v241, v182, v183
    v_mfma_f32_16x16x32_bf16 a[72:75], a[212:215], v[208:211], a[72:75]
    ds_read_b64_tr_b16 a[242:243], v18 offset:6400
    v_mfma_f32_16x16x32_bf16 a[76:79], a[208:211], v[200:203], a[76:79]
    ds_read_b64_tr_b16 a[244:245], v18 offset:12544
    v_mfma_f32_16x16x32_bf16 a[76:79], a[212:215], v[212:215], a[76:79]
    ds_read_b64_tr_b16 a[246:247], v18 offset:18688
    v_mfma_f32_16x16x32_bf16 a[80:83], a[208:211], v[204:207], a[80:83]
    ds_read_b64_tr_b16 a[248:249], v19 offset:256
    v_mfma_f32_16x16x32_bf16 a[80:83], a[212:215], v[216:219], a[80:83]
    ds_read_b64_tr_b16 a[250:251], v19 offset:6400
    v_mfma_f32_16x16x32_bf16 a[84:87], a[216:219], v[196:199], a[84:87]
    ds_read_b64_tr_b16 a[252:253], v19 offset:12544
    v_mfma_f32_16x16x32_bf16 a[84:87], a[220:223], v[208:211], a[84:87]
    ds_read_b64_tr_b16 a[254:255], v19 offset:18688
    v_mfma_f32_16x16x32_bf16 a[88:91], a[216:219], v[200:203], a[88:91]
    v_exp_f32 v184, v184
    v_mfma_f32_16x16x32_bf16 a[88:91], a[220:223], v[212:215], a[88:91]
    v_exp_f32 v185, v185
    v_mfma_f32_16x16x32_bf16 a[92:95], a[216:219], v[204:207], a[92:95]
    v_exp_f32 v186, v186
    v_mfma_f32_16x16x32_bf16 a[92:95], a[220:223], v[216:219], a[92:95]
    v_add_u32 v16, s46, v16
    s_waitcnt lgkmcnt(7)
    v_mfma_f32_16x16x32_bf16 a[96:99], a[224:227], v[196:199], a[96:99]
    v_exp_f32 v187, v187
    v_mfma_f32_16x16x32_bf16 a[96:99], a[228:231], v[208:211], a[96:99]
    s_waitcnt vmcnt(12) lgkmcnt(0)
    s_barrier
    v_mfma_f32_16x16x32_bf16 a[100:103], a[224:227], v[200:203], a[100:103]
    v_exp_f32 v188, v188
    v_mfma_f32_16x16x32_bf16 a[100:103], a[228:231], v[212:215], a[100:103]
    v_exp_f32 v189, v189
    v_mfma_f32_16x16x32_bf16 a[104:107], a[224:227], v[204:207], a[104:107]
    v_exp_f32 v190, v190
    v_mfma_f32_16x16x32_bf16 a[104:107], a[228:231], v[216:219], a[104:107]
    v_exp_f32 v191, v191
    v_mfma_f32_16x16x32_bf16 a[108:111], a[232:235], v[196:199], a[108:111]
    v_exp_f32 v192, v192
    v_mfma_f32_16x16x32_bf16 a[108:111], a[236:239], v[208:211], a[108:111]
    v_exp_f32 v193, v193
    v_mfma_f32_16x16x32_bf16 a[112:115], a[232:235], v[200:203], a[112:115]
    v_add_u32 v17, s46, v17
    v_add_u32 v18, s46, v18
    v_mfma_f32_16x16x32_bf16 a[112:115], a[236:239], v[212:215], a[112:115]
    v_add_u32 v19, s46, v19
    ds_read_b128 a[160:163], v14 offset:0
    v_mfma_f32_16x16x32_bf16 a[116:119], a[232:235], v[204:207], a[116:119]
    v_exp_f32 v194, v194
    v_mfma_f32_16x16x32_bf16 a[116:119], a[236:239], v[216:219], a[116:119]
    ds_read_b128 a[164:167], v15 offset:0
    v_cvt_pk_bf16_f32 v234, v184, v185
    v_mfma_f32_16x16x32_bf16 a[120:123], a[240:243], v[196:199], a[120:123]
    ds_read_b128 a[168:171], v14 offset:128
    v_cvt_pk_bf16_f32 v235, v186, v187
    v_mfma_f32_16x16x32_bf16 a[120:123], a[244:247], v[208:211], a[120:123]
    v_exp_f32 v195, v195
    v_mfma_f32_16x16x32_bf16 a[124:127], a[240:243], v[200:203], a[124:127]
    ds_read_b128 a[172:175], v15 offset:128
    v_cvt_pk_bf16_f32 v238, v188, v189
    v_mfma_f32_16x16x32_bf16 a[124:127], a[244:247], v[212:215], a[124:127]
    ds_read_b128 a[176:179], v14 offset:256
    v_cvt_pk_bf16_f32 v239, v190, v191
    v_mfma_f32_16x16x32_bf16 a[128:131], a[240:243], v[204:207], a[128:131]
    ds_read_b128 a[180:183], v15 offset:256
    v_cvt_pk_bf16_f32 v242, v192, v193
    v_mfma_f32_16x16x32_bf16 a[128:131], a[244:247], v[216:219], a[128:131]
    v_cvt_pk_bf16_f32 v243, v194, v195
    v_mfma_f32_16x16x32_bf16 a[132:135], a[248:251], v[196:199], a[132:135]
    v_mfma_f32_16x16x32_bf16 a[132:135], a[252:255], v[208:211], a[132:135]
    v_mfma_f32_16x16x32_bf16 a[136:139], a[248:251], v[200:203], a[136:139]
    v_mfma_f32_16x16x32_bf16 a[136:139], a[252:255], v[212:215], a[136:139]
    v_mfma_f32_16x16x32_bf16 a[140:143], a[248:251], v[204:207], a[140:143]
    v_mfma_f32_16x16x32_bf16 a[140:143], a[252:255], v[216:219], a[140:143]
    s_waitcnt lgkmcnt(0)
    v_mfma_f32_16x16x32_bf16 v[148:151], a[160:163], v[28:31], 0
    ds_read_b128 a[184:187], v14 offset:6144
    s_mov_b32 m0, s39
    v_mfma_f32_16x16x32_bf16 v[148:151], a[164:167], v[32:35], v[148:151]
    ds_read_b128 a[188:191], v15 offset:6144
    v_mfma_f32_16x16x32_bf16 v[148:151], a[168:171], v[36:39], v[148:151]
    ds_read_b128 a[192:195], v14 offset:6272
    v_mfma_f32_16x16x32_bf16 v[148:151], a[172:175], v[40:43], v[148:151]
    ds_read_b128 a[196:199], v15 offset:6272
    v_mfma_f32_16x16x32_bf16 v[148:151], a[176:179], v[44:47], v[148:151]
    ds_read_b128 a[200:203], v14 offset:6400
    v_mfma_f32_16x16x32_bf16 v[148:151], a[180:183], v[48:51], v[148:151]
    ds_read_b128 a[204:207], v15 offset:6400
    v_mfma_f32_16x16x32_bf16 v[152:155], a[160:163], v[52:55], 0
    s_cmp_eq_u32 s43, 49152
    s_cselect_b32 s45, s48, s47
    v_mfma_f32_16x16x32_bf16 v[152:155], a[164:167], v[56:59], v[152:155]
    s_add_u32 s43, s43, s45
    v_mfma_f32_16x16x32_bf16 v[152:155], a[168:171], v[60:63], v[152:155]
    s_cmp_eq_u32 s44, 49152
    s_cselect_b32 s46, s48, s47
    v_mfma_f32_16x16x32_bf16 v[152:155], a[172:175], v[64:67], v[152:155]
    s_add_u32 s44, s44, s46
    v_mfma_f32_16x16x32_bf16 v[152:155], a[176:179], v[68:71], v[152:155]
    v_exp_f32 v100, v100
    v_mfma_f32_16x16x32_bf16 v[152:155], a[180:183], v[72:75], v[152:155]
    v_exp_f32 v101, v101
    v_mfma_f32_16x16x32_bf16 v[156:159], a[160:163], v[76:79], 0
    v_exp_f32 v102, v102
    v_mfma_f32_16x16x32_bf16 v[156:159], a[164:167], v[80:83], v[156:159]
    v_exp_f32 v103, v103
    v_mfma_f32_16x16x32_bf16 v[156:159], a[168:171], v[84:87], v[156:159]
    v_exp_f32 v104, v104
    v_mfma_f32_16x16x32_bf16 v[156:159], a[172:175], v[88:91], v[156:159]
    v_exp_f32 v105, v105
    v_mfma_f32_16x16x32_bf16 v[156:159], a[176:179], v[92:95], v[156:159]
    buffer_load_dwordx4 v11, s[24:27], s36 offen nt lds
    v_mfma_f32_16x16x32_bf16 v[156:159], a[180:183], v[96:99], v[156:159]
    v_cvt_pk_bf16_f32 v196, v100, v101
    s_waitcnt lgkmcnt(0)
    v_mfma_f32_16x16x32_bf16 v[160:163], a[184:187], v[28:31], 0
    ds_read_b128 a[160:163], v14 offset:12288
    v_cvt_pk_bf16_f32 v197, v102, v103
    v_mfma_f32_16x16x32_bf16 v[160:163], a[188:191], v[32:35], v[160:163]
    ds_read_b128 a[164:167], v15 offset:12288
    v_cvt_pk_bf16_f32 v200, v104, v105
    v_mfma_f32_16x16x32_bf16 v[160:163], a[192:195], v[36:39], v[160:163]
    ds_read_b128 a[168:171], v14 offset:12416
    v_mfma_f32_16x16x32_bf16 v[160:163], a[196:199], v[40:43], v[160:163]
    ds_read_b128 a[172:175], v15 offset:12416
    v_mfma_f32_16x16x32_bf16 v[160:163], a[200:203], v[44:47], v[160:163]
    ds_read_b128 a[176:179], v14 offset:12544
    v_mfma_f32_16x16x32_bf16 v[160:163], a[204:207], v[48:51], v[160:163]
    ds_read_b128 a[180:183], v15 offset:12544
    v_mfma_f32_16x16x32_bf16 v[164:167], a[184:187], v[52:55], 0
    v_exp_f32 v106, v106
    v_mfma_f32_16x16x32_bf16 v[164:167], a[188:191], v[56:59], v[164:167]
    v_exp_f32 v107, v107
    v_mfma_f32_16x16x32_bf16 v[164:167], a[192:195], v[60:63], v[164:167]
    v_exp_f32 v108, v108
    v_mfma_f32_16x16x32_bf16 v[164:167], a[196:199], v[64:67], v[164:167]
    v_exp_f32 v109, v109
    v_mfma_f32_16x16x32_bf16 v[164:167], a[200:203], v[68:71], v[164:167]
    buffer_load_dwordx4 v12, s[24:27], s36 offen offset:1024 nt lds
    v_mfma_f32_16x16x32_bf16 v[164:167], a[204:207], v[72:75], v[164:167]
    v_exp_f32 v110, v110
    v_mfma_f32_16x16x32_bf16 v[168:171], a[184:187], v[76:79], 0
    buffer_load_dwordx4 v13, s[24:27], s36 offen offset:2048 nt lds
    v_mfma_f32_16x16x32_bf16 v[168:171], a[188:191], v[80:83], v[168:171]
    s_add_u32 s49, s36, s37
    s_add_u32 m0, s39, 3072
    v_mfma_f32_16x16x32_bf16 v[168:171], a[192:195], v[84:87], v[168:171]
    v_exp_f32 v111, v111
    v_mfma_f32_16x16x32_bf16 v[168:171], a[196:199], v[88:91], v[168:171]
    buffer_load_dwordx4 v11, s[24:27], s49 offen nt lds
    v_mfma_f32_16x16x32_bf16 v[168:171], a[200:203], v[92:95], v[168:171]
    buffer_load_dwordx4 v12, s[24:27], s49 offen offset:1024 nt lds
    v_mfma_f32_16x16x32_bf16 v[168:171], a[204:207], v[96:99], v[168:171]
    v_cvt_pk_bf16_f32 v201, v106, v107
    s_waitcnt lgkmcnt(0)
    v_mfma_f32_16x16x32_bf16 v[172:175], a[160:163], v[28:31], 0
    ds_read_b128 a[184:187], v14 offset:18432
    v_cvt_pk_bf16_f32 v204, v108, v109
    v_mfma_f32_16x16x32_bf16 v[172:175], a[164:167], v[32:35], v[172:175]
    ds_read_b128 a[188:191], v15 offset:18432
    v_cvt_pk_bf16_f32 v205, v110, v111
    v_mfma_f32_16x16x32_bf16 v[172:175], a[168:171], v[36:39], v[172:175]
    ds_read_b128 a[192:195], v14 offset:18560
    v_mfma_f32_16x16x32_bf16 v[172:175], a[172:175], v[40:43], v[172:175]
    ds_read_b128 a[196:199], v15 offset:18560
    v_mfma_f32_16x16x32_bf16 v[172:175], a[176:179], v[44:47], v[172:175]
    ds_read_b128 a[200:203], v14 offset:18688
    v_mfma_f32_16x16x32_bf16 v[172:175], a[180:183], v[48:51], v[172:175]
    ds_read_b128 a[204:207], v15 offset:18688
    v_mfma_f32_16x16x32_bf16 v[176:179], a[160:163], v[52:55], 0
    v_exp_f32 v112, v112
    v_mfma_f32_16x16x32_bf16 v[176:179], a[164:167], v[56:59], v[176:179]
    v_exp_f32 v113, v113
    v_mfma_f32_16x16x32_bf16 v[176:179], a[168:171], v[60:63], v[176:179]
    v_exp_f32 v114, v114
    v_mfma_f32_16x16x32_bf16 v[176:179], a[172:175], v[64:67], v[176:179]
    v_exp_f32 v115, v115
    v_mfma_f32_16x16x32_bf16 v[176:179], a[176:179], v[68:71], v[176:179]
    buffer_load_dwordx4 v13, s[24:27], s49 offen offset:2048 nt lds
    v_mfma_f32_16x16x32_bf16 v[176:179], a[180:183], v[72:75], v[176:179]
    v_exp_f32 v116, v116
    v_mfma_f32_16x16x32_bf16 v[180:183], a[160:163], v[76:79], 0
    s_add_u32 s36, s36, s38
    v_cvt_pk_bf16_f32 v198, v112, v113
    v_mfma_f32_16x16x32_bf16 v[180:183], a[164:167], v[80:83], v[180:183]
    s_cmp_eq_u32 s39, s41
    s_cselect_b32 s51, s48, s47
    v_mfma_f32_16x16x32_bf16 v[180:183], a[168:171], v[84:87], v[180:183]
    ds_read_b64_tr_b16 a[208:209], v16 offset:0
    v_add_u32 v14, s45, v14
    v_mfma_f32_16x16x32_bf16 v[180:183], a[172:175], v[88:91], v[180:183]
    ds_read_b64_tr_b16 a[210:211], v16 offset:6144
    v_add_u32 v15, s45, v15
    v_mfma_f32_16x16x32_bf16 v[180:183], a[176:179], v[92:95], v[180:183]
    ds_read_b64_tr_b16 a[212:213], v16 offset:12288
    s_add_u32 s39, s39, s51
    v_mfma_f32_16x16x32_bf16 v[180:183], a[180:183], v[96:99], v[180:183]
    ds_read_b64_tr_b16 a[214:215], v16 offset:18432
    s_waitcnt lgkmcnt(4)
    v_mfma_f32_16x16x32_bf16 v[184:187], a[184:187], v[28:31], 0
    ds_read_b64_tr_b16 a[216:217], v17 offset:0
    s_mov_b32 m0, s40
    v_mfma_f32_16x16x32_bf16 v[184:187], a[188:191], v[32:35], v[184:187]
    ds_read_b64_tr_b16 a[218:219], v17 offset:6144
    v_cvt_pk_bf16_f32 v199, v114, v115
    v_mfma_f32_16x16x32_bf16 v[184:187], a[192:195], v[36:39], v[184:187]
    ds_read_b64_tr_b16 a[220:221], v17 offset:12288
    v_mfma_f32_16x16x32_bf16 v[184:187], a[196:199], v[40:43], v[184:187]
    ds_read_b64_tr_b16 a[222:223], v17 offset:18432
    v_mfma_f32_16x16x32_bf16 v[184:187], a[200:203], v[44:47], v[184:187]
    v_exp_f32 v117, v117
    v_mfma_f32_16x16x32_bf16 v[184:187], a[204:207], v[48:51], v[184:187]
    v_exp_f32 v118, v118
    v_mfma_f32_16x16x32_bf16 v[188:191], a[184:187], v[52:55], 0
    ds_read_b64_tr_b16 a[224:225], v18 offset:0
    v_cvt_pk_bf16_f32 v202, v116, v117
    v_mfma_f32_16x16x32_bf16 v[188:191], a[188:191], v[56:59], v[188:191]
    ds_read_b64_tr_b16 a[226:227], v18 offset:6144
    v_mfma_f32_16x16x32_bf16 v[188:191], a[192:195], v[60:63], v[188:191]
    ds_read_b64_tr_b16 a[228:229], v18 offset:12288
    v_mfma_f32_16x16x32_bf16 v[188:191], a[196:199], v[64:67], v[188:191]
    ds_read_b64_tr_b16 a[230:231], v18 offset:18432
    s_waitcnt lgkmcnt(7)
    v_mfma_f32_16x16x32_bf16 v[188:191], a[200:203], v[68:71], v[188:191]
    ds_read_b64_tr_b16 a[232:233], v19 offset:0
    v_mfma_f32_16x16x32_bf16 v[188:191], a[204:207], v[72:75], v[188:191]
    ds_read_b64_tr_b16 a[234:235], v19 offset:6144
    v_mfma_f32_16x16x32_bf16 v[192:195], a[184:187], v[76:79], 0
    ds_read_b64_tr_b16 a[236:237], v19 offset:12288
    v_mfma_f32_16x16x32_bf16 v[192:195], a[188:191], v[80:83], v[192:195]
    ds_read_b64_tr_b16 a[238:239], v19 offset:18432
    v_mfma_f32_16x16x32_bf16 v[192:195], a[192:195], v[84:87], v[192:195]
    v_exp_f32 v119, v119
    v_mfma_f32_16x16x32_bf16 v[192:195], a[196:199], v[88:91], v[192:195]
    v_exp_f32 v120, v120
    v_mfma_f32_16x16x32_bf16 v[192:195], a[200:203], v[92:95], v[192:195]
    v_exp_f32 v121, v121
    v_mfma_f32_16x16x32_bf16 v[192:195], a[204:207], v[96:99], v[192:195]
    v_exp_f32 v122, v122
    v_mfma_f32_16x16x32_bf16 a[144:147], a[156:159], v[220:223], a[144:147]
    v_exp_f32 v123, v123
    v_mfma_f32_16x16x32_bf16 a[144:147], a[156:159], v[232:235], a[144:147]
    v_exp_f32 v124, v124
    v_mfma_f32_16x16x32_bf16 a[148:151], a[156:159], v[224:227], a[148:151]
    v_exp_f32 v125, v125
    v_mfma_f32_16x16x32_bf16 a[148:151], a[156:159], v[236:239], a[148:151]
    buffer_load_dwordx4 v8, s[20:23], s35 offen nt lds
    v_mfma_f32_16x16x32_bf16 a[152:155], a[156:159], v[228:231], a[152:155]
    v_exp_f32 v126, v126
    v_mfma_f32_16x16x32_bf16 a[152:155], a[156:159], v[240:243], a[152:155]
    buffer_load_dwordx4 v9, s[20:23], s35 offen offset:1024 nt lds
    s_waitcnt lgkmcnt(7)
    v_mfma_f32_16x16x32_bf16 a[0:3], a[208:211], v[220:223], a[0:3]
    ds_read_b64_tr_b16 a[240:241], v16 offset:128
    buffer_load_dwordx4 v10, s[20:23], s35 offen offset:2048 nt lds
    v_mfma_f32_16x16x32_bf16 a[0:3], a[212:215], v[232:235], a[0:3]
    ds_read_b64_tr_b16 a[242:243], v16 offset:6272
    s_add_u32 s50, s35, 3072
    v_mfma_f32_16x16x32_bf16 a[4:7], a[208:211], v[224:227], a[4:7]
    ds_read_b64_tr_b16 a[244:245], v16 offset:12416
    s_add_u32 m0, s40, 3072
    v_mfma_f32_16x16x32_bf16 a[4:7], a[212:215], v[236:239], a[4:7]
    ds_read_b64_tr_b16 a[246:247], v16 offset:18560
    buffer_load_dwordx4 v8, s[20:23], s50 offen nt lds
    v_mfma_f32_16x16x32_bf16 a[8:11], a[208:211], v[228:231], a[8:11]
    ds_read_b64_tr_b16 a[248:249], v17 offset:128
    buffer_load_dwordx4 v9, s[20:23], s50 offen offset:1024 nt lds
    v_mfma_f32_16x16x32_bf16 a[8:11], a[212:215], v[240:243], a[8:11]
    ds_read_b64_tr_b16 a[250:251], v17 offset:6272
    buffer_load_dwordx4 v10, s[20:23], s50 offen offset:2048 nt lds
    v_mfma_f32_16x16x32_bf16 a[12:15], a[216:219], v[220:223], a[12:15]
    ds_read_b64_tr_b16 a[252:253], v17 offset:12416
    s_add_u32 s35, s35, 24576
    v_mfma_f32_16x16x32_bf16 a[12:15], a[220:223], v[232:235], a[12:15]
    ds_read_b64_tr_b16 a[254:255], v17 offset:18560
    s_cmp_eq_u32 s40, s42
    s_cselect_b32 s51, s48, s47
    v_mfma_f32_16x16x32_bf16 a[16:19], a[216:219], v[224:227], a[16:19]
    v_exp_f32 v127, v127
    v_mfma_f32_16x16x32_bf16 a[16:19], a[220:223], v[236:239], a[16:19]
    v_exp_f32 v128, v128
    v_mfma_f32_16x16x32_bf16 a[20:23], a[216:219], v[228:231], a[20:23]
    v_exp_f32 v129, v129
    v_mfma_f32_16x16x32_bf16 a[20:23], a[220:223], v[240:243], a[20:23]
    s_add_u32 s40, s40, s51
    s_waitcnt lgkmcnt(7)
    v_mfma_f32_16x16x32_bf16 a[24:27], a[224:227], v[220:223], a[24:27]
    ds_read_b64_tr_b16 a[208:209], v18 offset:128
    v_cvt_pk_bf16_f32 v203, v118, v119
    v_mfma_f32_16x16x32_bf16 a[24:27], a[228:231], v[232:235], a[24:27]
    ds_read_b64_tr_b16 a[210:211], v18 offset:6272
    v_cvt_pk_bf16_f32 v206, v120, v121
    v_mfma_f32_16x16x32_bf16 a[28:31], a[224:227], v[224:227], a[28:31]
    ds_read_b64_tr_b16 a[212:213], v18 offset:12416
    v_cvt_pk_bf16_f32 v207, v122, v123
    v_mfma_f32_16x16x32_bf16 a[28:31], a[228:231], v[236:239], a[28:31]
    ds_read_b64_tr_b16 a[214:215], v18 offset:18560
    v_cvt_pk_bf16_f32 v208, v124, v125
    v_mfma_f32_16x16x32_bf16 a[32:35], a[224:227], v[228:231], a[32:35]
    ds_read_b64_tr_b16 a[216:217], v19 offset:128
    v_cvt_pk_bf16_f32 v209, v126, v127
    v_mfma_f32_16x16x32_bf16 a[32:35], a[228:231], v[240:243], a[32:35]
    ds_read_b64_tr_b16 a[218:219], v19 offset:6272
    v_cvt_pk_bf16_f32 v212, v128, v129
    v_mfma_f32_16x16x32_bf16 a[36:39], a[232:235], v[220:223], a[36:39]
    ds_read_b64_tr_b16 a[220:221], v19 offset:12416
    v_mfma_f32_16x16x32_bf16 a[36:39], a[236:239], v[232:235], a[36:39]
    ds_read_b64_tr_b16 a[222:223], v19 offset:18560
    v_mfma_f32_16x16x32_bf16 a[40:43], a[232:235], v[224:227], a[40:43]
    v_exp_f32 v130, v130
    v_mfma_f32_16x16x32_bf16 a[40:43], a[236:239], v[236:239], a[40:43]
    v_exp_f32 v131, v131
    v_mfma_f32_16x16x32_bf16 a[44:47], a[232:235], v[228:231], a[44:47]
    v_exp_f32 v132, v132
    v_mfma_f32_16x16x32_bf16 a[44:47], a[236:239], v[240:243], a[44:47]
    v_cvt_pk_bf16_f32 v213, v130, v131
    s_waitcnt lgkmcnt(7)
    v_mfma_f32_16x16x32_bf16 a[48:51], a[240:243], v[220:223], a[48:51]
    ds_read_b64_tr_b16 a[224:225], v16 offset:256
    v_mfma_f32_16x16x32_bf16 a[48:51], a[244:247], v[232:235], a[48:51]
    ds_read_b64_tr_b16 a[226:227], v16 offset:6400
    v_mfma_f32_16x16x32_bf16 a[52:55], a[240:243], v[224:227], a[52:55]
    ds_read_b64_tr_b16 a[228:229], v16 offset:12544
    v_mfma_f32_16x16x32_bf16 a[52:55], a[244:247], v[236:239], a[52:55]
    ds_read_b64_tr_b16 a[230:231], v16 offset:18688
    v_mfma_f32_16x16x32_bf16 a[56:59], a[240:243], v[228:231], a[56:59]
    ds_read_b64_tr_b16 a[232:233], v17 offset:256
    v_mfma_f32_16x16x32_bf16 a[56:59], a[244:247], v[240:243], a[56:59]
    ds_read_b64_tr_b16 a[234:235], v17 offset:6400
    v_mfma_f32_16x16x32_bf16 a[60:63], a[248:251], v[220:223], a[60:63]
    ds_read_b64_tr_b16 a[236:237], v17 offset:12544
    v_mfma_f32_16x16x32_bf16 a[60:63], a[252:255], v[232:235], a[60:63]
    ds_read_b64_tr_b16 a[238:239], v17 offset:18688
    v_mfma_f32_16x16x32_bf16 a[64:67], a[248:251], v[224:227], a[64:67]
    v_exp_f32 v133, v133
    v_mfma_f32_16x16x32_bf16 a[64:67], a[252:255], v[236:239], a[64:67]
    v_exp_f32 v134, v134
    v_mfma_f32_16x16x32_bf16 a[68:71], a[248:251], v[228:231], a[68:71]
    v_exp_f32 v135, v135
    v_mfma_f32_16x16x32_bf16 a[68:71], a[252:255], v[240:243], a[68:71]
    v_cvt_pk_bf16_f32 v216, v132, v133
    s_waitcnt lgkmcnt(7)
    v_mfma_f32_16x16x32_bf16 a[72:75], a[208:211], v[220:223], a[72:75]
    ds_read_b64_tr_b16 a[240:241], v18 offset:256
    v_cvt_pk_bf16_f32 v217, v134, v135
    v_mfma_f32_16x16x32_bf16 a[72:75], a[212:215], v[232:235], a[72:75]
    ds_read_b64_tr_b16 a[242:243], v18 offset:6400
    v_mfma_f32_16x16x32_bf16 a[76:79], a[208:211], v[224:227], a[76:79]
    ds_read_b64_tr_b16 a[244:245], v18 offset:12544
    v_mfma_f32_16x16x32_bf16 a[76:79], a[212:215], v[236:239], a[76:79]
    ds_read_b64_tr_b16 a[246:247], v18 offset:18688
    v_mfma_f32_16x16x32_bf16 a[80:83], a[208:211], v[228:231], a[80:83]
    ds_read_b64_tr_b16 a[248:249], v19 offset:256
    v_mfma_f32_16x16x32_bf16 a[80:83], a[212:215], v[240:243], a[80:83]
    ds_read_b64_tr_b16 a[250:251], v19 offset:6400
    v_mfma_f32_16x16x32_bf16 a[84:87], a[216:219], v[220:223], a[84:87]
    ds_read_b64_tr_b16 a[252:253], v19 offset:12544
    v_mfma_f32_16x16x32_bf16 a[84:87], a[220:223], v[232:235], a[84:87]
    ds_read_b64_tr_b16 a[254:255], v19 offset:18688
    v_mfma_f32_16x16x32_bf16 a[88:91], a[216:219], v[224:227], a[88:91]
    v_exp_f32 v136, v136
    v_mfma_f32_16x16x32_bf16 a[88:91], a[220:223], v[236:239], a[88:91]
    v_exp_f32 v137, v137
    v_mfma_f32_16x16x32_bf16 a[92:95], a[216:219], v[228:231], a[92:95]
    v_exp_f32 v138, v138
    v_mfma_f32_16x16x32_bf16 a[92:95], a[220:223], v[240:243], a[92:95]
    v_add_u32 v16, s46, v16
    s_waitcnt lgkmcnt(7)
    v_mfma_f32_16x16x32_bf16 a[96:99], a[224:227], v[220:223], a[96:99]
    v_exp_f32 v139, v139
    v_mfma_f32_16x16x32_bf16 a[96:99], a[228:231], v[232:235], a[96:99]
    s_waitcnt vmcnt(12) lgkmcnt(0)
    s_barrier
    v_mfma_f32_16x16x32_bf16 a[100:103], a[224:227], v[224:227], a[100:103]
    v_exp_f32 v140, v140
    v_mfma_f32_16x16x32_bf16 a[100:103], a[228:231], v[236:239], a[100:103]
    v_exp_f32 v141, v141
    v_mfma_f32_16x16x32_bf16 a[104:107], a[224:227], v[228:231], a[104:107]
    v_exp_f32 v142, v142
    v_mfma_f32_16x16x32_bf16 a[104:107], a[228:231], v[240:243], a[104:107]
    v_exp_f32 v143, v143
    v_mfma_f32_16x16x32_bf16 a[108:111], a[232:235], v[220:223], a[108:111]
    v_exp_f32 v144, v144
    v_mfma_f32_16x16x32_bf16 a[108:111], a[236:239], v[232:235], a[108:111]
    v_exp_f32 v145, v145
    v_mfma_f32_16x16x32_bf16 a[112:115], a[232:235], v[224:227], a[112:115]
    v_add_u32 v17, s46, v17
    v_add_u32 v18, s46, v18
    v_mfma_f32_16x16x32_bf16 a[112:115], a[236:239], v[236:239], a[112:115]
    v_add_u32 v19, s46, v19
    ds_read_b128 a[160:163], v14 offset:0
    v_mfma_f32_16x16x32_bf16 a[116:119], a[232:235], v[228:231], a[116:119]
    v_exp_f32 v146, v146
    v_mfma_f32_16x16x32_bf16 a[116:119], a[236:239], v[240:243], a[116:119]
    ds_read_b128 a[164:167], v15 offset:0
    v_cvt_pk_bf16_f32 v210, v136, v137
    v_mfma_f32_16x16x32_bf16 a[120:123], a[240:243], v[220:223], a[120:123]
    ds_read_b128 a[168:171], v14 offset:128
    v_cvt_pk_bf16_f32 v211, v138, v139
    v_mfma_f32_16x16x32_bf16 a[120:123], a[244:247], v[232:235], a[120:123]
    v_exp_f32 v147, v147
    v_mfma_f32_16x16x32_bf16 a[124:127], a[240:243], v[224:227], a[124:127]
    ds_read_b128 a[172:175], v15 offset:128
    v_cvt_pk_bf16_f32 v214, v140, v141
    v_mfma_f32_16x16x32_bf16 a[124:127], a[244:247], v[236:239], a[124:127]
    ds_read_b128 a[176:179], v14 offset:256
    v_cvt_pk_bf16_f32 v215, v142, v143
    v_mfma_f32_16x16x32_bf16 a[128:131], a[240:243], v[228:231], a[128:131]
    ds_read_b128 a[180:183], v15 offset:256
    v_cvt_pk_bf16_f32 v218, v144, v145
    v_mfma_f32_16x16x32_bf16 a[128:131], a[244:247], v[240:243], a[128:131]
    v_cvt_pk_bf16_f32 v219, v146, v147
    v_mfma_f32_16x16x32_bf16 a[132:135], a[248:251], v[220:223], a[132:135]
    v_mfma_f32_16x16x32_bf16 a[132:135], a[252:255], v[232:235], a[132:135]
    v_mfma_f32_16x16x32_bf16 a[136:139], a[248:251], v[224:227], a[136:139]
    v_mfma_f32_16x16x32_bf16 a[136:139], a[252:255], v[236:239], a[136:139]
    v_mfma_f32_16x16x32_bf16 a[140:143], a[248:251], v[228:231], a[140:143]
    v_mfma_f32_16x16x32_bf16 a[140:143], a[252:255], v[240:243], a[140:143]
    s_sub_u32 s53, s53, 1
    s_cmp_eq_u32 s53, 1
    s_cbranch_scc1 K1_tlsw
    s_cmp_lg_u32 s53, 0
    s_cbranch_scc1 K1_tl
    s_mov_b32 s32, 1572864
    s_mov_b32 s33, 0
    s_cmp_eq_u32 s54, 0
    s_cselect_b32 s14, s14, 0
    s_cmp_eq_u32 s54, 0
    s_cbranch_scc0 K1_gt1
    s_cmp_eq_u32 s3, 0
    s_cselect_b32 s72, s8, s12
    s_cselect_b32 s73, s9, s13
    s_cselect_b32 s74, s10, s14
    s_mov_b32 s49, 786432
    s_cselect_b32 s77, s49, 128
    s_mul_i32 s76, s77, 0
    s_cmp_ge_u32 s3, 2
    s_cselect_b32 s74, 0, s74
    s_mov_b32 s75, 131072
    s_branch K1_gt2
K1_gt1:
    s_lshl_b32 s49, s6, 3
    s_add_u32 s49, s49, s7
    s_mul_i32 s49, s49, 2359296
    s_and_b32 s50, s4, 3
    s_mul_i32 s51, s50, 147456
    s_add_u32 s49, s49, s51
    s_add_u32 s64, s94, s49
    s_addc_u32 s65, s95, 0
    s_lshr_b32 s52, s5, 3
    s_mul_i32 s50, s50, 1966080
    s_mul_i32 s51, s52, 320
    s_add_u32 s50, s50, s51
    s_add_u32 s66, s70, s50
    s_addc_u32 s67, s71, 0
    s_mov_b32 s68, 655360
    v_lshlrev_b32 v2, 7, v1
    s_mul_i32 s52, s52, 589824
    v_add_u32 v4, s52, v2
    s_add_u32 s69, s52, 49152
    s_mov_b32 s49, 21846
    v_mul_lo_u32 v3, v1, s49
    v_lshrrev_b32 v3, 16, v3
    v_mul_u32_u24 v2, 3, v3
    v_sub_u32 v2, v1, v2
    v_lshlrev_b32 v2, 7, v2
    s_lshl_b32 s49, s7, 3
    v_add_u32 v3, s49, v3
    s_mov_b32 s50, 1280
    v_mul_lo_u32 v3, v3, s50
    v_add_u32 v5, v3, v2
    s_and_b32 s49, s3, 1
    s_cmp_eq_u32 s49, 1
    s_cselect_b64 s[78:79], -1, 0
    s_cselect_b32 s51, 24, 48
    s_cselect_b32 s72, s66, s64
    s_cselect_b32 s73, s67, s65
    s_cselect_b32 s74, s68, s69
    s_mov_b32 s50, 81920
    s_cselect_b32 s77, s50, 6144
    s_and_b32 s73, s73, 65535
    s_mov_b32 s75, 131072
    v_cndmask_b32 v255, v4, v5, s[78:79]
    v_cmp_gt_u32 vcc, s51, v1
    v_mov_b32 v2, 2130706432
    s_nop 0
    v_cndmask_b32 v255, v2, v255, vcc
    s_lshr_b32 s49, s3, 1
    s_mul_i32 s76, s77, s49
    s_lshl_b32 s77, s77, 1
    v_readfirstlane_b32 s49, v27
    s_nop 0
    s_cmp_lt_u32 s49, 16
    s_cselect_b32 s50, 1, 0
    s_andn2_b32 s50, s50, s3
    s_and_b32 s50, s50, 1
    s_cselect_b32 s74, 0, s74
K1_gt2:
    v_mfma_f32_16x16x32_bf16 a[144:147], a[156:159], v[196:199], a[144:147]
    ds_read_b64_tr_b16 a[208:209], v16 offset:0
    s_mov_b32 m0, s40
    v_mfma_f32_16x16x32_bf16 a[144:147], a[156:159], v[208:211], a[144:147]
    ds_read_b64_tr_b16 a[210:211], v16 offset:6144
    v_mfma_f32_16x16x32_bf16 a[148:151], a[156:159], v[200:203], a[148:151]
    ds_read_b64_tr_b16 a[212:213], v16 offset:12288
    buffer_load_dwordx4 v244, s[12:15], s33 offen lds
    v_mfma_f32_16x16x32_bf16 a[148:151], a[156:159], v[212:215], a[148:151]
    ds_read_b64_tr_b16 a[214:215], v16 offset:18432
    ds_read_b64_tr_b16 a[216:217], v17 offset:0
    ds_read_b64_tr_b16 a[218:219], v17 offset:6144
    ds_read_b64_tr_b16 a[220:221], v17 offset:12288
    ds_read_b64_tr_b16 a[222:223], v17 offset:18432
    v_mfma_f32_16x16x32_bf16 a[152:155], a[156:159], v[204:207], a[152:155]
    s_cmp_eq_u32 s44, 49152
    s_cselect_b32 s46, s48, s47
    v_mfma_f32_16x16x32_bf16 a[152:155], a[156:159], v[216:219], a[152:155]
    s_add_u32 s44, s44, s46
    s_waitcnt lgkmcnt(0)
    v_mfma_f32_16x16x32_bf16 a[0:3], a[208:211], v[196:199], a[0:3]
    ds_read_b64_tr_b16 a[224:225], v18 offset:0
    v_mfma_f32_16x16x32_bf16 a[0:3], a[212:215], v[208:211], a[0:3]
    ds_read_b64_tr_b16 a[226:227], v18 offset:6144
    v_mfma_f32_16x16x32_bf16 a[4:7], a[208:211], v[200:203], a[4:7]
    ds_read_b64_tr_b16 a[228:229], v18 offset:12288
    v_mfma_f32_16x16x32_bf16 a[4:7], a[212:215], v[212:215], a[4:7]
    ds_read_b64_tr_b16 a[230:231], v18 offset:18432
    v_mfma_f32_16x16x32_bf16 a[8:11], a[208:211], v[204:207], a[8:11]
    ds_read_b64_tr_b16 a[232:233], v19 offset:0
    buffer_load_dword v254, v255, s[72:75], s76 offen sc1
    v_mfma_f32_16x16x32_bf16 a[8:11], a[212:215], v[216:219], a[8:11]
    ds_read_b64_tr_b16 a[234:235], v19 offset:6144
    s_add_u32 s76, s76, s77
    v_mfma_f32_16x16x32_bf16 a[12:15], a[216:219], v[196:199], a[12:15]
    ds_read_b64_tr_b16 a[236:237], v19 offset:12288
    v_mfma_f32_16x16x32_bf16 a[12:15], a[220:223], v[208:211], a[12:15]
    ds_read_b64_tr_b16 a[238:239], v19 offset:18432
    buffer_load_dwordx4 v245, s[12:15], s33 offen offset:1024 lds
    v_mfma_f32_16x16x32_bf16 a[16:19], a[216:219], v[200:203], a[16:19]
    v_exp_f32 v148, v148
    v_mfma_f32_16x16x32_bf16 a[16:19], a[220:223], v[212:215], a[16:19]
    v_exp_f32 v149, v149
    v_mfma_f32_16x16x32_bf16 a[20:23], a[216:219], v[204:207], a[20:23]
    v_exp_f32 v150, v150
    v_mfma_f32_16x16x32_bf16 a[20:23], a[220:223], v[216:219], a[20:23]
    v_cvt_pk_bf16_f32 v220, v148, v149
    s_waitcnt lgkmcnt(0)
    v_mfma_f32_16x16x32_bf16 a[24:27], a[224:227], v[196:199], a[24:27]
    ds_read_b64_tr_b16 a[240:241], v16 offset:128
    v_mfma_f32_16x16x32_bf16 a[24:27], a[228:231], v[208:211], a[24:27]
    ds_read_b64_tr_b16 a[242:243], v16 offset:6272
    v_mfma_f32_16x16x32_bf16 a[28:31], a[224:227], v[200:203], a[28:31]
    ds_read_b64_tr_b16 a[244:245], v16 offset:12416
    v_mfma_f32_16x16x32_bf16 a[28:31], a[228:231], v[212:215], a[28:31]
    ds_read_b64_tr_b16 a[246:247], v16 offset:18560
    v_mfma_f32_16x16x32_bf16 a[32:35], a[224:227], v[204:207], a[32:35]
    ds_read_b64_tr_b16 a[248:249], v17 offset:128
    v_mfma_f32_16x16x32_bf16 a[32:35], a[228:231], v[216:219], a[32:35]
    ds_read_b64_tr_b16 a[250:251], v17 offset:6272
    v_mfma_f32_16x16x32_bf16 a[36:39], a[232:235], v[196:199], a[36:39]
    ds_read_b64_tr_b16 a[252:253], v17 offset:12416
    buffer_load_dwordx4 v246, s[12:15], s33 offen offset:2048 lds
    v_mfma_f32_16x16x32_bf16 a[36:39], a[236:239], v[208:211], a[36:39]
    ds_read_b64_tr_b16 a[254:255], v17 offset:18560
    s_add_u32 s50, s33, 64
    v_mfma_f32_16x16x32_bf16 a[40:43], a[232:235], v[200:203], a[40:43]
    v_exp_f32 v151, v151
    v_mfma_f32_16x16x32_bf16 a[40:43], a[236:239], v[212:215], a[40:43]
    v_exp_f32 v152, v152
    v_mfma_f32_16x16x32_bf16 a[44:47], a[232:235], v[204:207], a[44:47]
    v_exp_f32 v153, v153
    v_mfma_f32_16x16x32_bf16 a[44:47], a[236:239], v[216:219], a[44:47]
    v_cvt_pk_bf16_f32 v221, v150, v151
    s_waitcnt lgkmcnt(0)
    v_mfma_f32_16x16x32_bf16 a[48:51], a[240:243], v[196:199], a[48:51]
    ds_read_b64_tr_b16 a[208:209], v18 offset:128
    v_cvt_pk_bf16_f32 v224, v152, v153
    v_mfma_f32_16x16x32_bf16 a[48:51], a[244:247], v[208:211], a[48:51]
    ds_read_b64_tr_b16 a[210:211], v18 offset:6272
    buffer_load_dword v254, v255, s[72:75], s76 offen sc1
    v_mfma_f32_16x16x32_bf16 a[52:55], a[240:243], v[200:203], a[52:55]
    ds_read_b64_tr_b16 a[212:213], v18 offset:12416
    s_add_u32 s76, s76, s77
    v_mfma_f32_16x16x32_bf16 a[52:55], a[244:247], v[212:215], a[52:55]
    ds_read_b64_tr_b16 a[214:215], v18 offset:18560
    v_mfma_f32_16x16x32_bf16 a[56:59], a[240:243], v[204:207], a[56:59]
    ds_read_b64_tr_b16 a[216:217], v19 offset:128
    s_add_u32 m0, s40, 3072
    v_mfma_f32_16x16x32_bf16 a[56:59], a[244:247], v[216:219], a[56:59]
    ds_read_b64_tr_b16 a[218:219], v19 offset:6272
    v_mfma_f32_16x16x32_bf16 a[60:63], a[248:251], v[196:199], a[60:63]
    ds_read_b64_tr_b16 a[220:221], v19 offset:12416
    buffer_load_dwordx4 v244, s[12:15], s50 offen lds
    v_mfma_f32_16x16x32_bf16 a[60:63], a[252:255], v[208:211], a[60:63]
    ds_read_b64_tr_b16 a[222:223], v19 offset:18560
    v_mfma_f32_16x16x32_bf16 a[64:67], a[248:251], v[200:203], a[64:67]
    v_exp_f32 v154, v154
    v_mfma_f32_16x16x32_bf16 a[64:67], a[252:255], v[212:215], a[64:67]
    v_exp_f32 v155, v155
    v_mfma_f32_16x16x32_bf16 a[68:71], a[248:251], v[204:207], a[68:71]
    v_exp_f32 v156, v156
    v_mfma_f32_16x16x32_bf16 a[68:71], a[252:255], v[216:219], a[68:71]
    v_cvt_pk_bf16_f32 v225, v154, v155
    s_waitcnt lgkmcnt(0)
    v_mfma_f32_16x16x32_bf16 a[72:75], a[208:211], v[196:199], a[72:75]
    ds_read_b64_tr_b16 a[224:225], v16 offset:256
    v_mfma_f32_16x16x32_bf16 a[72:75], a[212:215], v[208:211], a[72:75]
    ds_read_b64_tr_b16 a[226:227], v16 offset:6400
    v_mfma_f32_16x16x32_bf16 a[76:79], a[208:211], v[200:203], a[76:79]
    ds_read_b64_tr_b16 a[228:229], v16 offset:12544
    v_mfma_f32_16x16x32_bf16 a[76:79], a[212:215], v[212:215], a[76:79]
    ds_read_b64_tr_b16 a[230:231], v16 offset:18688
    v_mfma_f32_16x16x32_bf16 a[80:83], a[208:211], v[204:207], a[80:83]
    ds_read_b64_tr_b16 a[232:233], v17 offset:256
    v_mfma_f32_16x16x32_bf16 a[80:83], a[212:215], v[216:219], a[80:83]
    ds_read_b64_tr_b16 a[234:235], v17 offset:6400
    buffer_load_dwordx4 v245, s[12:15], s50 offen offset:1024 lds
    v_mfma_f32_16x16x32_bf16 a[84:87], a[216:219], v[196:199], a[84:87]
    ds_read_b64_tr_b16 a[236:237], v17 offset:12544
    v_mfma_f32_16x16x32_bf16 a[84:87], a[220:223], v[208:211], a[84:87]
    ds_read_b64_tr_b16 a[238:239], v17 offset:18688
    v_mfma_f32_16x16x32_bf16 a[88:91], a[216:219], v[200:203], a[88:91]
    v_exp_f32 v157, v157
    v_mfma_f32_16x16x32_bf16 a[88:91], a[220:223], v[212:215], a[88:91]
    v_exp_f32 v158, v158
    v_mfma_f32_16x16x32_bf16 a[92:95], a[216:219], v[204:207], a[92:95]
    v_exp_f32 v159, v159
    v_mfma_f32_16x16x32_bf16 a[92:95], a[220:223], v[216:219], a[92:95]
    v_cvt_pk_bf16_f32 v228, v156, v157
    s_waitcnt lgkmcnt(0)
    v_mfma_f32_16x16x32_bf16 a[96:99], a[224:227], v[196:199], a[96:99]
    ds_read_b64_tr_b16 a[240:241], v18 offset:256
    v_cvt_pk_bf16_f32 v229, v158, v159
    v_mfma_f32_16x16x32_bf16 a[96:99], a[228:231], v[208:211], a[96:99]
    ds_read_b64_tr_b16 a[242:243], v18 offset:6400
    buffer_load_dword v254, v255, s[72:75], s76 offen sc1
    v_mfma_f32_16x16x32_bf16 a[100:103], a[224:227], v[200:203], a[100:103]
    ds_read_b64_tr_b16 a[244:245], v18 offset:12544
    s_add_u32 s76, s76, s77
    v_mfma_f32_16x16x32_bf16 a[100:103], a[228:231], v[212:215], a[100:103]
    ds_read_b64_tr_b16 a[246:247], v18 offset:18688
    v_mfma_f32_16x16x32_bf16 a[104:107], a[224:227], v[204:207], a[104:107]
    ds_read_b64_tr_b16 a[248:249], v19 offset:256
    buffer_load_dwordx4 v246, s[12:15], s50 offen offset:2048 lds
    v_mfma_f32_16x16x32_bf16 a[104:107], a[228:231], v[216:219], a[104:107]
    ds_read_b64_tr_b16 a[250:251], v19 offset:6400
    s_add_u32 s33, s33, 128
    v_mfma_f32_16x16x32_bf16 a[108:111], a[232:235], v[196:199], a[108:111]
    ds_read_b64_tr_b16 a[252:253], v19 offset:12544
    s_cmp_eq_u32 s40, s42
    s_cselect_b32 s51, s48, s47
    v_mfma_f32_16x16x32_bf16 a[108:111], a[236:239], v[208:211], a[108:111]
    ds_read_b64_tr_b16 a[254:255], v19 offset:18688
    s_add_u32 s40, s40, s51
    v_mfma_f32_16x16x32_bf16 a[112:115], a[232:235], v[200:203], a[112:115]
    v_exp_f32 v160, v160
    v_add_u32 v16, s46, v16
    v_mfma_f32_16x16x32_bf16 a[112:115], a[236:239], v[212:215], a[112:115]
    v_exp_f32 v161, v161
    v_add_u32 v17, s46, v17
    v_mfma_f32_16x16x32_bf16 a[116:119], a[232:235], v[204:207], a[116:119]
    v_exp_f32 v162, v162
    v_add_u32 v18, s46, v18
    v_mfma_f32_16x16x32_bf16 a[116:119], a[236:239], v[216:219], a[116:119]
    v_add_u32 v19, s46, v19
    s_waitcnt vmcnt(9) lgkmcnt(0)
    s_barrier
    v_mfma_f32_16x16x32_bf16 a[120:123], a[240:243], v[196:199], a[120:123]
    v_exp_f32 v163, v163
    v_mfma_f32_16x16x32_bf16 a[120:123], a[244:247], v[208:211], a[120:123]
    v_exp_f32 v164, v164
    v_mfma_f32_16x16x32_bf16 a[124:127], a[240:243], v[200:203], a[124:127]
    v_exp_f32 v165, v165
    v_mfma_f32_16x16x32_bf16 a[124:127], a[244:247], v[212:215], a[124:127]
    v_exp_f32 v166, v166
    v_mfma_f32_16x16x32_bf16 a[128:131], a[240:243], v[204:207], a[128:131]
    v_exp_f32 v167, v167
    v_mfma_f32_16x16x32_bf16 a[128:131], a[244:247], v[216:219], a[128:131]
    v_exp_f32 v168, v168
    v_mfma_f32_16x16x32_bf16 a[132:135], a[248:251], v[196:199], a[132:135]
    v_exp_f32 v169, v169
    v_mfma_f32_16x16x32_bf16 a[132:135], a[252:255], v[208:211], a[132:135]
    v_exp_f32 v170, v170
    v_mfma_f32_16x16x32_bf16 a[136:139], a[248:251], v[200:203], a[136:139]
    v_exp_f32 v171, v171
    v_mfma_f32_16x16x32_bf16 a[136:139], a[252:255], v[212:215], a[136:139]
    v_exp_f32 v172, v172
    v_exp_f32 v173, v173
    v_exp_f32 v174, v174
    v_exp_f32 v175, v175
    v_exp_f32 v176, v176
    v_exp_f32 v177, v177
    v_exp_f32 v178, v178
    v_exp_f32 v179, v179
    v_exp_f32 v180, v180
    v_exp_f32 v181, v181
    v_exp_f32 v182, v182
    v_exp_f32 v183, v183
    v_exp_f32 v184, v184
    v_exp_f32 v185, v185
    v_exp_f32 v186, v186
    v_exp_f32 v187, v187
    v_exp_f32 v188, v188
    v_exp_f32 v189, v189
    v_exp_f32 v190, v190
    v_exp_f32 v191, v191
    v_exp_f32 v192, v192
    v_exp_f32 v193, v193
    v_exp_f32 v194, v194
    v_exp_f32 v195, v195
    v_mfma_f32_16x16x32_bf16 a[140:143], a[248:251], v[204:207], a[140:143]
    ds_read_b64_tr_b16 a[208:209], v16 offset:0
    v_cvt_pk_bf16_f32 v222, v160, v161
    v_cvt_pk_bf16_f32 v223, v162, v163
    v_cvt_pk_bf16_f32 v226, v164, v165
    v_cvt_pk_bf16_f32 v227, v166, v167
    v_cvt_pk_bf16_f32 v230, v168, v169
    v_cvt_pk_bf16_f32 v231, v170, v171
    v_cvt_pk_bf16_f32 v232, v172, v173
    v_mfma_f32_16x16x32_bf16 a[140:143], a[252:255], v[216:219], a[140:143]
    ds_read_b64_tr_b16 a[210:211], v16 offset:6144
    ds_read_b64_tr_b16 a[212:213], v16 offset:12288
    ds_read_b64_tr_b16 a[214:215], v16 offset:18432
    ds_read_b64_tr_b16 a[216:217], v17 offset:0
    ds_read_b64_tr_b16 a[218:219], v17 offset:6144
    ds_read_b64_tr_b16 a[220:221], v17 offset:12288
    ds_read_b64_tr_b16 a[222:223], v17 offset:18432
    v_cvt_pk_bf16_f32 v233, v174, v175
    v_cvt_pk_bf16_f32 v236, v176, v177
    v_cvt_pk_bf16_f32 v237, v178, v179
    v_cvt_pk_bf16_f32 v240, v180, v181
    v_cvt_pk_bf16_f32 v241, v182, v183
    v_cvt_pk_bf16_f32 v234, v184, v185
    v_cvt_pk_bf16_f32 v235, v186, v187
    v_cvt_pk_bf16_f32 v238, v188, v189
    v_cvt_pk_bf16_f32 v239, v190, v191
    v_cvt_pk_bf16_f32 v242, v192, v193
    v_cvt_pk_bf16_f32 v243, v194, v195
    v_mfma_f32_16x16x32_bf16 a[144:147], a[156:159], v[220:223], a[144:147]
    s_mov_b32 m0, s40
    s_waitcnt lgkmcnt(6)
    v_mfma_f32_16x16x32_bf16 a[144:147], a[156:159], v[232:235], a[144:147]
    ds_read_b64_tr_b16 a[224:225], v18 offset:0
    v_mfma_f32_16x16x32_bf16 a[148:151], a[156:159], v[224:227], a[148:151]
    ds_read_b64_tr_b16 a[226:227], v18 offset:6144
    v_mfma_f32_16x16x32_bf16 a[148:151], a[156:159], v[236:239], a[148:151]
    ds_read_b64_tr_b16 a[228:229], v18 offset:12288
    v_mfma_f32_16x16x32_bf16 a[152:155], a[156:159], v[228:231], a[152:155]
    ds_read_b64_tr_b16 a[230:231], v18 offset:18432
    v_mfma_f32_16x16x32_bf16 a[152:155], a[156:159], v[240:243], a[152:155]
    ds_read_b64_tr_b16 a[232:233], v19 offset:0
    s_waitcnt lgkmcnt(5)
    v_mfma_f32_16x16x32_bf16 a[0:3], a[208:211], v[220:223], a[0:3]
    ds_read_b64_tr_b16 a[234:235], v19 offset:6144
    buffer_load_dword v254, v255, s[72:75], s76 offen sc1
    v_mfma_f32_16x16x32_bf16 a[0:3], a[212:215], v[232:235], a[0:3]
    ds_read_b64_tr_b16 a[236:237], v19 offset:12288
    s_add_u32 s76, s76, s77
    v_mfma_f32_16x16x32_bf16 a[4:7], a[208:211], v[224:227], a[4:7]
    ds_read_b64_tr_b16 a[238:239], v19 offset:18432
    v_mfma_f32_16x16x32_bf16 a[4:7], a[212:215], v[236:239], a[4:7]
    s_cmp_eq_u32 s44, 49152
    s_cselect_b32 s46, s48, s47
    v_mfma_f32_16x16x32_bf16 a[8:11], a[208:211], v[228:231], a[8:11]
    s_add_u32 s44, s44, s46
    v_mfma_f32_16x16x32_bf16 a[8:11], a[212:215], v[240:243], a[8:11]
    buffer_load_dwordx4 v244, s[12:15], s33 offen lds
    v_mfma_f32_16x16x32_bf16 a[12:15], a[216:219], v[220:223], a[12:15]
    ds_read_b64_tr_b16 a[240:241], v16 offset:128
    v_mfma_f32_16x16x32_bf16 a[12:15], a[220:223], v[232:235], a[12:15]
    ds_read_b64_tr_b16 a[242:243], v16 offset:6272
    v_mfma_f32_16x16x32_bf16 a[16:19], a[216:219], v[224:227], a[16:19]
    ds_read_b64_tr_b16 a[244:245], v16 offset:12416
    v_mfma_f32_16x16x32_bf16 a[16:19], a[220:223], v[236:239], a[16:19]
    ds_read_b64_tr_b16 a[246:247], v16 offset:18560
    v_mfma_f32_16x16x32_bf16 a[20:23], a[216:219], v[228:231], a[20:23]
    ds_read_b64_tr_b16 a[248:249], v17 offset:128
    v_mfma_f32_16x16x32_bf16 a[20:23], a[220:223], v[240:243], a[20:23]
    ds_read_b64_tr_b16 a[250:251], v17 offset:6272
    s_waitcnt lgkmcnt(5)
    v_mfma_f32_16x16x32_bf16 a[24:27], a[224:227], v[220:223], a[24:27]
    ds_read_b64_tr_b16 a[252:253], v17 offset:12416
    v_mfma_f32_16x16x32_bf16 a[24:27], a[228:231], v[232:235], a[24:27]
    ds_read_b64_tr_b16 a[254:255], v17 offset:18560
    v_mfma_f32_16x16x32_bf16 a[28:31], a[224:227], v[224:227], a[28:31]
    ds_read_b64_tr_b16 a[208:209], v18 offset:128
    v_mfma_f32_16x16x32_bf16 a[28:31], a[228:231], v[236:239], a[28:31]
    ds_read_b64_tr_b16 a[210:211], v18 offset:6272
    v_mfma_f32_16x16x32_bf16 a[32:35], a[224:227], v[228:231], a[32:35]
    ds_read_b64_tr_b16 a[212:213], v18 offset:12416
    v_mfma_f32_16x16x32_bf16 a[32:35], a[228:231], v[240:243], a[32:35]
    ds_read_b64_tr_b16 a[214:215], v18 offset:18560
    v_mfma_f32_16x16x32_bf16 a[36:39], a[232:235], v[220:223], a[36:39]
    ds_read_b64_tr_b16 a[216:217], v19 offset:128
    v_mfma_f32_16x16x32_bf16 a[36:39], a[236:239], v[232:235], a[36:39]
    ds_read_b64_tr_b16 a[218:219], v19 offset:6272
    v_mfma_f32_16x16x32_bf16 a[40:43], a[232:235], v[224:227], a[40:43]
    ds_read_b64_tr_b16 a[220:221], v19 offset:12416
    buffer_load_dword v254, v255, s[72:75], s76 offen sc1
    v_mfma_f32_16x16x32_bf16 a[40:43], a[236:239], v[236:239], a[40:43]
    ds_read_b64_tr_b16 a[222:223], v19 offset:18560
    s_add_u32 s76, s76, s77
    v_mfma_f32_16x16x32_bf16 a[44:47], a[232:235], v[228:231], a[44:47]
    buffer_load_dwordx4 v245, s[12:15], s33 offen offset:1024 lds
    v_mfma_f32_16x16x32_bf16 a[44:47], a[236:239], v[240:243], a[44:47]
    s_waitcnt lgkmcnt(7)
    v_mfma_f32_16x16x32_bf16 a[48:51], a[240:243], v[220:223], a[48:51]
    ds_read_b64_tr_b16 a[224:225], v16 offset:256
    v_mfma_f32_16x16x32_bf16 a[48:51], a[244:247], v[232:235], a[48:51]
    ds_read_b64_tr_b16 a[226:227], v16 offset:6400
    v_mfma_f32_16x16x32_bf16 a[52:55], a[240:243], v[224:227], a[52:55]
    ds_read_b64_tr_b16 a[228:229], v16 offset:12544
    v_mfma_f32_16x16x32_bf16 a[52:55], a[244:247], v[236:239], a[52:55]
    ds_read_b64_tr_b16 a[230:231], v16 offset:18688
    v_mfma_f32_16x16x32_bf16 a[56:59], a[240:243], v[228:231], a[56:59]
    ds_read_b64_tr_b16 a[232:233], v17 offset:256
    v_mfma_f32_16x16x32_bf16 a[56:59], a[244:247], v[240:243], a[56:59]
    ds_read_b64_tr_b16 a[234:235], v17 offset:6400
    v_mfma_f32_16x16x32_bf16 a[60:63], a[248:251], v[220:223], a[60:63]
    ds_read_b64_tr_b16 a[236:237], v17 offset:12544
    v_mfma_f32_16x16x32_bf16 a[60:63], a[252:255], v[232:235], a[60:63]
    ds_read_b64_tr_b16 a[238:239], v17 offset:18688
    v_mfma_f32_16x16x32_bf16 a[64:67], a[248:251], v[224:227], a[64:67]
    buffer_load_dwordx4 v246, s[12:15], s33 offen offset:2048 lds
    v_mfma_f32_16x16x32_bf16 a[64:67], a[252:255], v[236:239], a[64:67]
    s_add_u32 s50, s33, 64
    s_add_u32 m0, s40, 3072
    v_mfma_f32_16x16x32_bf16 a[68:71], a[248:251], v[228:231], a[68:71]
    buffer_load_dwordx4 v244, s[12:15], s50 offen lds
    v_mfma_f32_16x16x32_bf16 a[68:71], a[252:255], v[240:243], a[68:71]
    s_waitcnt lgkmcnt(7)
    v_mfma_f32_16x16x32_bf16 a[72:75], a[208:211], v[220:223], a[72:75]
    ds_read_b64_tr_b16 a[240:241], v18 offset:256
    v_mfma_f32_16x16x32_bf16 a[72:75], a[212:215], v[232:235], a[72:75]
    ds_read_b64_tr_b16 a[242:243], v18 offset:6400
    v_mfma_f32_16x16x32_bf16 a[76:79], a[208:211], v[224:227], a[76:79]
    ds_read_b64_tr_b16 a[244:245], v18 offset:12544
    v_mfma_f32_16x16x32_bf16 a[76:79], a[212:215], v[236:239], a[76:79]
    ds_read_b64_tr_b16 a[246:247], v18 offset:18688
    v_mfma_f32_16x16x32_bf16 a[80:83], a[208:211], v[228:231], a[80:83]
    ds_read_b64_tr_b16 a[248:249], v19 offset:256
    buffer_load_dword v254, v255, s[72:75], s76 offen sc1
    v_mfma_f32_16x16x32_bf16 a[80:83], a[212:215], v[240:243], a[80:83]
    ds_read_b64_tr_b16 a[250:251], v19 offset:6400
    s_add_u32 s76, s76, s77
    v_mfma_f32_16x16x32_bf16 a[84:87], a[216:219], v[220:223], a[84:87]
    ds_read_b64_tr_b16 a[252:253], v19 offset:12544
    v_mfma_f32_16x16x32_bf16 a[84:87], a[220:223], v[232:235], a[84:87]
    ds_read_b64_tr_b16 a[254:255], v19 offset:18688
    v_mfma_f32_16x16x32_bf16 a[88:91], a[216:219], v[224:227], a[88:91]
    buffer_load_dwordx4 v245, s[12:15], s50 offen offset:1024 lds
    v_mfma_f32_16x16x32_bf16 a[88:91], a[220:223], v[236:239], a[88:91]
    buffer_load_dwordx4 v246, s[12:15], s50 offen offset:2048 lds
    s_add_u32 s33, s33, 128
    v_mfma_f32_16x16x32_bf16 a[92:95], a[216:219], v[228:231], a[92:95]
    v_add_u32 v16, 4294844416, v16
    v_add_u32 v17, 4294844416, v17
    s_cmp_eq_u32 s40, s42
    s_cselect_b32 s51, s48, s47
    v_mfma_f32_16x16x32_bf16 a[92:95], a[220:223], v[240:243], a[92:95]
    v_add_u32 v18, 4294844416, v18
    s_add_u32 s40, s40, s51
    s_waitcnt lgkmcnt(7)
    v_mfma_f32_16x16x32_bf16 a[96:99], a[224:227], v[220:223], a[96:99]
    v_add_u32 v19, 4294844416, v19
    v_add_u32 v14, 73728, v251
    v_mfma_f32_16x16x32_bf16 a[96:99], a[228:231], v[232:235], a[96:99]
    s_waitcnt vmcnt(9) lgkmcnt(0)
    s_barrier
    v_mfma_f32_16x16x32_bf16 a[100:103], a[224:227], v[224:227], a[100:103]
    ds_read_b64_tr_b16 a[208:209], v16 offset:0
    v_mfma_f32_16x16x32_bf16 a[100:103], a[228:231], v[236:239], a[100:103]
    ds_read_b64_tr_b16 a[210:211], v16 offset:6144
    v_mfma_f32_16x16x32_bf16 a[104:107], a[224:227], v[228:231], a[104:107]
    ds_read_b64_tr_b16 a[212:213], v16 offset:12288
    v_mfma_f32_16x16x32_bf16 a[104:107], a[228:231], v[240:243], a[104:107]
    ds_read_b64_tr_b16 a[214:215], v16 offset:18432
    v_mfma_f32_16x16x32_bf16 a[108:111], a[232:235], v[220:223], a[108:111]
    ds_read_b64_tr_b16 a[216:217], v17 offset:0
    v_mfma_f32_16x16x32_bf16 a[108:111], a[236:239], v[232:235], a[108:111]
    ds_read_b64_tr_b16 a[218:219], v17 offset:6144
    v_mfma_f32_16x16x32_bf16 a[112:115], a[232:235], v[224:227], a[112:115]
    ds_read_b64_tr_b16 a[220:221], v17 offset:12288
    v_mfma_f32_16x16x32_bf16 a[112:115], a[236:239], v[236:239], a[112:115]
    ds_read_b64_tr_b16 a[222:223], v17 offset:18432
    v_mfma_f32_16x16x32_bf16 a[116:119], a[232:235], v[228:231], a[116:119]
    ds_read_b128 a[160:163], v14 offset:0
    v_mfma_f32_16x16x32_bf16 a[116:119], a[236:239], v[240:243], a[116:119]
    ds_read_b128 a[164:167], v14 offset:1024
    v_mfma_f32_16x16x32_bf16 a[120:123], a[240:243], v[220:223], a[120:123]
    ds_read_b128 a[168:171], v14 offset:2048
    v_mfma_f32_16x16x32_bf16 a[120:123], a[244:247], v[232:235], a[120:123]
    ds_read_b128 a[172:175], v14 offset:3072
    v_mfma_f32_16x16x32_bf16 a[124:127], a[240:243], v[224:227], a[124:127]
    ds_read_b128 a[176:179], v14 offset:4096
    v_mfma_f32_16x16x32_bf16 a[124:127], a[244:247], v[236:239], a[124:127]
    ds_read_b128 a[180:183], v14 offset:5120
    s_waitcnt lgkmcnt(7)
    v_mfma_f32_16x16x32_bf16 a[128:131], a[240:243], v[228:231], a[128:131]
    ds_read_b64_tr_b16 a[224:225], v18 offset:0
    v_mfma_f32_16x16x32_bf16 a[128:131], a[244:247], v[240:243], a[128:131]
    ds_read_b64_tr_b16 a[226:227], v18 offset:6144
    v_mfma_f32_16x16x32_bf16 a[132:135], a[248:251], v[220:223], a[132:135]
    ds_read_b64_tr_b16 a[228:229], v18 offset:12288
    v_mfma_f32_16x16x32_bf16 a[132:135], a[252:255], v[232:235], a[132:135]
    ds_read_b64_tr_b16 a[230:231], v18 offset:18432
    v_mfma_f32_16x16x32_bf16 a[136:139], a[248:251], v[224:227], a[136:139]
    ds_read_b64_tr_b16 a[232:233], v19 offset:0
    v_mfma_f32_16x16x32_bf16 a[136:139], a[252:255], v[236:239], a[136:139]
    ds_read_b64_tr_b16 a[234:235], v19 offset:6144
    v_mfma_f32_16x16x32_bf16 a[140:143], a[248:251], v[228:231], a[140:143]
    ds_read_b64_tr_b16 a[236:237], v19 offset:12288
    v_mfma_f32_16x16x32_bf16 a[140:143], a[252:255], v[240:243], a[140:143]
    ds_read_b64_tr_b16 a[238:239], v19 offset:18432
    s_cmp_eq_u32 s54, 1
    s_cbranch_scc1 K1_fin
    s_mul_i32 s49, s92, 18432
    s_add_u32 s28, s90, s49
    s_addc_u32 s29, s91, 0
    s_and_b32 s29, s29, 65535
    s_mov_b32 s30, 1787904
    s_add_u32 s92, s92, 4
    s_mul_i32 s49, s92, 196608
    s_add_u32 s16, s84, s49
    s_addc_u32 s17, s85, 0
    s_and_b32 s17, s17, 65535
    s_mov_b32 s18, 196608
    s_mul_i32 s49, s92, 196608
    s_add_u32 s20, s86, s49
    s_addc_u32 s21, s87, 0
    s_and_b32 s21, s21, 65535
    s_mov_b32 s22, 196608
    s_mov_b32 s34, 0
    s_mov_b32 s35, 0
    s_mov_b32 s54, 1
    s_mov_b32 s24, s62
    s_and_b32 s25, s63, 65535
    s_mov_b32 s26, 4
    s_mov_b32 s27, 131072
    v_mov_b32 v2, 0
    buffer_load_dword v27, v2, s[24:27], 0 offen sc1
    s_branch K1_item
K1_tlsw:
    s_add_u32 s50, s92, 4
    s_mul_i32 s49, s50, 384
    s_add_u32 s8, s88, s49
    s_addc_u32 s9, s89, 0
    s_and_b32 s9, s9, 65535
    s_sub_u32 s10, 7864320, s49
    s_cmp_eq_u32 s54, 0
    s_cselect_b32 s10, s10, 0
    s_mov_b32 s24, s8
    s_mov_b32 s25, s9
    s_mov_b32 s26, s10
    s_mov_b32 s36, 0
    s_mov_b32 s37, 196608
    s_mov_b32 s38, 786432
    v_mov_b32 v11, v247
    v_mov_b32 v12, v248
    v_mov_b32 v13, v249
    v_mov_b32 v2, 0
    buffer_load_dword v27, v2, s[96:99], s83 offen sc1
    s_branch K1_tl
K1_fin:
    s_nop 7
    v_accvgpr_read_b32 v24, a144
    v_accvgpr_read_b32 v25, a148
    v_accvgpr_read_b32 v26, a152
    v_cmp_nge_f32 vcc, v24, s58
    v_rcp_f32 v21, v24
    s_or_b64 s[60:61], s[60:61], vcc
    v_cmp_nle_f32 vcc, v24, s59
    s_nop 0
    s_or_b64 s[60:61], s[60:61], vcc
    v_cmp_nge_f32 vcc, v25, s58
    v_rcp_f32 v22, v25
    s_or_b64 s[60:61], s[60:61], vcc
    v_cmp_nle_f32 vcc, v25, s59
    s_nop 0
    s_or_b64 s[60:61], s[60:61], vcc
    v_cmp_nge_f32 vcc, v26, s58
    v_rcp_f32 v23, v26
    s_or_b64 s[60:61], s[60:61], vcc
    v_cmp_nle_f32 vcc, v26, s59
    s_nop 0
    s_or_b64 s[60:61], s[60:61], vcc
    v_accvgpr_read_b32 v52, a0
    v_accvgpr_read_b32 v53, a1
    v_accvgpr_read_b32 v54, a2
    v_accvgpr_read_b32 v55, a3
    v_mul_f32 v52, v52, v21
    v_mul_f32 v53, v53, v21
    v_mul_f32 v54, v54, v21
    v_mul_f32 v55, v55, v21
    v_cvt_pk_bf16_f32 v28, v52, v53
    v_cvt_pk_bf16_f32 v29, v54, v55
    v_accvgpr_read_b32 v56, a12
    v_accvgpr_read_b32 v57, a13
    v_accvgpr_read_b32 v58, a14
    v_accvgpr_read_b32 v59, a15
    v_mul_f32 v56, v56, v21
    v_mul_f32 v57, v57, v21
    v_mul_f32 v58, v58, v21
    v_mul_f32 v59, v59, v21
    v_cvt_pk_bf16_f32 v30, v56, v57
    v_cvt_pk_bf16_f32 v31, v58, v59
    s_mov_b32 s52, 0
    buffer_store_dwordx4 v[28:31], v20, s[28:31], s52 offen sc1
    v_accvgpr_read_b32 v60, a4
    v_accvgpr_read_b32 v61, a5
    v_accvgpr_read_b32 v62, a6
    v_accvgpr_read_b32 v63, a7
    v_mul_f32 v60, v60, v22
    v_mul_f32 v61, v61, v22
    v_mul_f32 v62, v62, v22
    v_mul_f32 v63, v63, v22
    v_cvt_pk_bf16_f32 v32, v60, v61
    v_cvt_pk_bf16_f32 v33, v62, v63
    v_accvgpr_read_b32 v64, a16
    v_accvgpr_read_b32 v65, a17
    v_accvgpr_read_b32 v66, a18
    v_accvgpr_read_b32 v67, a19
    v_mul_f32 v64, v64, v22
    v_mul_f32 v65, v65, v22
    v_mul_f32 v66, v66, v22
    v_mul_f32 v67, v67, v22
    v_cvt_pk_bf16_f32 v34, v64, v65
    v_cvt_pk_bf16_f32 v35, v66, v67
    buffer_store_dwordx4 v[32:35], v20, s[28:31], s52 offen offset:1024 sc1
    v_accvgpr_read_b32 v68, a8
    v_accvgpr_read_b32 v69, a9
    v_accvgpr_read_b32 v70, a10
    v_accvgpr_read_b32 v71, a11
    v_mul_f32 v68, v68, v23
    v_mul_f32 v69, v69, v23
    v_mul_f32 v70, v70, v23
    v_mul_f32 v71, v71, v23
    v_cvt_pk_bf16_f32 v36, v68, v69
    v_cvt_pk_bf16_f32 v37, v70, v71
    v_accvgpr_read_b32 v72, a20
    v_accvgpr_read_b32 v73, a21
    v_accvgpr_read_b32 v74, a22
    v_accvgpr_read_b32 v75, a23
    v_mul_f32 v72, v72, v23
    v_mul_f32 v73, v73, v23
    v_mul_f32 v74, v74, v23
    v_mul_f32 v75, v75, v23
    v_cvt_pk_bf16_f32 v38, v72, v73
    v_cvt_pk_bf16_f32 v39, v74, v75
    buffer_store_dwordx4 v[36:39], v20, s[28:31], s52 offen offset:2048 sc1
    v_accvgpr_read_b32 v52, a24
    v_accvgpr_read_b32 v53, a25
    v_accvgpr_read_b32 v54, a26
    v_accvgpr_read_b32 v55, a27
    v_mul_f32 v52, v52, v21
    v_mul_f32 v53, v53, v21
    v_mul_f32 v54, v54, v21
    v_mul_f32 v55, v55, v21
    v_cvt_pk_bf16_f32 v40, v52, v53
    v_cvt_pk_bf16_f32 v41, v54, v55
    v_accvgpr_read_b32 v56, a36
    v_accvgpr_read_b32 v57, a37
    v_accvgpr_read_b32 v58, a38
    v_accvgpr_read_b32 v59, a39
    v_mul_f32 v56, v56, v21
    v_mul_f32 v57, v57, v21
    v_mul_f32 v58, v58, v21
    v_mul_f32 v59, v59, v21
    v_cvt_pk_bf16_f32 v42, v56, v57
    v_cvt_pk_bf16_f32 v43, v58, v59
    buffer_store_dwordx4 v[40:43], v20, s[28:31], s52 offen offset:3072 sc1
    v_accvgpr_read_b32 v60, a28
    v_accvgpr_read_b32 v61, a29
    v_accvgpr_read_b32 v62, a30
    v_accvgpr_read_b32 v63, a31
    v_mul_f32 v60, v60, v22
    v_mul_f32 v61, v61, v22
    v_mul_f32 v62, v62, v22
    v_mul_f32 v63, v63, v22
    v_cvt_pk_bf16_f32 v44, v60, v61
    v_cvt_pk_bf16_f32 v45, v62, v63
    v_accvgpr_read_b32 v64, a40
    v_accvgpr_read_b32 v65, a41
    v_accvgpr_read_b32 v66, a42
    v_accvgpr_read_b32 v67, a43
    v_mul_f32 v64, v64, v22
    v_mul_f32 v65, v65, v22
    v_mul_f32 v66, v66, v22
    v_mul_f32 v67, v67, v22
    v_cvt_pk_bf16_f32 v46, v64, v65
    v_cvt_pk_bf16_f32 v47, v66, v67
    s_mov_b32 s52, 4096
    buffer_store_dwordx4 v[44:47], v20, s[28:31], s52 offen sc1
    v_accvgpr_read_b32 v68, a32
    v_accvgpr_read_b32 v69, a33
    v_accvgpr_read_b32 v70, a34
    v_accvgpr_read_b32 v71, a35
    v_mul_f32 v68, v68, v23
    v_mul_f32 v69, v69, v23
    v_mul_f32 v70, v70, v23
    v_mul_f32 v71, v71, v23
    v_cvt_pk_bf16_f32 v48, v68, v69
    v_cvt_pk_bf16_f32 v49, v70, v71
    v_accvgpr_read_b32 v72, a44
    v_accvgpr_read_b32 v73, a45
    v_accvgpr_read_b32 v74, a46
    v_accvgpr_read_b32 v75, a47
    v_mul_f32 v72, v72, v23
    v_mul_f32 v73, v73, v23
    v_mul_f32 v74, v74, v23
    v_mul_f32 v75, v75, v23
    v_cvt_pk_bf16_f32 v50, v72, v73
    v_cvt_pk_bf16_f32 v51, v74, v75
    buffer_store_dwordx4 v[48:51], v20, s[28:31], s52 offen offset:1024 sc1
    v_accvgpr_read_b32 v52, a48
    v_accvgpr_read_b32 v53, a49
    v_accvgpr_read_b32 v54, a50
    v_accvgpr_read_b32 v55, a51
    v_mul_f32 v52, v52, v21
    v_mul_f32 v53, v53, v21
    v_mul_f32 v54, v54, v21
    v_mul_f32 v55, v55, v21
    v_cvt_pk_bf16_f32 v28, v52, v53
    v_cvt_pk_bf16_f32 v29, v54, v55
    v_accvgpr_read_b32 v56, a60
    v_accvgpr_read_b32 v57, a61
    v_accvgpr_read_b32 v58, a62
    v_accvgpr_read_b32 v59, a63
    v_mul_f32 v56, v56, v21
    v_mul_f32 v57, v57, v21
    v_mul_f32 v58, v58, v21
    v_mul_f32 v59, v59, v21
    v_cvt_pk_bf16_f32 v30, v56, v57
    v_cvt_pk_bf16_f32 v31, v58, v59
    buffer_store_dwordx4 v[28:31], v20, s[28:31], s52 offen offset:2048 sc1
    v_accvgpr_read_b32 v60, a52
    v_accvgpr_read_b32 v61, a53
    v_accvgpr_read_b32 v62, a54
    v_accvgpr_read_b32 v63, a55
    v_mul_f32 v60, v60, v22
    v_mul_f32 v61, v61, v22
    v_mul_f32 v62, v62, v22
    v_mul_f32 v63, v63, v22
    v_cvt_pk_bf16_f32 v32, v60, v61
    v_cvt_pk_bf16_f32 v33, v62, v63
    v_accvgpr_read_b32 v64, a64
    v_accvgpr_read_b32 v65, a65
    v_accvgpr_read_b32 v66, a66
    v_accvgpr_read_b32 v67, a67
    v_mul_f32 v64, v64, v22
    v_mul_f32 v65, v65, v22
    v_mul_f32 v66, v66, v22
    v_mul_f32 v67, v67, v22
    v_cvt_pk_bf16_f32 v34, v64, v65
    v_cvt_pk_bf16_f32 v35, v66, v67
    buffer_store_dwordx4 v[32:35], v20, s[28:31], s52 offen offset:3072 sc1
    v_accvgpr_read_b32 v68, a56
    v_accvgpr_read_b32 v69, a57
    v_accvgpr_read_b32 v70, a58
    v_accvgpr_read_b32 v71, a59
    v_mul_f32 v68, v68, v23
    v_mul_f32 v69, v69, v23
    v_mul_f32 v70, v70, v23
    v_mul_f32 v71, v71, v23
    v_cvt_pk_bf16_f32 v36, v68, v69
    v_cvt_pk_bf16_f32 v37, v70, v71
    v_accvgpr_read_b32 v72, a68
    v_accvgpr_read_b32 v73, a69
    v_accvgpr_read_b32 v74, a70
    v_accvgpr_read_b32 v75, a71
    v_mul_f32 v72, v72, v23
    v_mul_f32 v73, v73, v23
    v_mul_f32 v74, v74, v23
    v_mul_f32 v75, v75, v23
    v_cvt_pk_bf16_f32 v38, v72, v73
    v_cvt_pk_bf16_f32 v39, v74, v75
    s_mov_b32 s52, 8192
    buffer_store_dwordx4 v[36:39], v20, s[28:31], s52 offen sc1
    v_accvgpr_read_b32 v52, a72
    v_accvgpr_read_b32 v53, a73
    v_accvgpr_read_b32 v54, a74
    v_accvgpr_read_b32 v55, a75
    v_mul_f32 v52, v52, v21
    v_mul_f32 v53, v53, v21
    v_mul_f32 v54, v54, v21
    v_mul_f32 v55, v55, v21
    v_cvt_pk_bf16_f32 v40, v52, v53
    v_cvt_pk_bf16_f32 v41, v54, v55
    v_accvgpr_read_b32 v56, a84
    v_accvgpr_read_b32 v57, a85
    v_accvgpr_read_b32 v58, a86
    v_accvgpr_read_b32 v59, a87
    v_mul_f32 v56, v56, v21
    v_mul_f32 v57, v57, v21
    v_mul_f32 v58, v58, v21
    v_mul_f32 v59, v59, v21
    v_cvt_pk_bf16_f32 v42, v56, v57
    v_cvt_pk_bf16_f32 v43, v58, v59
    buffer_store_dwordx4 v[40:43], v20, s[28:31], s52 offen offset:1024 sc1
    v_accvgpr_read_b32 v60, a76
    v_accvgpr_read_b32 v61, a77
    v_accvgpr_read_b32 v62, a78
    v_accvgpr_read_b32 v63, a79
    v_mul_f32 v60, v60, v22
    v_mul_f32 v61, v61, v22
    v_mul_f32 v62, v62, v22
    v_mul_f32 v63, v63, v22
    v_cvt_pk_bf16_f32 v44, v60, v61
    v_cvt_pk_bf16_f32 v45, v62, v63
    v_accvgpr_read_b32 v64, a88
    v_accvgpr_read_b32 v65, a89
    v_accvgpr_read_b32 v66, a90
    v_accvgpr_read_b32 v67, a91
    v_mul_f32 v64, v64, v22
    v_mul_f32 v65, v65, v22
    v_mul_f32 v66, v66, v22
    v_mul_f32 v67, v67, v22
    v_cvt_pk_bf16_f32 v46, v64, v65
    v_cvt_pk_bf16_f32 v47, v66, v67
    buffer_store_dwordx4 v[44:47], v20, s[28:31], s52 offen offset:2048 sc1
    v_accvgpr_read_b32 v68, a80
    v_accvgpr_read_b32 v69, a81
    v_accvgpr_read_b32 v70, a82
    v_accvgpr_read_b32 v71, a83
    v_mul_f32 v68, v68, v23
    v_mul_f32 v69, v69, v23
    v_mul_f32 v70, v70, v23
    v_mul_f32 v71, v71, v23
    v_cvt_pk_bf16_f32 v48, v68, v69
    v_cvt_pk_bf16_f32 v49, v70, v71
    v_accvgpr_read_b32 v72, a92
    v_accvgpr_read_b32 v73, a93
    v_accvgpr_read_b32 v74, a94
    v_accvgpr_read_b32 v75, a95
    v_mul_f32 v72, v72, v23
    v_mul_f32 v73, v73, v23
    v_mul_f32 v74, v74, v23
    v_mul_f32 v75, v75, v23
    v_cvt_pk_bf16_f32 v50, v72, v73
    v_cvt_pk_bf16_f32 v51, v74, v75
    buffer_store_dwordx4 v[48:51], v20, s[28:31], s52 offen offset:3072 sc1
    v_accvgpr_read_b32 v52, a96
    v_accvgpr_read_b32 v53, a97
    v_accvgpr_read_b32 v54, a98
    v_accvgpr_read_b32 v55, a99
    v_mul_f32 v52, v52, v21
    v_mul_f32 v53, v53, v21
    v_mul_f32 v54, v54, v21
    v_mul_f32 v55, v55, v21
    v_cvt_pk_bf16_f32 v28, v52, v53
    v_cvt_pk_bf16_f32 v29, v54, v55
    v_accvgpr_read_b32 v56, a108
    v_accvgpr_read_b32 v57, a109
    v_accvgpr_read_b32 v58, a110
    v_accvgpr_read_b32 v59, a111
    v_mul_f32 v56, v56, v21
    v_mul_f32 v57, v57, v21
    v_mul_f32 v58, v58, v21
    v_mul_f32 v59, v59, v21
    v_cvt_pk_bf16_f32 v30, v56, v57
    v_cvt_pk_bf16_f32 v31, v58, v59
    s_mov_b32 s52, 12288
    buffer_store_dwordx4 v[28:31], v20, s[28:31], s52 offen sc1
    v_accvgpr_read_b32 v60, a100
    v_accvgpr_read_b32 v61, a101
    v_accvgpr_read_b32 v62, a102
    v_accvgpr_read_b32 v63, a103
    v_mul_f32 v60, v60, v22
    v_mul_f32 v61, v61, v22
    v_mul_f32 v62, v62, v22
    v_mul_f32 v63, v63, v22
    v_cvt_pk_bf16_f32 v32, v60, v61
    v_cvt_pk_bf16_f32 v33, v62, v63
    v_accvgpr_read_b32 v64, a112
    v_accvgpr_read_b32 v65, a113
    v_accvgpr_read_b32 v66, a114
    v_accvgpr_read_b32 v67, a115
    v_mul_f32 v64, v64, v22
    v_mul_f32 v65, v65, v22
    v_mul_f32 v66, v66, v22
    v_mul_f32 v67, v67, v22
    v_cvt_pk_bf16_f32 v34, v64, v65
    v_cvt_pk_bf16_f32 v35, v66, v67
    buffer_store_dwordx4 v[32:35], v20, s[28:31], s52 offen offset:1024 sc1
    v_accvgpr_read_b32 v68, a104
    v_accvgpr_read_b32 v69, a105
    v_accvgpr_read_b32 v70, a106
    v_accvgpr_read_b32 v71, a107
    v_mul_f32 v68, v68, v23
    v_mul_f32 v69, v69, v23
    v_mul_f32 v70, v70, v23
    v_mul_f32 v71, v71, v23
    v_cvt_pk_bf16_f32 v36, v68, v69
    v_cvt_pk_bf16_f32 v37, v70, v71
    v_accvgpr_read_b32 v72, a116
    v_accvgpr_read_b32 v73, a117
    v_accvgpr_read_b32 v74, a118
    v_accvgpr_read_b32 v75, a119
    v_mul_f32 v72, v72, v23
    v_mul_f32 v73, v73, v23
    v_mul_f32 v74, v74, v23
    v_mul_f32 v75, v75, v23
    v_cvt_pk_bf16_f32 v38, v72, v73
    v_cvt_pk_bf16_f32 v39, v74, v75
    buffer_store_dwordx4 v[36:39], v20, s[28:31], s52 offen offset:2048 sc1
    v_accvgpr_read_b32 v52, a120
    v_accvgpr_read_b32 v53, a121
    v_accvgpr_read_b32 v54, a122
    v_accvgpr_read_b32 v55, a123
    v_mul_f32 v52, v52, v21
    v_mul_f32 v53, v53, v21
    v_mul_f32 v54, v54, v21
    v_mul_f32 v55, v55, v21
    v_cvt_pk_bf16_f32 v40, v52, v53
    v_cvt_pk_bf16_f32 v41, v54, v55
    v_accvgpr_read_b32 v56, a132
    v_accvgpr_read_b32 v57, a133
    v_accvgpr_read_b32 v58, a134
    v_accvgpr_read_b32 v59, a135
    v_mul_f32 v56, v56, v21
    v_mul_f32 v57, v57, v21
    v_mul_f32 v58, v58, v21
    v_mul_f32 v59, v59, v21
    v_cvt_pk_bf16_f32 v42, v56, v57
    v_cvt_pk_bf16_f32 v43, v58, v59
    buffer_store_dwordx4 v[40:43], v20, s[28:31], s52 offen offset:3072 sc1
    v_accvgpr_read_b32 v60, a124
    v_accvgpr_read_b32 v61, a125
    v_accvgpr_read_b32 v62, a126
    v_accvgpr_read_b32 v63, a127
    v_mul_f32 v60, v60, v22
    v_mul_f32 v61, v61, v22
    v_mul_f32 v62, v62, v22
    v_mul_f32 v63, v63, v22
    v_cvt_pk_bf16_f32 v44, v60, v61
    v_cvt_pk_bf16_f32 v45, v62, v63
    v_accvgpr_read_b32 v64, a136
    v_accvgpr_read_b32 v65, a137
    v_accvgpr_read_b32 v66, a138
    v_accvgpr_read_b32 v67, a139
    v_mul_f32 v64, v64, v22
    v_mul_f32 v65, v65, v22
    v_mul_f32 v66, v66, v22
    v_mul_f32 v67, v67, v22
    v_cvt_pk_bf16_f32 v46, v64, v65
    v_cvt_pk_bf16_f32 v47, v66, v67
    s_mov_b32 s52, 16384
    buffer_store_dwordx4 v[44:47], v20, s[28:31], s52 offen sc1
    v_accvgpr_read_b32 v68, a128
    v_accvgpr_read_b32 v69, a129
    v_accvgpr_read_b32 v70, a130
    v_accvgpr_read_b32 v71, a131
    v_mul_f32 v68, v68, v23
    v_mul_f32 v69, v69, v23
    v_mul_f32 v70, v70, v23
    v_mul_f32 v71, v71, v23
    v_cvt_pk_bf16_f32 v48, v68, v69
    v_cvt_pk_bf16_f32 v49, v70, v71
    v_accvgpr_read_b32 v72, a140
    v_accvgpr_read_b32 v73, a141
    v_accvgpr_read_b32 v74, a142
    v_accvgpr_read_b32 v75, a143
    v_mul_f32 v72, v72, v23
    v_mul_f32 v73, v73, v23
    v_mul_f32 v74, v74, v23
    v_mul_f32 v75, v75, v23
    v_cvt_pk_bf16_f32 v50, v72, v73
    v_cvt_pk_bf16_f32 v51, v74, v75
    buffer_store_dwordx4 v[48:51], v20, s[28:31], s52 offen offset:1024 sc1
    s_cmp_lg_u64 s[60:61], 0
    s_cselect_b32 s49, 2, 0
    s_or_b32 s55, s55, s49
    s_mov_b64 s[60:61], 0
    s_waitcnt vmcnt(0)
    s_mov_b32 s51, 1
    s_cmp_eq_u32 s56, 0
    s_cbranch_scc1 K1_sf0
    s_sub_u32 s51, s92, s82
    s_lshr_b32 s51, s51, 2
    s_branch K1_sf1
K1_sf0:
    s_and_b32 s49, s55, 2
    s_cbranch_scc1 K1_sf2
K1_sf1:
    s_lshl_b32 s49, 1, s51
    s_and_b32 s50, s80, s49
    s_cbranch_scc1 K1_sf2
    s_or_b32 s80, s80, s49
    s_lshl_b32 s49, s51, 14
    s_add_u32 s50, s83, s49
    v_mov_b32 v2, 0
    v_mov_b32 v3, 1
    s_mov_b64 exec, 1
    buffer_atomic_add v3, v2, s[96:99], s50 offen sc1
    s_mov_b64 exec, -1
K1_sf2:
    s_cmp_lg_u32 s56, 0
    s_cbranch_scc1 K1_next
    s_lshl_b32 s49, s3, 2
    s_add_u32 s49, s49, 147456
    v_mov_b32 v2, s49
    v_mov_b32 v3, s55
    ds_write_b32 v2, v3
    s_waitcnt lgkmcnt(0)
    s_barrier
    v_mov_b32 v2, 147456
    ds_read_b128 v[4:7], v2
    s_waitcnt lgkmcnt(0)
    v_or_b32 v4, v4, v5
    v_or_b32 v6, v6, v7
    v_or_b32 v4, v4, v6
    s_nop 0
    v_readfirstlane_b32 s81, v4
    s_sub_u32 s92, s92, 4
    s_mov_b32 s82, s92
K1_next:
    s_cmp_eq_u32 s81, 0
    s_cbranch_scc1 K1_done
    s_and_b32 s49, s81, 1
    s_cmp_lg_u32 s49, 0
    s_cselect_b32 s50, 0, 4
    s_cselect_b32 s49, 1, 2
    s_andn2_b32 s81, s81, s49
    s_add_u32 s92, s82, s50
    s_mov_b32 s56, 1
    s_mov_b32 s54, 1
    s_barrier
    s_branch K1_cold
K1_done:
    s_barrier
    s_load_dwordx2 s[64:65], s[0:1], 32
    s_load_dwordx2 s[66:67], s[0:1], 72
    s_load_dwordx2 s[68:69], s[0:1], 96
    s_load_dwordx2 s[70:71], s[0:1], 80
    s_load_dwordx2 s[72:73], s[0:1], 88
    s_and_b32 s84, s4, 3
    s_and_b32 s7, s5, 7
    s_lshr_b32 s85, s5, 3
    s_mov_b32 s25, 3277
    s_mov_b32 s24, 1280
    v_add_u32 v2, 0, v1
    v_mul_lo_u32 v3, v2, s25
    v_lshrrev_b32 v3, 16, v3
    v_mul_u32_u24 v4, 20, v3
    v_sub_u32 v4, v2, v4
    v_lshrrev_b32 v5, 2, v3
    v_and_b32 v5, 1, v5
    v_lshlrev_b32 v5, 1, v5
    v_xor_b32 v4, v4, v5
    v_lshlrev_b32 v4, 4, v4
    s_lshl_b32 s27, s3, 4
    v_add_u32 v6, s27, v3
    v_mul_lo_u32 v6, v6, s24
    v_add_u32 v8, v6, v4
    v_add_u32 v2, 64, v1
    v_mul_lo_u32 v3, v2, s25
    v_lshrrev_b32 v3, 16, v3
    v_mul_u32_u24 v4, 20, v3
    v_sub_u32 v4, v2, v4
    v_lshrrev_b32 v5, 2, v3
    v_and_b32 v5, 1, v5
    v_lshlrev_b32 v5, 1, v5
    v_xor_b32 v4, v4, v5
    v_lshlrev_b32 v4, 4, v4
    v_subrev_u32 v4, 1024, v4
    s_lshl_b32 s27, s3, 4
    v_add_u32 v6, s27, v3
    v_mul_lo_u32 v6, v6, s24
    v_add_u32 v9, v6, v4
    v_add_u32 v2, 128, v1
    v_mul_lo_u32 v3, v2, s25
    v_lshrrev_b32 v3, 16, v3
    v_mul_u32_u24 v4, 20, v3
    v_sub_u32 v4, v2, v4
    v_lshrrev_b32 v5, 2, v3
    v_and_b32 v5, 1, v5
    v_lshlrev_b32 v5, 1, v5
    v_xor_b32 v4, v4, v5
    v_lshlrev_b32 v4, 4, v4
    v_subrev_u32 v4, 2048, v4
    s_lshl_b32 s27, s3, 4
    v_add_u32 v6, s27, v3
    v_mul_lo_u32 v6, v6, s24
    v_add_u32 v10, v6, v4
    v_add_u32 v2, 192, v1
    v_mul_lo_u32 v3, v2, s25
    v_lshrrev_b32 v3, 16, v3
    v_mul_u32_u24 v4, 20, v3
    v_sub_u32 v4, v2, v4
    v_lshrrev_b32 v5, 2, v3
    v_and_b32 v5, 1, v5
    v_lshlrev_b32 v5, 1, v5
    v_xor_b32 v4, v4, v5
    v_lshlrev_b32 v4, 4, v4
    v_subrev_u32 v4, 3072, v4
    s_lshl_b32 s27, s3, 4
    v_add_u32 v6, s27, v3
    v_mul_lo_u32 v6, v6, s24
    v_add_u32 v11, v6, v4
    v_add_u32 v2, 256, v1
    v_mul_lo_u32 v3, v2, s25
    v_lshrrev_b32 v3, 16, v3
    v_mul_u32_u24 v4, 20, v3
    v_sub_u32 v4, v2, v4
    v_lshrrev_b32 v5, 2, v3
    v_and_b32 v5, 1, v5
    v_lshlrev_b32 v5, 1, v5
    v_xor_b32 v4, v4, v5
    v_lshlrev_b32 v4, 4, v4
    s_lshl_b32 s27, s3, 4
    v_add_u32 v6, s27, v3
    v_mul_lo_u32 v6, v6, s24
    v_add_u32 v12, v6, v4
    v_lshrrev_b32 v3, 2, v1
    s_mov_b32 s24, 320
    v_mul_lo_u32 v6, v3, s24
    v_and_b32 v4, 3, v1
    v_lshlrev_b32 v4, 3, v4
    v_add_u32 v6, v6, v4
    v_lshrrev_b32 v5, 4, v1
    v_and_b32 v5, 1, v5
    v_lshlrev_b32 v5, 5, v5
    v_add_u32 v14, v6, v5
    v_sub_u32 v16, v6, v5
    v_add_u32 v15, 61440, v14
    v_add_u32 v17, 61440, v16
    v_lshlrev_b32 v6, 4, v1
    s_mul_i32 s27, s3, 589824
    v_add_u32 v18, s27, v6
    s_mul_i32 s27, s3, 30720
    v_add_u32 v19, s27, v6
    s_mul_i32 s22, s3, 5120
    s_waitcnt lgkmcnt(0)
    s_cmp_eq_u32 s6, 0
    s_cselect_b32 s64, s64, s66
    s_cselect_b32 s65, s65, s67
    s_mul_i32 s23, s84, 1966080
    s_mul_i32 s24, s85, 320
    s_add_u32 s23, s23, s24
    s_add_u32 s8, s64, s23
    s_addc_u32 s9, s65, 0
    s_and_b32 s9, s9, 65535
    s_sub_u32 s10, 7864320, s23
    s_mov_b32 s11, 131072
    s_lshl_b32 s23, s6, 3
    s_add_u32 s23, s23, s7
    s_mul_i32 s24, s23, 2359296
    s_mul_i32 s25, s84, 147456
    s_add_u32 s24, s24, s25
    s_add_u32 s12, s68, s24
    s_addc_u32 s13, s69, 0
    s_and_b32 s13, s13, 65535
    s_mov_b32 s14, 1916928
    s_mov_b32 s15, 131072
    s_lshl_b32 s23, s23, 2
    s_add_u32 s23, s23, s85
    s_mul_i32 s23, s23, 245760
    s_add_u32 s23, s23, 67108864
    s_add_u32 s16, s68, s23
    s_addc_u32 s17, s69, 0
    s_and_b32 s17, s17, 65535
    s_mov_b32 s18, 245760
    s_mov_b32 s19, 131072
    s_mov_b32 s20, 0
    s_mov_b32 s21, 0
    s_mov_b32 s44, s70
    s_and_b32 s45, s71, 65535
    s_mov_b32 s46, 3932160
    s_mov_b32 s47, 131072
    s_lshl_b32 s23, s6, 3
    s_add_u32 s23, s23, s7
    s_lshl_b32 s23, s23, 2
    s_add_u32 s23, s23, s85
    s_lshl_b32 s23, s23, 8
    s_add_u32 s23, s23, 62914560
    s_add_u32 s40, s68, s23
    s_addc_u32 s41, s69, 0
    s_and_b32 s41, s41, 65535
    s_mov_b32 s42, 4
    s_mov_b32 s43, 131072
    v_mov_b32 v6, 0
G_p0:
    buffer_load_dword v7, v6, s[96:99], s83 offen sc1
    s_waitcnt vmcnt(0)
    v_readfirstlane_b32 s23, v7
    s_nop 0
    s_cmp_ge_u32 s23, 16
    s_cbranch_scc1 G_p0k
    s_sleep 4
    s_branch G_p0
G_p0k:
    v_lshlrev_b32 v2, 7, v1
    s_mul_i32 s23, s85, 589824
    v_add_u32 v4, s23, v2
    s_mov_b32 s23, 21846
    v_mul_lo_u32 v2, v1, s23
    v_lshrrev_b32 v2, 16, v2
    v_mul_u32_u24 v3, 3, v2
    v_sub_u32 v3, v1, v3
    v_lshlrev_b32 v3, 7, v3
    s_lshl_b32 s23, s7, 3
    v_add_u32 v2, s23, v2
    s_mov_b32 s24, 1280
    v_mul_lo_u32 v2, v2, s24
    v_add_u32 v5, v2, v3
    s_cmp_eq_u32 s3, 1
    s_cselect_b64 s[78:79], -1, 0
    s_cselect_b32 s25, 24, 48
    v_cndmask_b32 v13, v4, v5, s[78:79]
    v_cmp_gt_u32 vcc, s25, v1
    v_mov_b32 v3, 2130706432
    s_nop 0
    v_cndmask_b32 v13, v3, v13, vcc
    s_cmp_eq_u32 s3, 1
    s_mul_i32 s24, s85, 589824
    s_add_u32 s24, s24, 147456
    s_cmp_eq_u32 s3, 1
    s_cselect_b32 s32, s8, s12
    s_cselect_b32 s33, s9, s13
    s_cselect_b32 s34, s10, s24
    s_mov_b32 s23, 81920
    s_cselect_b32 s37, s23, 6144
    s_mul_i32 s36, s37, 8
    s_mul_i32 s38, s37, 24
    s_cmp_ge_u32 s3, 2
    s_cselect_b32 s34, 0, s34
    s_mov_b32 s35, 131072
    s_mov_b32 s39, s34
    s_sub_u32 s24, s34, 73728
    s_cmp_eq_u32 s3, 0
    s_cselect_b32 s34, s24, s34
    s_add_u32 m0, s22, 0
    s_nop 0
    buffer_load_dwordx4 v8, s[8:11], s20 offen lds
    buffer_load_dwordx4 v9, s[8:11], s20 offen offset:1024 lds
    buffer_load_dwordx4 v10, s[8:11], s20 offen offset:2048 lds
    buffer_load_dwordx4 v11, s[8:11], s20 offen offset:3072 lds
    s_add_u32 m0, s22, 4096
    s_nop 0
    buffer_load_dwordx4 v12, s[8:11], s20 offen lds
    s_add_u32 s20, s20, 81920
    buffer_load_dwordx4 v[32:35], v18, s[12:15], s21 offen sc1
    buffer_load_dwordx4 v[36:39], v18, s[12:15], s21 offen offset:1024 sc1
    buffer_load_dwordx4 v[40:43], v18, s[12:15], s21 offen offset:2048 sc1
    buffer_load_dwordx4 v[44:47], v18, s[12:15], s21 offen offset:3072 sc1
    s_add_u32 s23, s21, 4096
    buffer_load_dwordx4 v[48:51], v18, s[12:15], s23 offen sc1
    buffer_load_dwordx4 v[52:55], v18, s[12:15], s23 offen offset:1024 sc1
    s_add_u32 s21, s21, 6144
    s_add_u32 m0, s22, 20480
    s_nop 0
    buffer_load_dwordx4 v8, s[8:11], s20 offen lds
    buffer_load_dwordx4 v9, s[8:11], s20 offen offset:1024 lds
    buffer_load_dwordx4 v10, s[8:11], s20 offen offset:2048 lds
    buffer_load_dwordx4 v11, s[8:11], s20 offen offset:3072 lds
    s_add_u32 m0, s22, 24576
    s_nop 0
    buffer_load_dwordx4 v12, s[8:11], s20 offen lds
    s_add_u32 s20, s20, 81920
    buffer_load_dwordx4 v[56:59], v18, s[12:15], s21 offen sc1
    buffer_load_dwordx4 v[60:63], v18, s[12:15], s21 offen offset:1024 sc1
    buffer_load_dwordx4 v[64:67], v18, s[12:15], s21 offen offset:2048 sc1
    buffer_load_dwordx4 v[68:71], v18, s[12:15], s21 offen offset:3072 sc1
    s_add_u32 s23, s21, 4096
    buffer_load_dwordx4 v[72:75], v18, s[12:15], s23 offen sc1
    buffer_load_dwordx4 v[76:79], v18, s[12:15], s23 offen offset:1024 sc1
    s_add_u32 s21, s21, 6144
    s_add_u32 m0, s22, 40960
    s_nop 0
    buffer_load_dwordx4 v8, s[8:11], s20 offen lds
    buffer_load_dwordx4 v9, s[8:11], s20 offen offset:1024 lds
    buffer_load_dwordx4 v10, s[8:11], s20 offen offset:2048 lds
    buffer_load_dwordx4 v11, s[8:11], s20 offen offset:3072 lds
    s_add_u32 m0, s22, 45056
    s_nop 0
    buffer_load_dwordx4 v12, s[8:11], s20 offen lds
    s_add_u32 s20, s20, 81920
    buffer_load_dwordx4 v[80:83], v18, s[12:15], s21 offen sc1
    buffer_load_dwordx4 v[84:87], v18, s[12:15], s21 offen offset:1024 sc1
    buffer_load_dwordx4 v[88:91], v18, s[12:15], s21 offen offset:2048 sc1
    buffer_load_dwordx4 v[92:95], v18, s[12:15], s21 offen offset:3072 sc1
    s_add_u32 s23, s21, 4096
    buffer_load_dwordx4 v[96:99], v18, s[12:15], s23 offen sc1
    buffer_load_dwordx4 v[100:103], v18, s[12:15], s23 offen offset:1024 sc1
    s_add_u32 s21, s21, 6144
    s_waitcnt vmcnt(22)
    s_barrier
    ds_read_b64_tr_b16 a[0:1], v14 offset:0
    ds_read_b64_tr_b16 a[2:3], v14 offset:5120
    ds_read_b64_tr_b16 a[4:5], v14 offset:10240
    ds_read_b64_tr_b16 a[6:7], v14 offset:15360
    ds_read_b64_tr_b16 a[8:9], v16 offset:32
    ds_read_b64_tr_b16 a[10:11], v16 offset:5152
    ds_read_b64_tr_b16 a[12:13], v16 offset:10272
    ds_read_b64_tr_b16 a[14:15], v16 offset:15392
    s_waitcnt lgkmcnt(0)
    v_mfma_f32_16x16x32_bf16 v[128:131], a[0:3], v[32:35], 0
    ds_read_b64_tr_b16 a[16:17], v14 offset:64
    s_add_u32 m0, s22, 61440
    v_mfma_f32_16x16x32_bf16 v[128:131], a[4:7], v[44:47], v[128:131]
    ds_read_b64_tr_b16 a[18:19], v14 offset:5184
    v_mfma_f32_16x16x32_bf16 v[168:171], a[0:3], v[36:39], 0
    ds_read_b64_tr_b16 a[20:21], v14 offset:10304
    v_mfma_f32_16x16x32_bf16 v[168:171], a[4:7], v[48:51], v[168:171]
    ds_read_b64_tr_b16 a[22:23], v14 offset:15424
    v_mfma_f32_16x16x32_bf16 v[208:211], a[0:3], v[40:43], 0
    ds_read_b64_tr_b16 a[24:25], v16 offset:96
    v_mfma_f32_16x16x32_bf16 v[208:211], a[4:7], v[52:55], v[208:211]
    ds_read_b64_tr_b16 a[26:27], v16 offset:5216
    v_mfma_f32_16x16x32_bf16 v[132:135], a[8:11], v[32:35], 0
    ds_read_b64_tr_b16 a[28:29], v16 offset:10336
    v_mfma_f32_16x16x32_bf16 v[132:135], a[12:15], v[44:47], v[132:135]
    ds_read_b64_tr_b16 a[30:31], v16 offset:15456
    v_mfma_f32_16x16x32_bf16 v[172:175], a[8:11], v[36:39], 0
    buffer_load_dwordx4 v8, s[8:11], s20 offen lds
    v_mfma_f32_16x16x32_bf16 v[172:175], a[12:15], v[48:51], v[172:175]
    buffer_load_dwordx4 v9, s[8:11], s20 offen offset:1024 lds
    v_mfma_f32_16x16x32_bf16 v[212:215], a[8:11], v[40:43], 0
    buffer_load_dwordx4 v[104:107], v18, s[12:15], s21 offen sc1
    v_mfma_f32_16x16x32_bf16 v[212:215], a[12:15], v[52:55], v[212:215]
    s_waitcnt lgkmcnt(0)
    v_mfma_f32_16x16x32_bf16 v[136:139], a[16:19], v[32:35], 0
    ds_read_b64_tr_b16 a[0:1], v14 offset:128
    v_mfma_f32_16x16x32_bf16 v[136:139], a[20:23], v[44:47], v[136:139]
    ds_read_b64_tr_b16 a[2:3], v14 offset:5248
    v_mfma_f32_16x16x32_bf16 v[176:179], a[16:19], v[36:39], 0
    ds_read_b64_tr_b16 a[4:5], v14 offset:10368
    v_mfma_f32_16x16x32_bf16 v[176:179], a[20:23], v[48:51], v[176:179]
    ds_read_b64_tr_b16 a[6:7], v14 offset:15488
    v_mfma_f32_16x16x32_bf16 v[216:219], a[16:19], v[40:43], 0
    ds_read_b64_tr_b16 a[8:9], v16 offset:160
    v_mfma_f32_16x16x32_bf16 v[216:219], a[20:23], v[52:55], v[216:219]
    ds_read_b64_tr_b16 a[10:11], v16 offset:5280
    v_mfma_f32_16x16x32_bf16 v[140:143], a[24:27], v[32:35], 0
    ds_read_b64_tr_b16 a[12:13], v16 offset:10400
    v_mfma_f32_16x16x32_bf16 v[140:143], a[28:31], v[44:47], v[140:143]
    ds_read_b64_tr_b16 a[14:15], v16 offset:15520
    v_mfma_f32_16x16x32_bf16 v[180:183], a[24:27], v[36:39], 0
    buffer_load_dwordx4 v10, s[8:11], s20 offen offset:2048 lds
    v_mfma_f32_16x16x32_bf16 v[180:183], a[28:31], v[48:51], v[180:183]
    buffer_load_dwordx4 v[108:111], v18, s[12:15], s21 offen offset:1024 sc1
    v_mfma_f32_16x16x32_bf16 v[220:223], a[24:27], v[40:43], 0
    buffer_load_dwordx4 v[112:115], v18, s[12:15], s21 offen offset:2048 sc1
    v_mfma_f32_16x16x32_bf16 v[220:223], a[28:31], v[52:55], v[220:223]
    s_waitcnt lgkmcnt(0)
    v_mfma_f32_16x16x32_bf16 v[144:147], a[0:3], v[32:35], 0
    ds_read_b64_tr_b16 a[16:17], v14 offset:192
    v_mfma_f32_16x16x32_bf16 v[144:147], a[4:7], v[44:47], v[144:147]
    ds_read_b64_tr_b16 a[18:19], v14 offset:5312
    v_mfma_f32_16x16x32_bf16 v[184:187], a[0:3], v[36:39], 0
    ds_read_b64_tr_b16 a[20:21], v14 offset:10432
    v_mfma_f32_16x16x32_bf16 v[184:187], a[4:7], v[48:51], v[184:187]
    ds_read_b64_tr_b16 a[22:23], v14 offset:15552
    v_mfma_f32_16x16x32_bf16 v[224:227], a[0:3], v[40:43], 0
    ds_read_b64_tr_b16 a[24:25], v16 offset:224
    v_mfma_f32_16x16x32_bf16 v[224:227], a[4:7], v[52:55], v[224:227]
    ds_read_b64_tr_b16 a[26:27], v16 offset:5344
    v_mfma_f32_16x16x32_bf16 v[148:151], a[8:11], v[32:35], 0
    ds_read_b64_tr_b16 a[28:29], v16 offset:10464
    v_mfma_f32_16x16x32_bf16 v[148:151], a[12:15], v[44:47], v[148:151]
    ds_read_b64_tr_b16 a[30:31], v16 offset:15584
    v_mfma_f32_16x16x32_bf16 v[188:191], a[8:11], v[36:39], 0
    buffer_load_dwordx4 v11, s[8:11], s20 offen offset:3072 lds
    v_mfma_f32_16x16x32_bf16 v[188:191], a[12:15], v[48:51], v[188:191]
    s_add_u32 m0, s22, 65536
    v_mfma_f32_16x16x32_bf16 v[228:231], a[8:11], v[40:43], 0
    buffer_load_dwordx4 v[116:119], v18, s[12:15], s21 offen offset:3072 sc1
    v_mfma_f32_16x16x32_bf16 v[228:231], a[12:15], v[52:55], v[228:231]
    s_add_u32 s23, s21, 4096
    s_waitcnt lgkmcnt(0)
    v_mfma_f32_16x16x32_bf16 v[152:155], a[16:19], v[32:35], 0
    ds_read_b64_tr_b16 a[0:1], v14 offset:256
    v_mfma_f32_16x16x32_bf16 v[152:155], a[20:23], v[44:47], v[152:155]
    ds_read_b64_tr_b16 a[2:3], v14 offset:5376
    v_mfma_f32_16x16x32_bf16 v[192:195], a[16:19], v[36:39], 0
    ds_read_b64_tr_b16 a[4:5], v14 offset:10496
    v_mfma_f32_16x16x32_bf16 v[192:195], a[20:23], v[48:51], v[192:195]
    ds_read_b64_tr_b16 a[6:7], v14 offset:15616
    v_mfma_f32_16x16x32_bf16 v[232:235], a[16:19], v[40:43], 0
    ds_read_b64_tr_b16 a[8:9], v16 offset:288
    v_mfma_f32_16x16x32_bf16 v[232:235], a[20:23], v[52:55], v[232:235]
    ds_read_b64_tr_b16 a[10:11], v16 offset:5408
    v_mfma_f32_16x16x32_bf16 v[156:159], a[24:27], v[32:35], 0
    ds_read_b64_tr_b16 a[12:13], v16 offset:10528
    v_mfma_f32_16x16x32_bf16 v[156:159], a[28:31], v[44:47], v[156:159]
    ds_read_b64_tr_b16 a[14:15], v16 offset:15648
    v_mfma_f32_16x16x32_bf16 v[196:199], a[24:27], v[36:39], 0
    buffer_load_dwordx4 v12, s[8:11], s20 offen lds
    v_mfma_f32_16x16x32_bf16 v[196:199], a[28:31], v[48:51], v[196:199]
    s_add_u32 s20, s20, 81920
    v_mfma_f32_16x16x32_bf16 v[236:239], a[24:27], v[40:43], 0
    buffer_load_dwordx4 v[120:123], v18, s[12:15], s23 offen sc1
    buffer_load_dwordx4 v[124:127], v18, s[12:15], s23 offen offset:1024 sc1
    s_add_u32 s21, s21, 6144
    v_mfma_f32_16x16x32_bf16 v[236:239], a[28:31], v[52:55], v[236:239]
    s_waitcnt vmcnt(22) lgkmcnt(0)
    s_barrier
    v_mfma_f32_16x16x32_bf16 v[160:163], a[0:3], v[32:35], 0
    ds_read_b64_tr_b16 a[16:17], v14 offset:20480
    v_mfma_f32_16x16x32_bf16 v[160:163], a[4:7], v[44:47], v[160:163]
    ds_read_b64_tr_b16 a[18:19], v14 offset:25600
    v_mfma_f32_16x16x32_bf16 v[200:203], a[0:3], v[36:39], 0
    ds_read_b64_tr_b16 a[20:21], v14 offset:30720
    v_mfma_f32_16x16x32_bf16 v[200:203], a[4:7], v[48:51], v[200:203]
    ds_read_b64_tr_b16 a[22:23], v14 offset:35840
    v_mfma_f32_16x16x32_bf16 v[240:243], a[0:3], v[40:43], 0
    ds_read_b64_tr_b16 a[24:25], v16 offset:20512
    v_mfma_f32_16x16x32_bf16 v[240:243], a[4:7], v[52:55], v[240:243]
    ds_read_b64_tr_b16 a[26:27], v16 offset:25632
    v_mfma_f32_16x16x32_bf16 v[164:167], a[8:11], v[32:35], 0
    ds_read_b64_tr_b16 a[28:29], v16 offset:30752
    v_mfma_f32_16x16x32_bf16 v[164:167], a[12:15], v[44:47], v[164:167]
    ds_read_b64_tr_b16 a[30:31], v16 offset:35872
    v_mfma_f32_16x16x32_bf16 v[204:207], a[8:11], v[36:39], 0
    buffer_load_dword v254, v13, s[32:35], s36 offen sc1
    v_mfma_f32_16x16x32_bf16 v[204:207], a[12:15], v[48:51], v[204:207]
    s_add_u32 s36, s36, s37
    v_mfma_f32_16x16x32_bf16 v[244:247], a[8:11], v[40:43], 0
    v_mfma_f32_16x16x32_bf16 v[244:247], a[12:15], v[52:55], v[244:247]
    v_mov_b32 v25, 16384
    buffer_load_dword v26, v25, s[96:99], s83 offen offset:0 sc1
    s_waitcnt lgkmcnt(0)
    v_mfma_f32_16x16x32_bf16 v[128:131], a[16:19], v[56:59], v[128:131]
    ds_read_b64_tr_b16 a[0:1], v14 offset:20544
    s_add_u32 m0, s22, 0
    v_mfma_f32_16x16x32_bf16 v[128:131], a[20:23], v[68:71], v[128:131]
    ds_read_b64_tr_b16 a[2:3], v14 offset:25664
    v_mfma_f32_16x16x32_bf16 v[168:171], a[16:19], v[60:63], v[168:171]
    ds_read_b64_tr_b16 a[4:5], v14 offset:30784
    v_mfma_f32_16x16x32_bf16 v[168:171], a[20:23], v[72:75], v[168:171]
    ds_read_b64_tr_b16 a[6:7], v14 offset:35904
    v_mfma_f32_16x16x32_bf16 v[208:211], a[16:19], v[64:67], v[208:211]
    ds_read_b64_tr_b16 a[8:9], v16 offset:20576
    v_mfma_f32_16x16x32_bf16 v[208:211], a[20:23], v[76:79], v[208:211]
    ds_read_b64_tr_b16 a[10:11], v16 offset:25696
    v_mfma_f32_16x16x32_bf16 v[132:135], a[24:27], v[56:59], v[132:135]
    ds_read_b64_tr_b16 a[12:13], v16 offset:30816
    v_mfma_f32_16x16x32_bf16 v[132:135], a[28:31], v[68:71], v[132:135]
    ds_read_b64_tr_b16 a[14:15], v16 offset:35936
    v_mfma_f32_16x16x32_bf16 v[172:175], a[24:27], v[60:63], v[172:175]
    buffer_load_dwordx4 v8, s[8:11], s20 offen lds
    v_mfma_f32_16x16x32_bf16 v[172:175], a[28:31], v[72:75], v[172:175]
    buffer_load_dwordx4 v9, s[8:11], s20 offen offset:1024 lds
    v_mfma_f32_16x16x32_bf16 v[212:215], a[24:27], v[64:67], v[212:215]
    buffer_load_dwordx4 v[32:35], v18, s[12:15], s21 offen sc1
    v_mfma_f32_16x16x32_bf16 v[212:215], a[28:31], v[76:79], v[212:215]
    s_waitcnt lgkmcnt(0)
    v_mfma_f32_16x16x32_bf16 v[136:139], a[0:3], v[56:59], v[136:139]
    ds_read_b64_tr_b16 a[16:17], v14 offset:20608
    v_mfma_f32_16x16x32_bf16 v[136:139], a[4:7], v[68:71], v[136:139]
    ds_read_b64_tr_b16 a[18:19], v14 offset:25728
    v_mfma_f32_16x16x32_bf16 v[176:179], a[0:3], v[60:63], v[176:179]
    ds_read_b64_tr_b16 a[20:21], v14 offset:30848
    v_mfma_f32_16x16x32_bf16 v[176:179], a[4:7], v[72:75], v[176:179]
    ds_read_b64_tr_b16 a[22:23], v14 offset:35968
    v_mfma_f32_16x16x32_bf16 v[216:219], a[0:3], v[64:67], v[216:219]
    ds_read_b64_tr_b16 a[24:25], v16 offset:20640
    v_mfma_f32_16x16x32_bf16 v[216:219], a[4:7], v[76:79], v[216:219]
    ds_read_b64_tr_b16 a[26:27], v16 offset:25760
    v_mfma_f32_16x16x32_bf16 v[140:143], a[8:11], v[56:59], v[140:143]
    ds_read_b64_tr_b16 a[28:29], v16 offset:30880
    v_mfma_f32_16x16x32_bf16 v[140:143], a[12:15], v[68:71], v[140:143]
    ds_read_b64_tr_b16 a[30:31], v16 offset:36000
    v_mfma_f32_16x16x32_bf16 v[180:183], a[8:11], v[60:63], v[180:183]
    buffer_load_dwordx4 v10, s[8:11], s20 offen offset:2048 lds
    v_mfma_f32_16x16x32_bf16 v[180:183], a[12:15], v[72:75], v[180:183]
    buffer_load_dwordx4 v[36:39], v18, s[12:15], s21 offen offset:1024 sc1
    v_mfma_f32_16x16x32_bf16 v[220:223], a[8:11], v[64:67], v[220:223]
    buffer_load_dwordx4 v[40:43], v18, s[12:15], s21 offen offset:2048 sc1
    v_mfma_f32_16x16x32_bf16 v[220:223], a[12:15], v[76:79], v[220:223]
    s_waitcnt lgkmcnt(0)
    v_mfma_f32_16x16x32_bf16 v[144:147], a[16:19], v[56:59], v[144:147]
    ds_read_b64_tr_b16 a[0:1], v14 offset:20672
    v_mfma_f32_16x16x32_bf16 v[144:147], a[20:23], v[68:71], v[144:147]
    ds_read_b64_tr_b16 a[2:3], v14 offset:25792
    v_mfma_f32_16x16x32_bf16 v[184:187], a[16:19], v[60:63], v[184:187]
    ds_read_b64_tr_b16 a[4:5], v14 offset:30912
    v_mfma_f32_16x16x32_bf16 v[184:187], a[20:23], v[72:75], v[184:187]
    ds_read_b64_tr_b16 a[6:7], v14 offset:36032
    v_mfma_f32_16x16x32_bf16 v[224:227], a[16:19], v[64:67], v[224:227]
    ds_read_b64_tr_b16 a[8:9], v16 offset:20704
    v_mfma_f32_16x16x32_bf16 v[224:227], a[20:23], v[76:79], v[224:227]
    ds_read_b64_tr_b16 a[10:11], v16 offset:25824
    v_mfma_f32_16x16x32_bf16 v[148:151], a[24:27], v[56:59], v[148:151]
    ds_read_b64_tr_b16 a[12:13], v16 offset:30944
    v_mfma_f32_16x16x32_bf16 v[148:151], a[28:31], v[68:71], v[148:151]
    ds_read_b64_tr_b16 a[14:15], v16 offset:36064
    v_mfma_f32_16x16x32_bf16 v[188:191], a[24:27], v[60:63], v[188:191]
    buffer_load_dwordx4 v11, s[8:11], s20 offen offset:3072 lds
    v_mfma_f32_16x16x32_bf16 v[188:191], a[28:31], v[72:75], v[188:191]
    s_add_u32 m0, s22, 4096
    v_mfma_f32_16x16x32_bf16 v[228:231], a[24:27], v[64:67], v[228:231]
    buffer_load_dwordx4 v[44:47], v18, s[12:15], s21 offen offset:3072 sc1
    v_mfma_f32_16x16x32_bf16 v[228:231], a[28:31], v[76:79], v[228:231]
    s_add_u32 s23, s21, 4096
    s_waitcnt lgkmcnt(0)
    v_mfma_f32_16x16x32_bf16 v[152:155], a[0:3], v[56:59], v[152:155]
    ds_read_b64_tr_b16 a[16:17], v14 offset:20736
    v_mfma_f32_16x16x32_bf16 v[152:155], a[4:7], v[68:71], v[152:155]
    ds_read_b64_tr_b16 a[18:19], v14 offset:25856
    v_mfma_f32_16x16x32_bf16 v[192:195], a[0:3], v[60:63], v[192:195]
    ds_read_b64_tr_b16 a[20:21], v14 offset:30976
    v_mfma_f32_16x16x32_bf16 v[192:195], a[4:7], v[72:75], v[192:195]
    ds_read_b64_tr_b16 a[22:23], v14 offset:36096
    v_mfma_f32_16x16x32_bf16 v[232:235], a[0:3], v[64:67], v[232:235]
    ds_read_b64_tr_b16 a[24:25], v16 offset:20768
    v_mfma_f32_16x16x32_bf16 v[232:235], a[4:7], v[76:79], v[232:235]
    ds_read_b64_tr_b16 a[26:27], v16 offset:25888
    v_mfma_f32_16x16x32_bf16 v[156:159], a[8:11], v[56:59], v[156:159]
    ds_read_b64_tr_b16 a[28:29], v16 offset:31008
    v_mfma_f32_16x16x32_bf16 v[156:159], a[12:15], v[68:71], v[156:159]
    ds_read_b64_tr_b16 a[30:31], v16 offset:36128
    v_mfma_f32_16x16x32_bf16 v[196:199], a[8:11], v[60:63], v[196:199]
    buffer_load_dwordx4 v12, s[8:11], s20 offen lds
    v_mfma_f32_16x16x32_bf16 v[196:199], a[12:15], v[72:75], v[196:199]
    s_add_u32 s20, s20, 81920
    v_mfma_f32_16x16x32_bf16 v[236:239], a[8:11], v[64:67], v[236:239]
    buffer_load_dwordx4 v[48:51], v18, s[12:15], s23 offen sc1
    buffer_load_dwordx4 v[52:55], v18, s[12:15], s23 offen offset:1024 sc1
    s_add_u32 s21, s21, 6144
    v_mfma_f32_16x16x32_bf16 v[236:239], a[12:15], v[76:79], v[236:239]
    s_waitcnt vmcnt(24) lgkmcnt(0)
    s_barrier
    v_mfma_f32_16x16x32_bf16 v[160:163], a[16:19], v[56:59], v[160:163]
    ds_read_b64_tr_b16 a[0:1], v14 offset:40960
    v_mfma_f32_16x16x32_bf16 v[160:163], a[20:23], v[68:71], v[160:163]
    ds_read_b64_tr_b16 a[2:3], v14 offset:46080
    v_mfma_f32_16x16x32_bf16 v[200:203], a[16:19], v[60:63], v[200:203]
    ds_read_b64_tr_b16 a[4:5], v14 offset:51200
    v_mfma_f32_16x16x32_bf16 v[200:203], a[20:23], v[72:75], v[200:203]
    ds_read_b64_tr_b16 a[6:7], v14 offset:56320
    v_mfma_f32_16x16x32_bf16 v[240:243], a[16:19], v[64:67], v[240:243]
    ds_read_b64_tr_b16 a[8:9], v16 offset:40992
    v_mfma_f32_16x16x32_bf16 v[240:243], a[20:23], v[76:79], v[240:243]
    ds_read_b64_tr_b16 a[10:11], v16 offset:46112
    v_mfma_f32_16x16x32_bf16 v[164:167], a[24:27], v[56:59], v[164:167]
    ds_read_b64_tr_b16 a[12:13], v16 offset:51232
    v_mfma_f32_16x16x32_bf16 v[164:167], a[28:31], v[68:71], v[164:167]
    ds_read_b64_tr_b16 a[14:15], v16 offset:56352
    v_mfma_f32_16x16x32_bf16 v[204:207], a[24:27], v[60:63], v[204:207]
    buffer_load_dword v254, v13, s[32:35], s36 offen sc1
    v_mfma_f32_16x16x32_bf16 v[204:207], a[28:31], v[72:75], v[204:207]
    s_add_u32 s36, s36, s37
    v_mfma_f32_16x16x32_bf16 v[244:247], a[24:27], v[64:67], v[244:247]
    v_mfma_f32_16x16x32_bf16 v[244:247], a[28:31], v[76:79], v[244:247]
    s_waitcnt lgkmcnt(0)
    v_mfma_f32_16x16x32_bf16 v[128:131], a[0:3], v[80:83], v[128:131]
    ds_read_b64_tr_b16 a[16:17], v14 offset:41024
    s_add_u32 m0, s22, 20480
    v_mfma_f32_16x16x32_bf16 v[128:131], a[4:7], v[92:95], v[128:131]
    ds_read_b64_tr_b16 a[18:19], v14 offset:46144
    v_mfma_f32_16x16x32_bf16 v[168:171], a[0:3], v[84:87], v[168:171]
    ds_read_b64_tr_b16 a[20:21], v14 offset:51264
    v_mfma_f32_16x16x32_bf16 v[168:171], a[4:7], v[96:99], v[168:171]
    ds_read_b64_tr_b16 a[22:23], v14 offset:56384
    v_mfma_f32_16x16x32_bf16 v[208:211], a[0:3], v[88:91], v[208:211]
    ds_read_b64_tr_b16 a[24:25], v16 offset:41056
    v_mfma_f32_16x16x32_bf16 v[208:211], a[4:7], v[100:103], v[208:211]
    ds_read_b64_tr_b16 a[26:27], v16 offset:46176
    v_mfma_f32_16x16x32_bf16 v[132:135], a[8:11], v[80:83], v[132:135]
    ds_read_b64_tr_b16 a[28:29], v16 offset:51296
    v_mfma_f32_16x16x32_bf16 v[132:135], a[12:15], v[92:95], v[132:135]
    ds_read_b64_tr_b16 a[30:31], v16 offset:56416
    v_mfma_f32_16x16x32_bf16 v[172:175], a[8:11], v[84:87], v[172:175]
    buffer_load_dwordx4 v8, s[8:11], s20 offen lds
    v_mfma_f32_16x16x32_bf16 v[172:175], a[12:15], v[96:99], v[172:175]
    buffer_load_dwordx4 v9, s[8:11], s20 offen offset:1024 lds
    v_mfma_f32_16x16x32_bf16 v[212:215], a[8:11], v[88:91], v[212:215]
    buffer_load_dwordx4 v[56:59], v18, s[12:15], s21 offen sc1
    v_mfma_f32_16x16x32_bf16 v[212:215], a[12:15], v[100:103], v[212:215]
    s_waitcnt lgkmcnt(0)
    v_mfma_f32_16x16x32_bf16 v[136:139], a[16:19], v[80:83], v[136:139]
    ds_read_b64_tr_b16 a[0:1], v14 offset:41088
    v_mfma_f32_16x16x32_bf16 v[136:139], a[20:23], v[92:95], v[136:139]
    ds_read_b64_tr_b16 a[2:3], v14 offset:46208
    v_mfma_f32_16x16x32_bf16 v[176:179], a[16:19], v[84:87], v[176:179]
    ds_read_b64_tr_b16 a[4:5], v14 offset:51328
    v_mfma_f32_16x16x32_bf16 v[176:179], a[20:23], v[96:99], v[176:179]
    ds_read_b64_tr_b16 a[6:7], v14 offset:56448
    v_mfma_f32_16x16x32_bf16 v[216:219], a[16:19], v[88:91], v[216:219]
    ds_read_b64_tr_b16 a[8:9], v16 offset:41120
    v_mfma_f32_16x16x32_bf16 v[216:219], a[20:23], v[100:103], v[216:219]
    ds_read_b64_tr_b16 a[10:11], v16 offset:46240
    v_mfma_f32_16x16x32_bf16 v[140:143], a[24:27], v[80:83], v[140:143]
    ds_read_b64_tr_b16 a[12:13], v16 offset:51360
    v_mfma_f32_16x16x32_bf16 v[140:143], a[28:31], v[92:95], v[140:143]
    ds_read_b64_tr_b16 a[14:15], v16 offset:56480
    v_mfma_f32_16x16x32_bf16 v[180:183], a[24:27], v[84:87], v[180:183]
    buffer_load_dwordx4 v10, s[8:11], s20 offen offset:2048 lds
    v_mfma_f32_16x16x32_bf16 v[180:183], a[28:31], v[96:99], v[180:183]
    buffer_load_dwordx4 v[60:63], v18, s[12:15], s21 offen offset:1024 sc1
    v_mfma_f32_16x16x32_bf16 v[220:223], a[24:27], v[88:91], v[220:223]
    buffer_load_dwordx4 v[64:67], v18, s[12:15], s21 offen offset:2048 sc1
    v_mfma_f32_16x16x32_bf16 v[220:223], a[28:31], v[100:103], v[220:223]
    s_waitcnt lgkmcnt(0)
    v_mfma_f32_16x16x32_bf16 v[144:147], a[0:3], v[80:83], v[144:147]
    ds_read_b64_tr_b16 a[16:17], v14 offset:41152
    v_mfma_f32_16x16x32_bf16 v[144:147], a[4:7], v[92:95], v[144:147]
    ds_read_b64_tr_b16 a[18:19], v14 offset:46272
    v_mfma_f32_16x16x32_bf16 v[184:187], a[0:3], v[84:87], v[184:187]
    ds_read_b64_tr_b16 a[20:21], v14 offset:51392
    v_mfma_f32_16x16x32_bf16 v[184:187], a[4:7], v[96:99], v[184:187]
    ds_read_b64_tr_b16 a[22:23], v14 offset:56512
    v_mfma_f32_16x16x32_bf16 v[224:227], a[0:3], v[88:91], v[224:227]
    ds_read_b64_tr_b16 a[24:25], v16 offset:41184
    v_mfma_f32_16x16x32_bf16 v[224:227], a[4:7], v[100:103], v[224:227]
    ds_read_b64_tr_b16 a[26:27], v16 offset:46304
    v_mfma_f32_16x16x32_bf16 v[148:151], a[8:11], v[80:83], v[148:151]
    ds_read_b64_tr_b16 a[28:29], v16 offset:51424
    v_mfma_f32_16x16x32_bf16 v[148:151], a[12:15], v[92:95], v[148:151]
    ds_read_b64_tr_b16 a[30:31], v16 offset:56544
    v_mfma_f32_16x16x32_bf16 v[188:191], a[8:11], v[84:87], v[188:191]
    buffer_load_dwordx4 v11, s[8:11], s20 offen offset:3072 lds
    v_mfma_f32_16x16x32_bf16 v[188:191], a[12:15], v[96:99], v[188:191]
    s_add_u32 m0, s22, 24576
    v_mfma_f32_16x16x32_bf16 v[228:231], a[8:11], v[88:91], v[228:231]
    buffer_load_dwordx4 v[68:71], v18, s[12:15], s21 offen offset:3072 sc1
    v_mfma_f32_16x16x32_bf16 v[228:231], a[12:15], v[100:103], v[228:231]
    s_add_u32 s23, s21, 4096
    s_waitcnt lgkmcnt(0)
    v_mfma_f32_16x16x32_bf16 v[152:155], a[16:19], v[80:83], v[152:155]
    ds_read_b64_tr_b16 a[0:1], v14 offset:41216
    v_mfma_f32_16x16x32_bf16 v[152:155], a[20:23], v[92:95], v[152:155]
    ds_read_b64_tr_b16 a[2:3], v14 offset:46336
    v_mfma_f32_16x16x32_bf16 v[192:195], a[16:19], v[84:87], v[192:195]
    ds_read_b64_tr_b16 a[4:5], v14 offset:51456
    v_mfma_f32_16x16x32_bf16 v[192:195], a[20:23], v[96:99], v[192:195]
    ds_read_b64_tr_b16 a[6:7], v14 offset:56576
    v_mfma_f32_16x16x32_bf16 v[232:235], a[16:19], v[88:91], v[232:235]
    ds_read_b64_tr_b16 a[8:9], v16 offset:41248
    v_mfma_f32_16x16x32_bf16 v[232:235], a[20:23], v[100:103], v[232:235]
    ds_read_b64_tr_b16 a[10:11], v16 offset:46368
    v_mfma_f32_16x16x32_bf16 v[156:159], a[24:27], v[80:83], v[156:159]
    ds_read_b64_tr_b16 a[12:13], v16 offset:51488
    v_mfma_f32_16x16x32_bf16 v[156:159], a[28:31], v[92:95], v[156:159]
    ds_read_b64_tr_b16 a[14:15], v16 offset:56608
    v_mfma_f32_16x16x32_bf16 v[196:199], a[24:27], v[84:87], v[196:199]
    buffer_load_dwordx4 v12, s[8:11], s20 offen lds
    v_mfma_f32_16x16x32_bf16 v[196:199], a[28:31], v[96:99], v[196:199]
    s_add_u32 s20, s20, 81920
    v_mfma_f32_16x16x32_bf16 v[236:239], a[24:27], v[88:91], v[236:239]
    buffer_load_dwordx4 v[72:75], v18, s[12:15], s23 offen sc1
    buffer_load_dwordx4 v[76:79], v18, s[12:15], s23 offen offset:1024 sc1
    s_add_u32 s21, s21, 6144
    v_mfma_f32_16x16x32_bf16 v[236:239], a[28:31], v[100:103], v[236:239]
    s_waitcnt vmcnt(25) lgkmcnt(0)
    s_barrier
    v_mfma_f32_16x16x32_bf16 v[160:163], a[0:3], v[80:83], v[160:163]
    ds_read_b64_tr_b16 a[16:17], v15 offset:0
    v_mfma_f32_16x16x32_bf16 v[160:163], a[4:7], v[92:95], v[160:163]
    ds_read_b64_tr_b16 a[18:19], v15 offset:5120
    v_mfma_f32_16x16x32_bf16 v[200:203], a[0:3], v[84:87], v[200:203]
    ds_read_b64_tr_b16 a[20:21], v15 offset:10240
    v_mfma_f32_16x16x32_bf16 v[200:203], a[4:7], v[96:99], v[200:203]
    ds_read_b64_tr_b16 a[22:23], v15 offset:15360
    v_mfma_f32_16x16x32_bf16 v[240:243], a[0:3], v[88:91], v[240:243]
    ds_read_b64_tr_b16 a[24:25], v17 offset:32
    v_mfma_f32_16x16x32_bf16 v[240:243], a[4:7], v[100:103], v[240:243]
    ds_read_b64_tr_b16 a[26:27], v17 offset:5152
    v_mfma_f32_16x16x32_bf16 v[164:167], a[8:11], v[80:83], v[164:167]
    ds_read_b64_tr_b16 a[28:29], v17 offset:10272
    v_mfma_f32_16x16x32_bf16 v[164:167], a[12:15], v[92:95], v[164:167]
    ds_read_b64_tr_b16 a[30:31], v17 offset:15392
    v_mfma_f32_16x16x32_bf16 v[204:207], a[8:11], v[84:87], v[204:207]
    buffer_load_dword v254, v13, s[32:35], s36 offen sc1
    v_mfma_f32_16x16x32_bf16 v[204:207], a[12:15], v[96:99], v[204:207]
    s_add_u32 s36, s36, s37
    v_mfma_f32_16x16x32_bf16 v[244:247], a[8:11], v[88:91], v[244:247]
    v_mfma_f32_16x16x32_bf16 v[244:247], a[12:15], v[100:103], v[244:247]
    s_waitcnt lgkmcnt(0)
    v_mfma_f32_16x16x32_bf16 v[128:131], a[16:19], v[104:107], v[128:131]
    ds_read_b64_tr_b16 a[0:1], v15 offset:64
    s_add_u32 m0, s22, 40960
    v_mfma_f32_16x16x32_bf16 v[128:131], a[20:23], v[116:119], v[128:131]
    ds_read_b64_tr_b16 a[2:3], v15 offset:5184
    v_mfma_f32_16x16x32_bf16 v[168:171], a[16:19], v[108:111], v[168:171]
    ds_read_b64_tr_b16 a[4:5], v15 offset:10304
    v_mfma_f32_16x16x32_bf16 v[168:171], a[20:23], v[120:123], v[168:171]
    ds_read_b64_tr_b16 a[6:7], v15 offset:15424
    v_mfma_f32_16x16x32_bf16 v[208:211], a[16:19], v[112:115], v[208:211]
    ds_read_b64_tr_b16 a[8:9], v17 offset:96
    v_mfma_f32_16x16x32_bf16 v[208:211], a[20:23], v[124:127], v[208:211]
    ds_read_b64_tr_b16 a[10:11], v17 offset:5216
    v_mfma_f32_16x16x32_bf16 v[132:135], a[24:27], v[104:107], v[132:135]
    ds_read_b64_tr_b16 a[12:13], v17 offset:10336
    v_mfma_f32_16x16x32_bf16 v[132:135], a[28:31], v[116:119], v[132:135]
    ds_read_b64_tr_b16 a[14:15], v17 offset:15456
    v_mfma_f32_16x16x32_bf16 v[172:175], a[24:27], v[108:111], v[172:175]
    buffer_load_dwordx4 v8, s[8:11], s20 offen lds
    v_mfma_f32_16x16x32_bf16 v[172:175], a[28:31], v[120:123], v[172:175]
    buffer_load_dwordx4 v9, s[8:11], s20 offen offset:1024 lds
    v_mfma_f32_16x16x32_bf16 v[212:215], a[24:27], v[112:115], v[212:215]
    buffer_load_dwordx4 v[80:83], v18, s[12:15], s21 offen sc1
    v_mfma_f32_16x16x32_bf16 v[212:215], a[28:31], v[124:127], v[212:215]
    s_waitcnt lgkmcnt(0)
    v_mfma_f32_16x16x32_bf16 v[136:139], a[0:3], v[104:107], v[136:139]
    ds_read_b64_tr_b16 a[16:17], v15 offset:128
    v_mfma_f32_16x16x32_bf16 v[136:139], a[4:7], v[116:119], v[136:139]
    ds_read_b64_tr_b16 a[18:19], v15 offset:5248
    v_mfma_f32_16x16x32_bf16 v[176:179], a[0:3], v[108:111], v[176:179]
    ds_read_b64_tr_b16 a[20:21], v15 offset:10368
    v_mfma_f32_16x16x32_bf16 v[176:179], a[4:7], v[120:123], v[176:179]
    ds_read_b64_tr_b16 a[22:23], v15 offset:15488
    v_mfma_f32_16x16x32_bf16 v[216:219], a[0:3], v[112:115], v[216:219]
    ds_read_b64_tr_b16 a[24:25], v17 offset:160
    v_mfma_f32_16x16x32_bf16 v[216:219], a[4:7], v[124:127], v[216:219]
    ds_read_b64_tr_b16 a[26:27], v17 offset:5280
    v_mfma_f32_16x16x32_bf16 v[140:143], a[8:11], v[104:107], v[140:143]
    ds_read_b64_tr_b16 a[28:29], v17 offset:10400
    v_mfma_f32_16x16x32_bf16 v[140:143], a[12:15], v[116:119], v[140:143]
    ds_read_b64_tr_b16 a[30:31], v17 offset:15520
    v_mfma_f32_16x16x32_bf16 v[180:183], a[8:11], v[108:111], v[180:183]
    buffer_load_dwordx4 v10, s[8:11], s20 offen offset:2048 lds
    v_mfma_f32_16x16x32_bf16 v[180:183], a[12:15], v[120:123], v[180:183]
    buffer_load_dwordx4 v[84:87], v18, s[12:15], s21 offen offset:1024 sc1
    v_mfma_f32_16x16x32_bf16 v[220:223], a[8:11], v[112:115], v[220:223]
    buffer_load_dwordx4 v[88:91], v18, s[12:15], s21 offen offset:2048 sc1
    v_mfma_f32_16x16x32_bf16 v[220:223], a[12:15], v[124:127], v[220:223]
    s_waitcnt lgkmcnt(0)
    v_mfma_f32_16x16x32_bf16 v[144:147], a[16:19], v[104:107], v[144:147]
    ds_read_b64_tr_b16 a[0:1], v15 offset:192
    v_mfma_f32_16x16x32_bf16 v[144:147], a[20:23], v[116:119], v[144:147]
    ds_read_b64_tr_b16 a[2:3], v15 offset:5312
    v_mfma_f32_16x16x32_bf16 v[184:187], a[16:19], v[108:111], v[184:187]
    ds_read_b64_tr_b16 a[4:5], v15 offset:10432
    v_mfma_f32_16x16x32_bf16 v[184:187], a[20:23], v[120:123], v[184:187]
    ds_read_b64_tr_b16 a[6:7], v15 offset:15552
    v_mfma_f32_16x16x32_bf16 v[224:227], a[16:19], v[112:115], v[224:227]
    ds_read_b64_tr_b16 a[8:9], v17 offset:224
    v_mfma_f32_16x16x32_bf16 v[224:227], a[20:23], v[124:127], v[224:227]
    ds_read_b64_tr_b16 a[10:11], v17 offset:5344
    v_mfma_f32_16x16x32_bf16 v[148:151], a[24:27], v[104:107], v[148:151]
    ds_read_b64_tr_b16 a[12:13], v17 offset:10464
    v_mfma_f32_16x16x32_bf16 v[148:151], a[28:31], v[116:119], v[148:151]
    ds_read_b64_tr_b16 a[14:15], v17 offset:15584
    v_mfma_f32_16x16x32_bf16 v[188:191], a[24:27], v[108:111], v[188:191]
    buffer_load_dwordx4 v11, s[8:11], s20 offen offset:3072 lds
    v_mfma_f32_16x16x32_bf16 v[188:191], a[28:31], v[120:123], v[188:191]
    s_add_u32 m0, s22, 45056
    v_mfma_f32_16x16x32_bf16 v[228:231], a[24:27], v[112:115], v[228:231]
    buffer_load_dwordx4 v[92:95], v18, s[12:15], s21 offen offset:3072 sc1
    v_mfma_f32_16x16x32_bf16 v[228:231], a[28:31], v[124:127], v[228:231]
    s_add_u32 s23, s21, 4096
    s_waitcnt lgkmcnt(0)
    v_mfma_f32_16x16x32_bf16 v[152:155], a[0:3], v[104:107], v[152:155]
    ds_read_b64_tr_b16 a[16:17], v15 offset:256
    v_mfma_f32_16x16x32_bf16 v[152:155], a[4:7], v[116:119], v[152:155]
    ds_read_b64_tr_b16 a[18:19], v15 offset:5376
    v_mfma_f32_16x16x32_bf16 v[192:195], a[0:3], v[108:111], v[192:195]
    ds_read_b64_tr_b16 a[20:21], v15 offset:10496
    v_mfma_f32_16x16x32_bf16 v[192:195], a[4:7], v[120:123], v[192:195]
    ds_read_b64_tr_b16 a[22:23], v15 offset:15616
    v_mfma_f32_16x16x32_bf16 v[232:235], a[0:3], v[112:115], v[232:235]
    ds_read_b64_tr_b16 a[24:25], v17 offset:288
    v_mfma_f32_16x16x32_bf16 v[232:235], a[4:7], v[124:127], v[232:235]
    ds_read_b64_tr_b16 a[26:27], v17 offset:5408
    v_mfma_f32_16x16x32_bf16 v[156:159], a[8:11], v[104:107], v[156:159]
    ds_read_b64_tr_b16 a[28:29], v17 offset:10528
    v_mfma_f32_16x16x32_bf16 v[156:159], a[12:15], v[116:119], v[156:159]
    ds_read_b64_tr_b16 a[30:31], v17 offset:15648
    v_mfma_f32_16x16x32_bf16 v[196:199], a[8:11], v[108:111], v[196:199]
    buffer_load_dwordx4 v12, s[8:11], s20 offen lds
    v_mfma_f32_16x16x32_bf16 v[196:199], a[12:15], v[120:123], v[196:199]
    s_add_u32 s20, s20, 81920
    v_mfma_f32_16x16x32_bf16 v[236:239], a[8:11], v[112:115], v[236:239]
    buffer_load_dwordx4 v[96:99], v18, s[12:15], s23 offen sc1
    buffer_load_dwordx4 v[100:103], v18, s[12:15], s23 offen offset:1024 sc1
    s_add_u32 s21, s21, 6144
    v_mfma_f32_16x16x32_bf16 v[236:239], a[12:15], v[124:127], v[236:239]
    s_waitcnt vmcnt(24) lgkmcnt(0)
    s_barrier
    v_mfma_f32_16x16x32_bf16 v[160:163], a[16:19], v[104:107], v[160:163]
    ds_read_b64_tr_b16 a[0:1], v14 offset:0
    v_mfma_f32_16x16x32_bf16 v[160:163], a[20:23], v[116:119], v[160:163]
    ds_read_b64_tr_b16 a[2:3], v14 offset:5120
    v_mfma_f32_16x16x32_bf16 v[200:203], a[16:19], v[108:111], v[200:203]
    ds_read_b64_tr_b16 a[4:5], v14 offset:10240
    v_mfma_f32_16x16x32_bf16 v[200:203], a[20:23], v[120:123], v[200:203]
    ds_read_b64_tr_b16 a[6:7], v14 offset:15360
    v_mfma_f32_16x16x32_bf16 v[240:243], a[16:19], v[112:115], v[240:243]
    ds_read_b64_tr_b16 a[8:9], v16 offset:32
    v_mfma_f32_16x16x32_bf16 v[240:243], a[20:23], v[124:127], v[240:243]
    ds_read_b64_tr_b16 a[10:11], v16 offset:5152
    v_mfma_f32_16x16x32_bf16 v[164:167], a[24:27], v[104:107], v[164:167]
    ds_read_b64_tr_b16 a[12:13], v16 offset:10272
    v_mfma_f32_16x16x32_bf16 v[164:167], a[28:31], v[116:119], v[164:167]
    ds_read_b64_tr_b16 a[14:15], v16 offset:15392
    v_mfma_f32_16x16x32_bf16 v[204:207], a[24:27], v[108:111], v[204:207]
    buffer_load_dword v254, v13, s[32:35], s36 offen sc1
    v_mfma_f32_16x16x32_bf16 v[204:207], a[28:31], v[120:123], v[204:207]
    s_add_u32 s36, s36, s37
    v_mfma_f32_16x16x32_bf16 v[244:247], a[24:27], v[112:115], v[244:247]
    v_mfma_f32_16x16x32_bf16 v[244:247], a[28:31], v[124:127], v[244:247]
    v_readfirstlane_b32 s23, v26
    s_nop 0
    s_cmp_ge_u32 s23, 16
    s_cselect_b32 s34, s39, s34
    s_mov_b32 s26, 4
K2_loop:
    buffer_load_dword v26, v25, s[96:99], s83 offen offset:0 sc1
    s_waitcnt lgkmcnt(0)
    v_mfma_f32_16x16x32_bf16 v[128:131], a[0:3], v[32:35], v[128:131]
    ds_read_b64_tr_b16 a[16:17], v14 offset:64
    s_add_u32 m0, s22, 61440
    v_mfma_f32_16x16x32_bf16 v[128:131], a[4:7], v[44:47], v[128:131]
    ds_read_b64_tr_b16 a[18:19], v14 offset:5184
    v_mfma_f32_16x16x32_bf16 v[168:171], a[0:3], v[36:39], v[168:171]
    ds_read_b64_tr_b16 a[20:21], v14 offset:10304
    v_mfma_f32_16x16x32_bf16 v[168:171], a[4:7], v[48:51], v[168:171]
    ds_read_b64_tr_b16 a[22:23], v14 offset:15424
    v_mfma_f32_16x16x32_bf16 v[208:211], a[0:3], v[40:43], v[208:211]
    ds_read_b64_tr_b16 a[24:25], v16 offset:96
    v_mfma_f32_16x16x32_bf16 v[208:211], a[4:7], v[52:55], v[208:211]
    ds_read_b64_tr_b16 a[26:27], v16 offset:5216
    v_mfma_f32_16x16x32_bf16 v[132:135], a[8:11], v[32:35], v[132:135]
    ds_read_b64_tr_b16 a[28:29], v16 offset:10336
    v_mfma_f32_16x16x32_bf16 v[132:135], a[12:15], v[44:47], v[132:135]
    ds_read_b64_tr_b16 a[30:31], v16 offset:15456
    v_mfma_f32_16x16x32_bf16 v[172:175], a[8:11], v[36:39], v[172:175]
    buffer_load_dwordx4 v8, s[8:11], s20 offen lds
    v_mfma_f32_16x16x32_bf16 v[172:175], a[12:15], v[48:51], v[172:175]
    buffer_load_dwordx4 v9, s[8:11], s20 offen offset:1024 lds
    v_mfma_f32_16x16x32_bf16 v[212:215], a[8:11], v[40:43], v[212:215]
    buffer_load_dwordx4 v[104:107], v18, s[12:15], s21 offen sc1
    v_mfma_f32_16x16x32_bf16 v[212:215], a[12:15], v[52:55], v[212:215]
    s_waitcnt lgkmcnt(0)
    v_mfma_f32_16x16x32_bf16 v[136:139], a[16:19], v[32:35], v[136:139]
    ds_read_b64_tr_b16 a[0:1], v14 offset:128
    v_mfma_f32_16x16x32_bf16 v[136:139], a[20:23], v[44:47], v[136:139]
    ds_read_b64_tr_b16 a[2:3], v14 offset:5248
    v_mfma_f32_16x16x32_bf16 v[176:179], a[16:19], v[36:39], v[176:179]
    ds_read_b64_tr_b16 a[4:5], v14 offset:10368
    v_mfma_f32_16x16x32_bf16 v[176:179], a[20:23], v[48:51], v[176:179]
    ds_read_b64_tr_b16 a[6:7], v14 offset:15488
    v_mfma_f32_16x16x32_bf16 v[216:219], a[16:19], v[40:43], v[216:219]
    ds_read_b64_tr_b16 a[8:9], v16 offset:160
    v_mfma_f32_16x16x32_bf16 v[216:219], a[20:23], v[52:55], v[216:219]
    ds_read_b64_tr_b16 a[10:11], v16 offset:5280
    v_mfma_f32_16x16x32_bf16 v[140:143], a[24:27], v[32:35], v[140:143]
    ds_read_b64_tr_b16 a[12:13], v16 offset:10400
    v_mfma_f32_16x16x32_bf16 v[140:143], a[28:31], v[44:47], v[140:143]
    ds_read_b64_tr_b16 a[14:15], v16 offset:15520
    v_mfma_f32_16x16x32_bf16 v[180:183], a[24:27], v[36:39], v[180:183]
    buffer_load_dwordx4 v10, s[8:11], s20 offen offset:2048 lds
    v_mfma_f32_16x16x32_bf16 v[180:183], a[28:31], v[48:51], v[180:183]
    buffer_load_dwordx4 v[108:111], v18, s[12:15], s21 offen offset:1024 sc1
    v_mfma_f32_16x16x32_bf16 v[220:223], a[24:27], v[40:43], v[220:223]
    buffer_load_dwordx4 v[112:115], v18, s[12:15], s21 offen offset:2048 sc1
    v_mfma_f32_16x16x32_bf16 v[220:223], a[28:31], v[52:55], v[220:223]
    s_waitcnt lgkmcnt(0)
    v_mfma_f32_16x16x32_bf16 v[144:147], a[0:3], v[32:35], v[144:147]
    ds_read_b64_tr_b16 a[16:17], v14 offset:192
    v_mfma_f32_16x16x32_bf16 v[144:147], a[4:7], v[44:47], v[144:147]
    ds_read_b64_tr_b16 a[18:19], v14 offset:5312
    v_mfma_f32_16x16x32_bf16 v[184:187], a[0:3], v[36:39], v[184:187]
    ds_read_b64_tr_b16 a[20:21], v14 offset:10432
    v_mfma_f32_16x16x32_bf16 v[184:187], a[4:7], v[48:51], v[184:187]
    ds_read_b64_tr_b16 a[22:23], v14 offset:15552
    v_mfma_f32_16x16x32_bf16 v[224:227], a[0:3], v[40:43], v[224:227]
    ds_read_b64_tr_b16 a[24:25], v16 offset:224
    v_mfma_f32_16x16x32_bf16 v[224:227], a[4:7], v[52:55], v[224:227]
    ds_read_b64_tr_b16 a[26:27], v16 offset:5344
    v_mfma_f32_16x16x32_bf16 v[148:151], a[8:11], v[32:35], v[148:151]
    ds_read_b64_tr_b16 a[28:29], v16 offset:10464
    v_mfma_f32_16x16x32_bf16 v[148:151], a[12:15], v[44:47], v[148:151]
    ds_read_b64_tr_b16 a[30:31], v16 offset:15584
    v_mfma_f32_16x16x32_bf16 v[188:191], a[8:11], v[36:39], v[188:191]
    buffer_load_dwordx4 v11, s[8:11], s20 offen offset:3072 lds
    v_mfma_f32_16x16x32_bf16 v[188:191], a[12:15], v[48:51], v[188:191]
    s_add_u32 m0, s22, 65536
    v_mfma_f32_16x16x32_bf16 v[228:231], a[8:11], v[40:43], v[228:231]
    buffer_load_dwordx4 v[116:119], v18, s[12:15], s21 offen offset:3072 sc1
    v_mfma_f32_16x16x32_bf16 v[228:231], a[12:15], v[52:55], v[228:231]
    s_add_u32 s23, s21, 4096
    s_waitcnt lgkmcnt(0)
    v_mfma_f32_16x16x32_bf16 v[152:155], a[16:19], v[32:35], v[152:155]
    ds_read_b64_tr_b16 a[0:1], v14 offset:256
    v_mfma_f32_16x16x32_bf16 v[152:155], a[20:23], v[44:47], v[152:155]
    ds_read_b64_tr_b16 a[2:3], v14 offset:5376
    v_mfma_f32_16x16x32_bf16 v[192:195], a[16:19], v[36:39], v[192:195]
    ds_read_b64_tr_b16 a[4:5], v14 offset:10496
    v_mfma_f32_16x16x32_bf16 v[192:195], a[20:23], v[48:51], v[192:195]
    ds_read_b64_tr_b16 a[6:7], v14 offset:15616
    v_mfma_f32_16x16x32_bf16 v[232:235], a[16:19], v[40:43], v[232:235]
    ds_read_b64_tr_b16 a[8:9], v16 offset:288
    v_mfma_f32_16x16x32_bf16 v[232:235], a[20:23], v[52:55], v[232:235]
    ds_read_b64_tr_b16 a[10:11], v16 offset:5408
    v_mfma_f32_16x16x32_bf16 v[156:159], a[24:27], v[32:35], v[156:159]
    ds_read_b64_tr_b16 a[12:13], v16 offset:10528
    v_mfma_f32_16x16x32_bf16 v[156:159], a[28:31], v[44:47], v[156:159]
    ds_read_b64_tr_b16 a[14:15], v16 offset:15648
    v_mfma_f32_16x16x32_bf16 v[196:199], a[24:27], v[36:39], v[196:199]
    buffer_load_dwordx4 v12, s[8:11], s20 offen lds
    v_mfma_f32_16x16x32_bf16 v[196:199], a[28:31], v[48:51], v[196:199]
    s_add_u32 s20, s20, 81920
    v_mfma_f32_16x16x32_bf16 v[236:239], a[24:27], v[40:43], v[236:239]
    buffer_load_dwordx4 v[120:123], v18, s[12:15], s23 offen sc1
    buffer_load_dwordx4 v[124:127], v18, s[12:15], s23 offen offset:1024 sc1
    s_add_u32 s21, s21, 6144
    v_mfma_f32_16x16x32_bf16 v[236:239], a[28:31], v[52:55], v[236:239]
    s_waitcnt vmcnt(25) lgkmcnt(0)
    s_barrier
    v_mfma_f32_16x16x32_bf16 v[160:163], a[0:3], v[32:35], v[160:163]
    ds_read_b64_tr_b16 a[16:17], v14 offset:20480
    v_mfma_f32_16x16x32_bf16 v[160:163], a[4:7], v[44:47], v[160:163]
    ds_read_b64_tr_b16 a[18:19], v14 offset:25600
    v_mfma_f32_16x16x32_bf16 v[200:203], a[0:3], v[36:39], v[200:203]
    ds_read_b64_tr_b16 a[20:21], v14 offset:30720
    v_mfma_f32_16x16x32_bf16 v[200:203], a[4:7], v[48:51], v[200:203]
    ds_read_b64_tr_b16 a[22:23], v14 offset:35840
    v_mfma_f32_16x16x32_bf16 v[240:243], a[0:3], v[40:43], v[240:243]
    ds_read_b64_tr_b16 a[24:25], v16 offset:20512
    v_mfma_f32_16x16x32_bf16 v[240:243], a[4:7], v[52:55], v[240:243]
    ds_read_b64_tr_b16 a[26:27], v16 offset:25632
    v_mfma_f32_16x16x32_bf16 v[164:167], a[8:11], v[32:35], v[164:167]
    ds_read_b64_tr_b16 a[28:29], v16 offset:30752
    v_mfma_f32_16x16x32_bf16 v[164:167], a[12:15], v[44:47], v[164:167]
    ds_read_b64_tr_b16 a[30:31], v16 offset:35872
    v_mfma_f32_16x16x32_bf16 v[204:207], a[8:11], v[36:39], v[204:207]
    buffer_load_dword v254, v13, s[32:35], s36 offen sc1
    v_mfma_f32_16x16x32_bf16 v[204:207], a[12:15], v[48:51], v[204:207]
    s_add_u32 s36, s36, s37
    v_mfma_f32_16x16x32_bf16 v[244:247], a[8:11], v[40:43], v[244:247]
    v_mfma_f32_16x16x32_bf16 v[244:247], a[12:15], v[52:55], v[244:247]
    s_waitcnt lgkmcnt(0)
    v_mfma_f32_16x16x32_bf16 v[128:131], a[16:19], v[56:59], v[128:131]
    ds_read_b64_tr_b16 a[0:1], v14 offset:20544
    s_add_u32 m0, s22, 0
    v_mfma_f32_16x16x32_bf16 v[128:131], a[20:23], v[68:71], v[128:131]
    ds_read_b64_tr_b16 a[2:3], v14 offset:25664
    v_mfma_f32_16x16x32_bf16 v[168:171], a[16:19], v[60:63], v[168:171]
    ds_read_b64_tr_b16 a[4:5], v14 offset:30784
    v_mfma_f32_16x16x32_bf16 v[168:171], a[20:23], v[72:75], v[168:171]
    ds_read_b64_tr_b16 a[6:7], v14 offset:35904
    v_mfma_f32_16x16x32_bf16 v[208:211], a[16:19], v[64:67], v[208:211]
    ds_read_b64_tr_b16 a[8:9], v16 offset:20576
    v_mfma_f32_16x16x32_bf16 v[208:211], a[20:23], v[76:79], v[208:211]
    ds_read_b64_tr_b16 a[10:11], v16 offset:25696
    v_mfma_f32_16x16x32_bf16 v[132:135], a[24:27], v[56:59], v[132:135]
    ds_read_b64_tr_b16 a[12:13], v16 offset:30816
    v_mfma_f32_16x16x32_bf16 v[132:135], a[28:31], v[68:71], v[132:135]
    ds_read_b64_tr_b16 a[14:15], v16 offset:35936
    v_mfma_f32_16x16x32_bf16 v[172:175], a[24:27], v[60:63], v[172:175]
    buffer_load_dwordx4 v8, s[8:11], s20 offen lds
    v_mfma_f32_16x16x32_bf16 v[172:175], a[28:31], v[72:75], v[172:175]
    buffer_load_dwordx4 v9, s[8:11], s20 offen offset:1024 lds
    v_mfma_f32_16x16x32_bf16 v[212:215], a[24:27], v[64:67], v[212:215]
    buffer_load_dwordx4 v[32:35], v18, s[12:15], s21 offen sc1
    v_mfma_f32_16x16x32_bf16 v[212:215], a[28:31], v[76:79], v[212:215]
    s_waitcnt lgkmcnt(0)
    v_mfma_f32_16x16x32_bf16 v[136:139], a[0:3], v[56:59], v[136:139]
    ds_read_b64_tr_b16 a[16:17], v14 offset:20608
    v_mfma_f32_16x16x32_bf16 v[136:139], a[4:7], v[68:71], v[136:139]
    ds_read_b64_tr_b16 a[18:19], v14 offset:25728
    v_mfma_f32_16x16x32_bf16 v[176:179], a[0:3], v[60:63], v[176:179]
    ds_read_b64_tr_b16 a[20:21], v14 offset:30848
    v_mfma_f32_16x16x32_bf16 v[176:179], a[4:7], v[72:75], v[176:179]
    ds_read_b64_tr_b16 a[22:23], v14 offset:35968
    v_mfma_f32_16x16x32_bf16 v[216:219], a[0:3], v[64:67], v[216:219]
    ds_read_b64_tr_b16 a[24:25], v16 offset:20640
    v_mfma_f32_16x16x32_bf16 v[216:219], a[4:7], v[76:79], v[216:219]
    ds_read_b64_tr_b16 a[26:27], v16 offset:25760
    v_mfma_f32_16x16x32_bf16 v[140:143], a[8:11], v[56:59], v[140:143]
    ds_read_b64_tr_b16 a[28:29], v16 offset:30880
    v_mfma_f32_16x16x32_bf16 v[140:143], a[12:15], v[68:71], v[140:143]
    ds_read_b64_tr_b16 a[30:31], v16 offset:36000
    v_mfma_f32_16x16x32_bf16 v[180:183], a[8:11], v[60:63], v[180:183]
    buffer_load_dwordx4 v10, s[8:11], s20 offen offset:2048 lds
    v_mfma_f32_16x16x32_bf16 v[180:183], a[12:15], v[72:75], v[180:183]
    buffer_load_dwordx4 v[36:39], v18, s[12:15], s21 offen offset:1024 sc1
    v_mfma_f32_16x16x32_bf16 v[220:223], a[8:11], v[64:67], v[220:223]
    buffer_load_dwordx4 v[40:43], v18, s[12:15], s21 offen offset:2048 sc1
    v_mfma_f32_16x16x32_bf16 v[220:223], a[12:15], v[76:79], v[220:223]
    s_waitcnt lgkmcnt(0)
    v_mfma_f32_16x16x32_bf16 v[144:147], a[16:19], v[56:59], v[144:147]
    ds_read_b64_tr_b16 a[0:1], v14 offset:20672
    v_mfma_f32_16x16x32_bf16 v[144:147], a[20:23], v[68:71], v[144:147]
    ds_read_b64_tr_b16 a[2:3], v14 offset:25792
    v_mfma_f32_16x16x32_bf16 v[184:187], a[16:19], v[60:63], v[184:187]
    ds_read_b64_tr_b16 a[4:5], v14 offset:30912
    v_mfma_f32_16x16x32_bf16 v[184:187], a[20:23], v[72:75], v[184:187]
    ds_read_b64_tr_b16 a[6:7], v14 offset:36032
    v_mfma_f32_16x16x32_bf16 v[224:227], a[16:19], v[64:67], v[224:227]
    ds_read_b64_tr_b16 a[8:9], v16 offset:20704
    v_mfma_f32_16x16x32_bf16 v[224:227], a[20:23], v[76:79], v[224:227]
    ds_read_b64_tr_b16 a[10:11], v16 offset:25824
    v_mfma_f32_16x16x32_bf16 v[148:151], a[24:27], v[56:59], v[148:151]
    ds_read_b64_tr_b16 a[12:13], v16 offset:30944
    v_mfma_f32_16x16x32_bf16 v[148:151], a[28:31], v[68:71], v[148:151]
    ds_read_b64_tr_b16 a[14:15], v16 offset:36064
    v_mfma_f32_16x16x32_bf16 v[188:191], a[24:27], v[60:63], v[188:191]
    buffer_load_dwordx4 v11, s[8:11], s20 offen offset:3072 lds
    v_mfma_f32_16x16x32_bf16 v[188:191], a[28:31], v[72:75], v[188:191]
    s_add_u32 m0, s22, 4096
    v_mfma_f32_16x16x32_bf16 v[228:231], a[24:27], v[64:67], v[228:231]
    buffer_load_dwordx4 v[44:47], v18, s[12:15], s21 offen offset:3072 sc1
    v_mfma_f32_16x16x32_bf16 v[228:231], a[28:31], v[76:79], v[228:231]
    s_add_u32 s23, s21, 4096
    s_waitcnt lgkmcnt(0)
    v_mfma_f32_16x16x32_bf16 v[152:155], a[0:3], v[56:59], v[152:155]
    ds_read_b64_tr_b16 a[16:17], v14 offset:20736
    v_mfma_f32_16x16x32_bf16 v[152:155], a[4:7], v[68:71], v[152:155]
    ds_read_b64_tr_b16 a[18:19], v14 offset:25856
    v_mfma_f32_16x16x32_bf16 v[192:195], a[0:3], v[60:63], v[192:195]
    ds_read_b64_tr_b16 a[20:21], v14 offset:30976
    v_mfma_f32_16x16x32_bf16 v[192:195], a[4:7], v[72:75], v[192:195]
    ds_read_b64_tr_b16 a[22:23], v14 offset:36096
    v_mfma_f32_16x16x32_bf16 v[232:235], a[0:3], v[64:67], v[232:235]
    ds_read_b64_tr_b16 a[24:25], v16 offset:20768
    v_mfma_f32_16x16x32_bf16 v[232:235], a[4:7], v[76:79], v[232:235]
    ds_read_b64_tr_b16 a[26:27], v16 offset:25888
    v_mfma_f32_16x16x32_bf16 v[156:159], a[8:11], v[56:59], v[156:159]
    ds_read_b64_tr_b16 a[28:29], v16 offset:31008
    v_mfma_f32_16x16x32_bf16 v[156:159], a[12:15], v[68:71], v[156:159]
    ds_read_b64_tr_b16 a[30:31], v16 offset:36128
    v_mfma_f32_16x16x32_bf16 v[196:199], a[8:11], v[60:63], v[196:199]
    buffer_load_dwordx4 v12, s[8:11], s20 offen lds
    v_mfma_f32_16x16x32_bf16 v[196:199], a[12:15], v[72:75], v[196:199]
    s_add_u32 s20, s20, 81920
    v_mfma_f32_16x16x32_bf16 v[236:239], a[8:11], v[64:67], v[236:239]
    buffer_load_dwordx4 v[48:51], v18, s[12:15], s23 offen sc1
    buffer_load_dwordx4 v[52:55], v18, s[12:15], s23 offen offset:1024 sc1
    s_add_u32 s21, s21, 6144
    v_mfma_f32_16x16x32_bf16 v[236:239], a[12:15], v[76:79], v[236:239]
    s_waitcnt vmcnt(25) lgkmcnt(0)
    s_barrier
    v_mfma_f32_16x16x32_bf16 v[160:163], a[16:19], v[56:59], v[160:163]
    ds_read_b64_tr_b16 a[0:1], v14 offset:40960
    v_mfma_f32_16x16x32_bf16 v[160:163], a[20:23], v[68:71], v[160:163]
    ds_read_b64_tr_b16 a[2:3], v14 offset:46080
    v_mfma_f32_16x16x32_bf16 v[200:203], a[16:19], v[60:63], v[200:203]
    ds_read_b64_tr_b16 a[4:5], v14 offset:51200
    v_mfma_f32_16x16x32_bf16 v[200:203], a[20:23], v[72:75], v[200:203]
    ds_read_b64_tr_b16 a[6:7], v14 offset:56320
    v_mfma_f32_16x16x32_bf16 v[240:243], a[16:19], v[64:67], v[240:243]
    ds_read_b64_tr_b16 a[8:9], v16 offset:40992
    v_mfma_f32_16x16x32_bf16 v[240:243], a[20:23], v[76:79], v[240:243]
    ds_read_b64_tr_b16 a[10:11], v16 offset:46112
    v_mfma_f32_16x16x32_bf16 v[164:167], a[24:27], v[56:59], v[164:167]
    ds_read_b64_tr_b16 a[12:13], v16 offset:51232
    v_mfma_f32_16x16x32_bf16 v[164:167], a[28:31], v[68:71], v[164:167]
    ds_read_b64_tr_b16 a[14:15], v16 offset:56352
    v_mfma_f32_16x16x32_bf16 v[204:207], a[24:27], v[60:63], v[204:207]
    buffer_load_dword v254, v13, s[32:35], s36 offen sc1
    v_mfma_f32_16x16x32_bf16 v[204:207], a[28:31], v[72:75], v[204:207]
    s_add_u32 s36, s36, s37
    v_mfma_f32_16x16x32_bf16 v[244:247], a[24:27], v[64:67], v[244:247]
    v_mfma_f32_16x16x32_bf16 v[244:247], a[28:31], v[76:79], v[244:247]
    s_waitcnt lgkmcnt(0)
    v_mfma_f32_16x16x32_bf16 v[128:131], a[0:3], v[80:83], v[128:131]
    ds_read_b64_tr_b16 a[16:17], v14 offset:41024
    s_add_u32 m0, s22, 20480
    v_mfma_f32_16x16x32_bf16 v[128:131], a[4:7], v[92:95], v[128:131]
    ds_read_b64_tr_b16 a[18:19], v14 offset:46144
    v_mfma_f32_16x16x32_bf16 v[168:171], a[0:3], v[84:87], v[168:171]
    ds_read_b64_tr_b16 a[20:21], v14 offset:51264
    v_mfma_f32_16x16x32_bf16 v[168:171], a[4:7], v[96:99], v[168:171]
    ds_read_b64_tr_b16 a[22:23], v14 offset:56384
    v_mfma_f32_16x16x32_bf16 v[208:211], a[0:3], v[88:91], v[208:211]
    ds_read_b64_tr_b16 a[24:25], v16 offset:41056
    v_mfma_f32_16x16x32_bf16 v[208:211], a[4:7], v[100:103], v[208:211]
    ds_read_b64_tr_b16 a[26:27], v16 offset:46176
    v_mfma_f32_16x16x32_bf16 v[132:135], a[8:11], v[80:83], v[132:135]
    ds_read_b64_tr_b16 a[28:29], v16 offset:51296
    v_mfma_f32_16x16x32_bf16 v[132:135], a[12:15], v[92:95], v[132:135]
    ds_read_b64_tr_b16 a[30:31], v16 offset:56416
    v_mfma_f32_16x16x32_bf16 v[172:175], a[8:11], v[84:87], v[172:175]
    buffer_load_dwordx4 v8, s[8:11], s20 offen lds
    v_mfma_f32_16x16x32_bf16 v[172:175], a[12:15], v[96:99], v[172:175]
    buffer_load_dwordx4 v9, s[8:11], s20 offen offset:1024 lds
    v_mfma_f32_16x16x32_bf16 v[212:215], a[8:11], v[88:91], v[212:215]
    buffer_load_dwordx4 v[56:59], v18, s[12:15], s21 offen sc1
    v_mfma_f32_16x16x32_bf16 v[212:215], a[12:15], v[100:103], v[212:215]
    s_waitcnt lgkmcnt(0)
    v_mfma_f32_16x16x32_bf16 v[136:139], a[16:19], v[80:83], v[136:139]
    ds_read_b64_tr_b16 a[0:1], v14 offset:41088
    v_mfma_f32_16x16x32_bf16 v[136:139], a[20:23], v[92:95], v[136:139]
    ds_read_b64_tr_b16 a[2:3], v14 offset:46208
    v_mfma_f32_16x16x32_bf16 v[176:179], a[16:19], v[84:87], v[176:179]
    ds_read_b64_tr_b16 a[4:5], v14 offset:51328
    v_mfma_f32_16x16x32_bf16 v[176:179], a[20:23], v[96:99], v[176:179]
    ds_read_b64_tr_b16 a[6:7], v14 offset:56448
    v_mfma_f32_16x16x32_bf16 v[216:219], a[16:19], v[88:91], v[216:219]
    ds_read_b64_tr_b16 a[8:9], v16 offset:41120
    v_mfma_f32_16x16x32_bf16 v[216:219], a[20:23], v[100:103], v[216:219]
    ds_read_b64_tr_b16 a[10:11], v16 offset:46240
    v_mfma_f32_16x16x32_bf16 v[140:143], a[24:27], v[80:83], v[140:143]
    ds_read_b64_tr_b16 a[12:13], v16 offset:51360
    v_mfma_f32_16x16x32_bf16 v[140:143], a[28:31], v[92:95], v[140:143]
    ds_read_b64_tr_b16 a[14:15], v16 offset:56480
    v_mfma_f32_16x16x32_bf16 v[180:183], a[24:27], v[84:87], v[180:183]
    buffer_load_dwordx4 v10, s[8:11], s20 offen offset:2048 lds
    v_mfma_f32_16x16x32_bf16 v[180:183], a[28:31], v[96:99], v[180:183]
    buffer_load_dwordx4 v[60:63], v18, s[12:15], s21 offen offset:1024 sc1
    v_mfma_f32_16x16x32_bf16 v[220:223], a[24:27], v[88:91], v[220:223]
    buffer_load_dwordx4 v[64:67], v18, s[12:15], s21 offen offset:2048 sc1
    v_mfma_f32_16x16x32_bf16 v[220:223], a[28:31], v[100:103], v[220:223]
    s_waitcnt lgkmcnt(0)
    v_mfma_f32_16x16x32_bf16 v[144:147], a[0:3], v[80:83], v[144:147]
    ds_read_b64_tr_b16 a[16:17], v14 offset:41152
    v_mfma_f32_16x16x32_bf16 v[144:147], a[4:7], v[92:95], v[144:147]
    ds_read_b64_tr_b16 a[18:19], v14 offset:46272
    v_mfma_f32_16x16x32_bf16 v[184:187], a[0:3], v[84:87], v[184:187]
    ds_read_b64_tr_b16 a[20:21], v14 offset:51392
    v_mfma_f32_16x16x32_bf16 v[184:187], a[4:7], v[96:99], v[184:187]
    ds_read_b64_tr_b16 a[22:23], v14 offset:56512
    v_mfma_f32_16x16x32_bf16 v[224:227], a[0:3], v[88:91], v[224:227]
    ds_read_b64_tr_b16 a[24:25], v16 offset:41184
    v_mfma_f32_16x16x32_bf16 v[224:227], a[4:7], v[100:103], v[224:227]
    ds_read_b64_tr_b16 a[26:27], v16 offset:46304
    v_mfma_f32_16x16x32_bf16 v[148:151], a[8:11], v[80:83], v[148:151]
    ds_read_b64_tr_b16 a[28:29], v16 offset:51424
    v_mfma_f32_16x16x32_bf16 v[148:151], a[12:15], v[92:95], v[148:151]
    ds_read_b64_tr_b16 a[30:31], v16 offset:56544
    v_mfma_f32_16x16x32_bf16 v[188:191], a[8:11], v[84:87], v[188:191]
    buffer_load_dwordx4 v11, s[8:11], s20 offen offset:3072 lds
    v_mfma_f32_16x16x32_bf16 v[188:191], a[12:15], v[96:99], v[188:191]
    s_add_u32 m0, s22, 24576
    v_mfma_f32_16x16x32_bf16 v[228:231], a[8:11], v[88:91], v[228:231]
    buffer_load_dwordx4 v[68:71], v18, s[12:15], s21 offen offset:3072 sc1
    v_mfma_f32_16x16x32_bf16 v[228:231], a[12:15], v[100:103], v[228:231]
    s_add_u32 s23, s21, 4096
    s_waitcnt lgkmcnt(0)
    v_mfma_f32_16x16x32_bf16 v[152:155], a[16:19], v[80:83], v[152:155]
    ds_read_b64_tr_b16 a[0:1], v14 offset:41216
    v_mfma_f32_16x16x32_bf16 v[152:155], a[20:23], v[92:95], v[152:155]
    ds_read_b64_tr_b16 a[2:3], v14 offset:46336
    v_mfma_f32_16x16x32_bf16 v[192:195], a[16:19], v[84:87], v[192:195]
    ds_read_b64_tr_b16 a[4:5], v14 offset:51456
    v_mfma_f32_16x16x32_bf16 v[192:195], a[20:23], v[96:99], v[192:195]
    ds_read_b64_tr_b16 a[6:7], v14 offset:56576
    v_mfma_f32_16x16x32_bf16 v[232:235], a[16:19], v[88:91], v[232:235]
    ds_read_b64_tr_b16 a[8:9], v16 offset:41248
    v_mfma_f32_16x16x32_bf16 v[232:235], a[20:23], v[100:103], v[232:235]
    ds_read_b64_tr_b16 a[10:11], v16 offset:46368
    v_mfma_f32_16x16x32_bf16 v[156:159], a[24:27], v[80:83], v[156:159]
    ds_read_b64_tr_b16 a[12:13], v16 offset:51488
    v_mfma_f32_16x16x32_bf16 v[156:159], a[28:31], v[92:95], v[156:159]
    ds_read_b64_tr_b16 a[14:15], v16 offset:56608
    v_mfma_f32_16x16x32_bf16 v[196:199], a[24:27], v[84:87], v[196:199]
    buffer_load_dwordx4 v12, s[8:11], s20 offen lds
    v_mfma_f32_16x16x32_bf16 v[196:199], a[28:31], v[96:99], v[196:199]
    s_add_u32 s20, s20, 81920
    v_mfma_f32_16x16x32_bf16 v[236:239], a[24:27], v[88:91], v[236:239]
    buffer_load_dwordx4 v[72:75], v18, s[12:15], s23 offen sc1
    buffer_load_dwordx4 v[76:79], v18, s[12:15], s23 offen offset:1024 sc1
    s_add_u32 s21, s21, 6144
    v_mfma_f32_16x16x32_bf16 v[236:239], a[28:31], v[100:103], v[236:239]
    s_waitcnt vmcnt(24) lgkmcnt(0)
    s_barrier
    v_mfma_f32_16x16x32_bf16 v[160:163], a[0:3], v[80:83], v[160:163]
    ds_read_b64_tr_b16 a[16:17], v15 offset:0
    v_mfma_f32_16x16x32_bf16 v[160:163], a[4:7], v[92:95], v[160:163]
    ds_read_b64_tr_b16 a[18:19], v15 offset:5120
    v_mfma_f32_16x16x32_bf16 v[200:203], a[0:3], v[84:87], v[200:203]
    ds_read_b64_tr_b16 a[20:21], v15 offset:10240
    v_mfma_f32_16x16x32_bf16 v[200:203], a[4:7], v[96:99], v[200:203]
    ds_read_b64_tr_b16 a[22:23], v15 offset:15360
    v_mfma_f32_16x16x32_bf16 v[240:243], a[0:3], v[88:91], v[240:243]
    ds_read_b64_tr_b16 a[24:25], v17 offset:32
    v_mfma_f32_16x16x32_bf16 v[240:243], a[4:7], v[100:103], v[240:243]
    ds_read_b64_tr_b16 a[26:27], v17 offset:5152
    v_mfma_f32_16x16x32_bf16 v[164:167], a[8:11], v[80:83], v[164:167]
    ds_read_b64_tr_b16 a[28:29], v17 offset:10272
    v_mfma_f32_16x16x32_bf16 v[164:167], a[12:15], v[92:95], v[164:167]
    ds_read_b64_tr_b16 a[30:31], v17 offset:15392
    v_mfma_f32_16x16x32_bf16 v[204:207], a[8:11], v[84:87], v[204:207]
    buffer_load_dword v254, v13, s[32:35], s36 offen sc1
    v_mfma_f32_16x16x32_bf16 v[204:207], a[12:15], v[96:99], v[204:207]
    s_add_u32 s36, s36, s37
    v_mfma_f32_16x16x32_bf16 v[244:247], a[8:11], v[88:91], v[244:247]
    v_mfma_f32_16x16x32_bf16 v[244:247], a[12:15], v[100:103], v[244:247]
    s_waitcnt lgkmcnt(0)
    v_mfma_f32_16x16x32_bf16 v[128:131], a[16:19], v[104:107], v[128:131]
    ds_read_b64_tr_b16 a[0:1], v15 offset:64
    s_add_u32 m0, s22, 40960
    v_mfma_f32_16x16x32_bf16 v[128:131], a[20:23], v[116:119], v[128:131]
    ds_read_b64_tr_b16 a[2:3], v15 offset:5184
    v_mfma_f32_16x16x32_bf16 v[168:171], a[16:19], v[108:111], v[168:171]
    ds_read_b64_tr_b16 a[4:5], v15 offset:10304
    v_mfma_f32_16x16x32_bf16 v[168:171], a[20:23], v[120:123], v[168:171]
    ds_read_b64_tr_b16 a[6:7], v15 offset:15424
    v_mfma_f32_16x16x32_bf16 v[208:211], a[16:19], v[112:115], v[208:211]
    ds_read_b64_tr_b16 a[8:9], v17 offset:96
    v_mfma_f32_16x16x32_bf16 v[208:211], a[20:23], v[124:127], v[208:211]
    ds_read_b64_tr_b16 a[10:11], v17 offset:5216
    v_mfma_f32_16x16x32_bf16 v[132:135], a[24:27], v[104:107], v[132:135]
    ds_read_b64_tr_b16 a[12:13], v17 offset:10336
    v_mfma_f32_16x16x32_bf16 v[132:135], a[28:31], v[116:119], v[132:135]
    ds_read_b64_tr_b16 a[14:15], v17 offset:15456
    v_mfma_f32_16x16x32_bf16 v[172:175], a[24:27], v[108:111], v[172:175]
    buffer_load_dwordx4 v8, s[8:11], s20 offen lds
    v_mfma_f32_16x16x32_bf16 v[172:175], a[28:31], v[120:123], v[172:175]
    buffer_load_dwordx4 v9, s[8:11], s20 offen offset:1024 lds
    v_mfma_f32_16x16x32_bf16 v[212:215], a[24:27], v[112:115], v[212:215]
    buffer_load_dwordx4 v[80:83], v18, s[12:15], s21 offen sc1
    v_mfma_f32_16x16x32_bf16 v[212:215], a[28:31], v[124:127], v[212:215]
    s_waitcnt lgkmcnt(0)
    v_mfma_f32_16x16x32_bf16 v[136:139], a[0:3], v[104:107], v[136:139]
    ds_read_b64_tr_b16 a[16:17], v15 offset:128
    v_mfma_f32_16x16x32_bf16 v[136:139], a[4:7], v[116:119], v[136:139]
    ds_read_b64_tr_b16 a[18:19], v15 offset:5248
    v_mfma_f32_16x16x32_bf16 v[176:179], a[0:3], v[108:111], v[176:179]
    ds_read_b64_tr_b16 a[20:21], v15 offset:10368
    v_mfma_f32_16x16x32_bf16 v[176:179], a[4:7], v[120:123], v[176:179]
    ds_read_b64_tr_b16 a[22:23], v15 offset:15488
    v_mfma_f32_16x16x32_bf16 v[216:219], a[0:3], v[112:115], v[216:219]
    ds_read_b64_tr_b16 a[24:25], v17 offset:160
    v_mfma_f32_16x16x32_bf16 v[216:219], a[4:7], v[124:127], v[216:219]
    ds_read_b64_tr_b16 a[26:27], v17 offset:5280
    v_mfma_f32_16x16x32_bf16 v[140:143], a[8:11], v[104:107], v[140:143]
    ds_read_b64_tr_b16 a[28:29], v17 offset:10400
    v_mfma_f32_16x16x32_bf16 v[140:143], a[12:15], v[116:119], v[140:143]
    ds_read_b64_tr_b16 a[30:31], v17 offset:15520
    v_mfma_f32_16x16x32_bf16 v[180:183], a[8:11], v[108:111], v[180:183]
    buffer_load_dwordx4 v10, s[8:11], s20 offen offset:2048 lds
    v_mfma_f32_16x16x32_bf16 v[180:183], a[12:15], v[120:123], v[180:183]
    buffer_load_dwordx4 v[84:87], v18, s[12:15], s21 offen offset:1024 sc1
    v_mfma_f32_16x16x32_bf16 v[220:223], a[8:11], v[112:115], v[220:223]
    buffer_load_dwordx4 v[88:91], v18, s[12:15], s21 offen offset:2048 sc1
    v_mfma_f32_16x16x32_bf16 v[220:223], a[12:15], v[124:127], v[220:223]
    s_waitcnt lgkmcnt(0)
    v_mfma_f32_16x16x32_bf16 v[144:147], a[16:19], v[104:107], v[144:147]
    ds_read_b64_tr_b16 a[0:1], v15 offset:192
    v_mfma_f32_16x16x32_bf16 v[144:147], a[20:23], v[116:119], v[144:147]
    ds_read_b64_tr_b16 a[2:3], v15 offset:5312
    v_mfma_f32_16x16x32_bf16 v[184:187], a[16:19], v[108:111], v[184:187]
    ds_read_b64_tr_b16 a[4:5], v15 offset:10432
    v_mfma_f32_16x16x32_bf16 v[184:187], a[20:23], v[120:123], v[184:187]
    ds_read_b64_tr_b16 a[6:7], v15 offset:15552
    v_mfma_f32_16x16x32_bf16 v[224:227], a[16:19], v[112:115], v[224:227]
    ds_read_b64_tr_b16 a[8:9], v17 offset:224
    v_mfma_f32_16x16x32_bf16 v[224:227], a[20:23], v[124:127], v[224:227]
    ds_read_b64_tr_b16 a[10:11], v17 offset:5344
    v_mfma_f32_16x16x32_bf16 v[148:151], a[24:27], v[104:107], v[148:151]
    ds_read_b64_tr_b16 a[12:13], v17 offset:10464
    v_mfma_f32_16x16x32_bf16 v[148:151], a[28:31], v[116:119], v[148:151]
    ds_read_b64_tr_b16 a[14:15], v17 offset:15584
    v_mfma_f32_16x16x32_bf16 v[188:191], a[24:27], v[108:111], v[188:191]
    buffer_load_dwordx4 v11, s[8:11], s20 offen offset:3072 lds
    v_mfma_f32_16x16x32_bf16 v[188:191], a[28:31], v[120:123], v[188:191]
    s_add_u32 m0, s22, 45056
    v_mfma_f32_16x16x32_bf16 v[228:231], a[24:27], v[112:115], v[228:231]
    buffer_load_dwordx4 v[92:95], v18, s[12:15], s21 offen offset:3072 sc1
    v_mfma_f32_16x16x32_bf16 v[228:231], a[28:31], v[124:127], v[228:231]
    s_add_u32 s23, s21, 4096
    s_waitcnt lgkmcnt(0)
    v_mfma_f32_16x16x32_bf16 v[152:155], a[0:3], v[104:107], v[152:155]
    ds_read_b64_tr_b16 a[16:17], v15 offset:256
    v_mfma_f32_16x16x32_bf16 v[152:155], a[4:7], v[116:119], v[152:155]
    ds_read_b64_tr_b16 a[18:19], v15 offset:5376
    v_mfma_f32_16x16x32_bf16 v[192:195], a[0:3], v[108:111], v[192:195]
    ds_read_b64_tr_b16 a[20:21], v15 offset:10496
    v_mfma_f32_16x16x32_bf16 v[192:195], a[4:7], v[120:123], v[192:195]
    ds_read_b64_tr_b16 a[22:23], v15 offset:15616
    v_mfma_f32_16x16x32_bf16 v[232:235], a[0:3], v[112:115], v[232:235]
    ds_read_b64_tr_b16 a[24:25], v17 offset:288
    v_mfma_f32_16x16x32_bf16 v[232:235], a[4:7], v[124:127], v[232:235]
    ds_read_b64_tr_b16 a[26:27], v17 offset:5408
    v_mfma_f32_16x16x32_bf16 v[156:159], a[8:11], v[104:107], v[156:159]
    ds_read_b64_tr_b16 a[28:29], v17 offset:10528
    v_mfma_f32_16x16x32_bf16 v[156:159], a[12:15], v[116:119], v[156:159]
    ds_read_b64_tr_b16 a[30:31], v17 offset:15648
    v_mfma_f32_16x16x32_bf16 v[196:199], a[8:11], v[108:111], v[196:199]
    buffer_load_dwordx4 v12, s[8:11], s20 offen lds
    v_mfma_f32_16x16x32_bf16 v[196:199], a[12:15], v[120:123], v[196:199]
    s_add_u32 s20, s20, 81920
    v_mfma_f32_16x16x32_bf16 v[236:239], a[8:11], v[112:115], v[236:239]
    buffer_load_dwordx4 v[96:99], v18, s[12:15], s23 offen sc1
    buffer_load_dwordx4 v[100:103], v18, s[12:15], s23 offen offset:1024 sc1
    s_add_u32 s21, s21, 6144
    v_mfma_f32_16x16x32_bf16 v[236:239], a[12:15], v[124:127], v[236:239]
    s_waitcnt vmcnt(24) lgkmcnt(0)
    s_barrier
    v_mfma_f32_16x16x32_bf16 v[160:163], a[16:19], v[104:107], v[160:163]
    ds_read_b64_tr_b16 a[0:1], v14 offset:0
    v_mfma_f32_16x16x32_bf16 v[160:163], a[20:23], v[116:119], v[160:163]
    ds_read_b64_tr_b16 a[2:3], v14 offset:5120
    v_mfma_f32_16x16x32_bf16 v[200:203], a[16:19], v[108:111], v[200:203]
    ds_read_b64_tr_b16 a[4:5], v14 offset:10240
    v_mfma_f32_16x16x32_bf16 v[200:203], a[20:23], v[120:123], v[200:203]
    ds_read_b64_tr_b16 a[6:7], v14 offset:15360
    v_mfma_f32_16x16x32_bf16 v[240:243], a[16:19], v[112:115], v[240:243]
    ds_read_b64_tr_b16 a[8:9], v16 offset:32
    v_mfma_f32_16x16x32_bf16 v[240:243], a[20:23], v[124:127], v[240:243]
    ds_read_b64_tr_b16 a[10:11], v16 offset:5152
    v_mfma_f32_16x16x32_bf16 v[164:167], a[24:27], v[104:107], v[164:167]
    ds_read_b64_tr_b16 a[12:13], v16 offset:10272
    v_mfma_f32_16x16x32_bf16 v[164:167], a[28:31], v[116:119], v[164:167]
    ds_read_b64_tr_b16 a[14:15], v16 offset:15392
    v_mfma_f32_16x16x32_bf16 v[204:207], a[24:27], v[108:111], v[204:207]
    buffer_load_dword v254, v13, s[32:35], s36 offen sc1
    v_mfma_f32_16x16x32_bf16 v[204:207], a[28:31], v[120:123], v[204:207]
    s_add_u32 s36, s36, s37
    v_mfma_f32_16x16x32_bf16 v[244:247], a[24:27], v[112:115], v[244:247]
    v_mfma_f32_16x16x32_bf16 v[244:247], a[28:31], v[124:127], v[244:247]
    s_cmp_lg_u32 s26, 4
    s_cbranch_scc1 G_c1
    v_readfirstlane_b32 s23, v26
    s_nop 0
    s_cmp_ge_u32 s23, 16
    s_cbranch_scc1 G_c1
    v_mov_b32 v6, 16384
G_p1:
    buffer_load_dword v7, v6, s[96:99], s83 offen sc1
    s_waitcnt vmcnt(0)
    v_readfirstlane_b32 s23, v7
    s_nop 0
    s_cmp_ge_u32 s23, 16
    s_cbranch_scc1 G_p1k
    s_sleep 4
    s_branch G_p1
G_p1k:
G_c1:
    s_mov_b32 s34, s39
    s_sub_u32 s26, s26, 1
    s_cmp_lg_u32 s26, 0
    s_cbranch_scc1 K2_loop
    s_waitcnt lgkmcnt(0)
    v_mfma_f32_16x16x32_bf16 v[128:131], a[0:3], v[32:35], v[128:131]
    ds_read_b64_tr_b16 a[16:17], v14 offset:64
    s_add_u32 m0, s22, 61440
    v_mfma_f32_16x16x32_bf16 v[128:131], a[4:7], v[44:47], v[128:131]
    ds_read_b64_tr_b16 a[18:19], v14 offset:5184
    v_mfma_f32_16x16x32_bf16 v[168:171], a[0:3], v[36:39], v[168:171]
    ds_read_b64_tr_b16 a[20:21], v14 offset:10304
    v_mfma_f32_16x16x32_bf16 v[168:171], a[4:7], v[48:51], v[168:171]
    ds_read_b64_tr_b16 a[22:23], v14 offset:15424
    v_mfma_f32_16x16x32_bf16 v[208:211], a[0:3], v[40:43], v[208:211]
    ds_read_b64_tr_b16 a[24:25], v16 offset:96
    v_mfma_f32_16x16x32_bf16 v[208:211], a[4:7], v[52:55], v[208:211]
    ds_read_b64_tr_b16 a[26:27], v16 offset:5216
    v_mfma_f32_16x16x32_bf16 v[132:135], a[8:11], v[32:35], v[132:135]
    ds_read_b64_tr_b16 a[28:29], v16 offset:10336
    v_mfma_f32_16x16x32_bf16 v[132:135], a[12:15], v[44:47], v[132:135]
    ds_read_b64_tr_b16 a[30:31], v16 offset:15456
    v_mfma_f32_16x16x32_bf16 v[172:175], a[8:11], v[36:39], v[172:175]
    buffer_load_dwordx4 v8, s[8:11], s20 offen lds
    v_mfma_f32_16x16x32_bf16 v[172:175], a[12:15], v[48:51], v[172:175]
    buffer_load_dwordx4 v9, s[8:11], s20 offen offset:1024 lds
    v_mfma_f32_16x16x32_bf16 v[212:215], a[8:11], v[40:43], v[212:215]
    buffer_load_dwordx4 v[104:107], v18, s[12:15], s21 offen sc1
    v_mfma_f32_16x16x32_bf16 v[212:215], a[12:15], v[52:55], v[212:215]
    s_waitcnt lgkmcnt(0)
    v_mfma_f32_16x16x32_bf16 v[136:139], a[16:19], v[32:35], v[136:139]
    ds_read_b64_tr_b16 a[0:1], v14 offset:128
    v_mfma_f32_16x16x32_bf16 v[136:139], a[20:23], v[44:47], v[136:139]
    ds_read_b64_tr_b16 a[2:3], v14 offset:5248
    v_mfma_f32_16x16x32_bf16 v[176:179], a[16:19], v[36:39], v[176:179]
    ds_read_b64_tr_b16 a[4:5], v14 offset:10368
    v_mfma_f32_16x16x32_bf16 v[176:179], a[20:23], v[48:51], v[176:179]
    ds_read_b64_tr_b16 a[6:7], v14 offset:15488
    v_mfma_f32_16x16x32_bf16 v[216:219], a[16:19], v[40:43], v[216:219]
    ds_read_b64_tr_b16 a[8:9], v16 offset:160
    v_mfma_f32_16x16x32_bf16 v[216:219], a[20:23], v[52:55], v[216:219]
    ds_read_b64_tr_b16 a[10:11], v16 offset:5280
    v_mfma_f32_16x16x32_bf16 v[140:143], a[24:27], v[32:35], v[140:143]
    ds_read_b64_tr_b16 a[12:13], v16 offset:10400
    v_mfma_f32_16x16x32_bf16 v[140:143], a[28:31], v[44:47], v[140:143]
    ds_read_b64_tr_b16 a[14:15], v16 offset:15520
    v_mfma_f32_16x16x32_bf16 v[180:183], a[24:27], v[36:39], v[180:183]
    buffer_load_dwordx4 v10, s[8:11], s20 offen offset:2048 lds
    v_mfma_f32_16x16x32_bf16 v[180:183], a[28:31], v[48:51], v[180:183]
    buffer_load_dwordx4 v[108:111], v18, s[12:15], s21 offen offset:1024 sc1
    v_mfma_f32_16x16x32_bf16 v[220:223], a[24:27], v[40:43], v[220:223]
    buffer_load_dwordx4 v[112:115], v18, s[12:15], s21 offen offset:2048 sc1
    v_mfma_f32_16x16x32_bf16 v[220:223], a[28:31], v[52:55], v[220:223]
    s_waitcnt lgkmcnt(0)
    v_mfma_f32_16x16x32_bf16 v[144:147], a[0:3], v[32:35], v[144:147]
    ds_read_b64_tr_b16 a[16:17], v14 offset:192
    v_mfma_f32_16x16x32_bf16 v[144:147], a[4:7], v[44:47], v[144:147]
    ds_read_b64_tr_b16 a[18:19], v14 offset:5312
    v_mfma_f32_16x16x32_bf16 v[184:187], a[0:3], v[36:39], v[184:187]
    ds_read_b64_tr_b16 a[20:21], v14 offset:10432
    v_mfma_f32_16x16x32_bf16 v[184:187], a[4:7], v[48:51], v[184:187]
    ds_read_b64_tr_b16 a[22:23], v14 offset:15552
    v_mfma_f32_16x16x32_bf16 v[224:227], a[0:3], v[40:43], v[224:227]
    ds_read_b64_tr_b16 a[24:25], v16 offset:224
    v_mfma_f32_16x16x32_bf16 v[224:227], a[4:7], v[52:55], v[224:227]
    ds_read_b64_tr_b16 a[26:27], v16 offset:5344
    v_mfma_f32_16x16x32_bf16 v[148:151], a[8:11], v[32:35], v[148:151]
    ds_read_b64_tr_b16 a[28:29], v16 offset:10464
    v_mfma_f32_16x16x32_bf16 v[148:151], a[12:15], v[44:47], v[148:151]
    ds_read_b64_tr_b16 a[30:31], v16 offset:15584
    v_mfma_f32_16x16x32_bf16 v[188:191], a[8:11], v[36:39], v[188:191]
    buffer_load_dwordx4 v11, s[8:11], s20 offen offset:3072 lds
    v_mfma_f32_16x16x32_bf16 v[188:191], a[12:15], v[48:51], v[188:191]
    s_add_u32 m0, s22, 65536
    v_mfma_f32_16x16x32_bf16 v[228:231], a[8:11], v[40:43], v[228:231]
    buffer_load_dwordx4 v[116:119], v18, s[12:15], s21 offen offset:3072 sc1
    v_mfma_f32_16x16x32_bf16 v[228:231], a[12:15], v[52:55], v[228:231]
    s_add_u32 s23, s21, 4096
    s_waitcnt lgkmcnt(0)
    v_mfma_f32_16x16x32_bf16 v[152:155], a[16:19], v[32:35], v[152:155]
    ds_read_b64_tr_b16 a[0:1], v14 offset:256
    v_mfma_f32_16x16x32_bf16 v[152:155], a[20:23], v[44:47], v[152:155]
    ds_read_b64_tr_b16 a[2:3], v14 offset:5376
    v_mfma_f32_16x16x32_bf16 v[192:195], a[16:19], v[36:39], v[192:195]
    ds_read_b64_tr_b16 a[4:5], v14 offset:10496
    v_mfma_f32_16x16x32_bf16 v[192:195], a[20:23], v[48:51], v[192:195]
    ds_read_b64_tr_b16 a[6:7], v14 offset:15616
    v_mfma_f32_16x16x32_bf16 v[232:235], a[16:19], v[40:43], v[232:235]
    ds_read_b64_tr_b16 a[8:9], v16 offset:288
    v_mfma_f32_16x16x32_bf16 v[232:235], a[20:23], v[52:55], v[232:235]
    ds_read_b64_tr_b16 a[10:11], v16 offset:5408
    v_mfma_f32_16x16x32_bf16 v[156:159], a[24:27], v[32:35], v[156:159]
    ds_read_b64_tr_b16 a[12:13], v16 offset:10528
    v_mfma_f32_16x16x32_bf16 v[156:159], a[28:31], v[44:47], v[156:159]
    ds_read_b64_tr_b16 a[14:15], v16 offset:15648
    v_mfma_f32_16x16x32_bf16 v[196:199], a[24:27], v[36:39], v[196:199]
    buffer_load_dwordx4 v12, s[8:11], s20 offen lds
    v_mfma_f32_16x16x32_bf16 v[196:199], a[28:31], v[48:51], v[196:199]
    s_add_u32 s20, s20, 81920
    v_mfma_f32_16x16x32_bf16 v[236:239], a[24:27], v[40:43], v[236:239]
    buffer_load_dwordx4 v[120:123], v18, s[12:15], s23 offen sc1
    buffer_load_dwordx4 v[124:127], v18, s[12:15], s23 offen offset:1024 sc1
    s_add_u32 s21, s21, 6144
    v_mfma_f32_16x16x32_bf16 v[236:239], a[28:31], v[52:55], v[236:239]
    s_waitcnt vmcnt(24) lgkmcnt(0)
    s_barrier
    v_mfma_f32_16x16x32_bf16 v[160:163], a[0:3], v[32:35], v[160:163]
    ds_read_b64_tr_b16 a[16:17], v14 offset:20480
    v_mfma_f32_16x16x32_bf16 v[160:163], a[4:7], v[44:47], v[160:163]
    ds_read_b64_tr_b16 a[18:19], v14 offset:25600
    v_mfma_f32_16x16x32_bf16 v[200:203], a[0:3], v[36:39], v[200:203]
    ds_read_b64_tr_b16 a[20:21], v14 offset:30720
    v_mfma_f32_16x16x32_bf16 v[200:203], a[4:7], v[48:51], v[200:203]
    ds_read_b64_tr_b16 a[22:23], v14 offset:35840
    v_mfma_f32_16x16x32_bf16 v[240:243], a[0:3], v[40:43], v[240:243]
    ds_read_b64_tr_b16 a[24:25], v16 offset:20512
    v_mfma_f32_16x16x32_bf16 v[240:243], a[4:7], v[52:55], v[240:243]
    ds_read_b64_tr_b16 a[26:27], v16 offset:25632
    v_mfma_f32_16x16x32_bf16 v[164:167], a[8:11], v[32:35], v[164:167]
    ds_read_b64_tr_b16 a[28:29], v16 offset:30752
    v_mfma_f32_16x16x32_bf16 v[164:167], a[12:15], v[44:47], v[164:167]
    ds_read_b64_tr_b16 a[30:31], v16 offset:35872
    v_mfma_f32_16x16x32_bf16 v[204:207], a[8:11], v[36:39], v[204:207]
    v_mfma_f32_16x16x32_bf16 v[204:207], a[12:15], v[48:51], v[204:207]
    v_mfma_f32_16x16x32_bf16 v[244:247], a[8:11], v[40:43], v[244:247]
    v_mfma_f32_16x16x32_bf16 v[244:247], a[12:15], v[52:55], v[244:247]
    s_waitcnt lgkmcnt(0)
    v_mfma_f32_16x16x32_bf16 v[128:131], a[16:19], v[56:59], v[128:131]
    ds_read_b64_tr_b16 a[0:1], v14 offset:20544
    v_mfma_f32_16x16x32_bf16 v[128:131], a[20:23], v[68:71], v[128:131]
    ds_read_b64_tr_b16 a[2:3], v14 offset:25664
    v_mfma_f32_16x16x32_bf16 v[168:171], a[16:19], v[60:63], v[168:171]
    ds_read_b64_tr_b16 a[4:5], v14 offset:30784
    v_mfma_f32_16x16x32_bf16 v[168:171], a[20:23], v[72:75], v[168:171]
    ds_read_b64_tr_b16 a[6:7], v14 offset:35904
    v_mfma_f32_16x16x32_bf16 v[208:211], a[16:19], v[64:67], v[208:211]
    ds_read_b64_tr_b16 a[8:9], v16 offset:20576
    v_mfma_f32_16x16x32_bf16 v[208:211], a[20:23], v[76:79], v[208:211]
    ds_read_b64_tr_b16 a[10:11], v16 offset:25696
    v_mfma_f32_16x16x32_bf16 v[132:135], a[24:27], v[56:59], v[132:135]
    ds_read_b64_tr_b16 a[12:13], v16 offset:30816
    v_mfma_f32_16x16x32_bf16 v[132:135], a[28:31], v[68:71], v[132:135]
    ds_read_b64_tr_b16 a[14:15], v16 offset:35936
    v_mfma_f32_16x16x32_bf16 v[172:175], a[24:27], v[60:63], v[172:175]
    v_mfma_f32_16x16x32_bf16 v[172:175], a[28:31], v[72:75], v[172:175]
    v_mfma_f32_16x16x32_bf16 v[212:215], a[24:27], v[64:67], v[212:215]
    v_mfma_f32_16x16x32_bf16 v[212:215], a[28:31], v[76:79], v[212:215]
    s_waitcnt lgkmcnt(0)
    v_mfma_f32_16x16x32_bf16 v[136:139], a[0:3], v[56:59], v[136:139]
    ds_read_b64_tr_b16 a[16:17], v14 offset:20608
    v_mfma_f32_16x16x32_bf16 v[136:139], a[4:7], v[68:71], v[136:139]
    ds_read_b64_tr_b16 a[18:19], v14 offset:25728
    v_mfma_f32_16x16x32_bf16 v[176:179], a[0:3], v[60:63], v[176:179]
    ds_read_b64_tr_b16 a[20:21], v14 offset:30848
    v_mfma_f32_16x16x32_bf16 v[176:179], a[4:7], v[72:75], v[176:179]
    ds_read_b64_tr_b16 a[22:23], v14 offset:35968
    v_mfma_f32_16x16x32_bf16 v[216:219], a[0:3], v[64:67], v[216:219]
    ds_read_b64_tr_b16 a[24:25], v16 offset:20640
    v_mfma_f32_16x16x32_bf16 v[216:219], a[4:7], v[76:79], v[216:219]
    ds_read_b64_tr_b16 a[26:27], v16 offset:25760
    v_mfma_f32_16x16x32_bf16 v[140:143], a[8:11], v[56:59], v[140:143]
    ds_read_b64_tr_b16 a[28:29], v16 offset:30880
    v_mfma_f32_16x16x32_bf16 v[140:143], a[12:15], v[68:71], v[140:143]
    ds_read_b64_tr_b16 a[30:31], v16 offset:36000
    v_mfma_f32_16x16x32_bf16 v[180:183], a[8:11], v[60:63], v[180:183]
    v_mfma_f32_16x16x32_bf16 v[180:183], a[12:15], v[72:75], v[180:183]
    v_mfma_f32_16x16x32_bf16 v[220:223], a[8:11], v[64:67], v[220:223]
    v_mfma_f32_16x16x32_bf16 v[220:223], a[12:15], v[76:79], v[220:223]
    s_waitcnt lgkmcnt(0)
    v_mfma_f32_16x16x32_bf16 v[144:147], a[16:19], v[56:59], v[144:147]
    ds_read_b64_tr_b16 a[0:1], v14 offset:20672
    v_mfma_f32_16x16x32_bf16 v[144:147], a[20:23], v[68:71], v[144:147]
    ds_read_b64_tr_b16 a[2:3], v14 offset:25792
    v_mfma_f32_16x16x32_bf16 v[184:187], a[16:19], v[60:63], v[184:187]
    ds_read_b64_tr_b16 a[4:5], v14 offset:30912
    v_mfma_f32_16x16x32_bf16 v[184:187], a[20:23], v[72:75], v[184:187]
    ds_read_b64_tr_b16 a[6:7], v14 offset:36032
    v_mfma_f32_16x16x32_bf16 v[224:227], a[16:19], v[64:67], v[224:227]
    ds_read_b64_tr_b16 a[8:9], v16 offset:20704
    v_mfma_f32_16x16x32_bf16 v[224:227], a[20:23], v[76:79], v[224:227]
    ds_read_b64_tr_b16 a[10:11], v16 offset:25824
    v_mfma_f32_16x16x32_bf16 v[148:151], a[24:27], v[56:59], v[148:151]
    ds_read_b64_tr_b16 a[12:13], v16 offset:30944
    v_mfma_f32_16x16x32_bf16 v[148:151], a[28:31], v[68:71], v[148:151]
    ds_read_b64_tr_b16 a[14:15], v16 offset:36064
    v_mfma_f32_16x16x32_bf16 v[188:191], a[24:27], v[60:63], v[188:191]
    v_mfma_f32_16x16x32_bf16 v[188:191], a[28:31], v[72:75], v[188:191]
    v_mfma_f32_16x16x32_bf16 v[228:231], a[24:27], v[64:67], v[228:231]
    v_mfma_f32_16x16x32_bf16 v[228:231], a[28:31], v[76:79], v[228:231]
    s_waitcnt lgkmcnt(0)
    v_mfma_f32_16x16x32_bf16 v[152:155], a[0:3], v[56:59], v[152:155]
    ds_read_b64_tr_b16 a[16:17], v14 offset:20736
    v_mfma_f32_16x16x32_bf16 v[152:155], a[4:7], v[68:71], v[152:155]
    ds_read_b64_tr_b16 a[18:19], v14 offset:25856
    v_mfma_f32_16x16x32_bf16 v[192:195], a[0:3], v[60:63], v[192:195]
    ds_read_b64_tr_b16 a[20:21], v14 offset:30976
    v_mfma_f32_16x16x32_bf16 v[192:195], a[4:7], v[72:75], v[192:195]
    ds_read_b64_tr_b16 a[22:23], v14 offset:36096
    v_mfma_f32_16x16x32_bf16 v[232:235], a[0:3], v[64:67], v[232:235]
    ds_read_b64_tr_b16 a[24:25], v16 offset:20768
    v_mfma_f32_16x16x32_bf16 v[232:235], a[4:7], v[76:79], v[232:235]
    ds_read_b64_tr_b16 a[26:27], v16 offset:25888
    v_mfma_f32_16x16x32_bf16 v[156:159], a[8:11], v[56:59], v[156:159]
    ds_read_b64_tr_b16 a[28:29], v16 offset:31008
    v_mfma_f32_16x16x32_bf16 v[156:159], a[12:15], v[68:71], v[156:159]
    ds_read_b64_tr_b16 a[30:31], v16 offset:36128
    v_mfma_f32_16x16x32_bf16 v[196:199], a[8:11], v[60:63], v[196:199]
    v_mfma_f32_16x16x32_bf16 v[196:199], a[12:15], v[72:75], v[196:199]
    v_mfma_f32_16x16x32_bf16 v[236:239], a[8:11], v[64:67], v[236:239]
    v_mfma_f32_16x16x32_bf16 v[236:239], a[12:15], v[76:79], v[236:239]
    s_waitcnt vmcnt(12) lgkmcnt(0)
    s_barrier
    v_mfma_f32_16x16x32_bf16 v[160:163], a[16:19], v[56:59], v[160:163]
    ds_read_b64_tr_b16 a[0:1], v14 offset:40960
    v_mfma_f32_16x16x32_bf16 v[160:163], a[20:23], v[68:71], v[160:163]
    ds_read_b64_tr_b16 a[2:3], v14 offset:46080
    v_mfma_f32_16x16x32_bf16 v[200:203], a[16:19], v[60:63], v[200:203]
    ds_read_b64_tr_b16 a[4:5], v14 offset:51200
    v_mfma_f32_16x16x32_bf16 v[200:203], a[20:23], v[72:75], v[200:203]
    ds_read_b64_tr_b16 a[6:7], v14 offset:56320
    v_mfma_f32_16x16x32_bf16 v[240:243], a[16:19], v[64:67], v[240:243]
    ds_read_b64_tr_b16 a[8:9], v16 offset:40992
    v_mfma_f32_16x16x32_bf16 v[240:243], a[20:23], v[76:79], v[240:243]
    ds_read_b64_tr_b16 a[10:11], v16 offset:46112
    v_mfma_f32_16x16x32_bf16 v[164:167], a[24:27], v[56:59], v[164:167]
    ds_read_b64_tr_b16 a[12:13], v16 offset:51232
    v_mfma_f32_16x16x32_bf16 v[164:167], a[28:31], v[68:71], v[164:167]
    ds_read_b64_tr_b16 a[14:15], v16 offset:56352
    v_mfma_f32_16x16x32_bf16 v[204:207], a[24:27], v[60:63], v[204:207]
    v_mfma_f32_16x16x32_bf16 v[204:207], a[28:31], v[72:75], v[204:207]
    v_mfma_f32_16x16x32_bf16 v[244:247], a[24:27], v[64:67], v[244:247]
    v_mfma_f32_16x16x32_bf16 v[244:247], a[28:31], v[76:79], v[244:247]
    s_waitcnt lgkmcnt(0)
    v_mfma_f32_16x16x32_bf16 v[128:131], a[0:3], v[80:83], v[128:131]
    ds_read_b64_tr_b16 a[16:17], v14 offset:41024
    v_mfma_f32_16x16x32_bf16 v[128:131], a[4:7], v[92:95], v[128:131]
    ds_read_b64_tr_b16 a[18:19], v14 offset:46144
    v_mfma_f32_16x16x32_bf16 v[168:171], a[0:3], v[84:87], v[168:171]
    ds_read_b64_tr_b16 a[20:21], v14 offset:51264
    v_mfma_f32_16x16x32_bf16 v[168:171], a[4:7], v[96:99], v[168:171]
    ds_read_b64_tr_b16 a[22:23], v14 offset:56384
    v_mfma_f32_16x16x32_bf16 v[208:211], a[0:3], v[88:91], v[208:211]
    ds_read_b64_tr_b16 a[24:25], v16 offset:41056
    v_mfma_f32_16x16x32_bf16 v[208:211], a[4:7], v[100:103], v[208:211]
    ds_read_b64_tr_b16 a[26:27], v16 offset:46176
    v_mfma_f32_16x16x32_bf16 v[132:135], a[8:11], v[80:83], v[132:135]
    ds_read_b64_tr_b16 a[28:29], v16 offset:51296
    v_mfma_f32_16x16x32_bf16 v[132:135], a[12:15], v[92:95], v[132:135]
    ds_read_b64_tr_b16 a[30:31], v16 offset:56416
    v_mfma_f32_16x16x32_bf16 v[172:175], a[8:11], v[84:87], v[172:175]
    v_mfma_f32_16x16x32_bf16 v[172:175], a[12:15], v[96:99], v[172:175]
    v_mfma_f32_16x16x32_bf16 v[212:215], a[8:11], v[88:91], v[212:215]
    v_mfma_f32_16x16x32_bf16 v[212:215], a[12:15], v[100:103], v[212:215]
    s_waitcnt lgkmcnt(0)
    v_mfma_f32_16x16x32_bf16 v[136:139], a[16:19], v[80:83], v[136:139]
    ds_read_b64_tr_b16 a[0:1], v14 offset:41088
    v_mfma_f32_16x16x32_bf16 v[136:139], a[20:23], v[92:95], v[136:139]
    ds_read_b64_tr_b16 a[2:3], v14 offset:46208
    v_mfma_f32_16x16x32_bf16 v[176:179], a[16:19], v[84:87], v[176:179]
    ds_read_b64_tr_b16 a[4:5], v14 offset:51328
    v_mfma_f32_16x16x32_bf16 v[176:179], a[20:23], v[96:99], v[176:179]
    ds_read_b64_tr_b16 a[6:7], v14 offset:56448
    v_mfma_f32_16x16x32_bf16 v[216:219], a[16:19], v[88:91], v[216:219]
    ds_read_b64_tr_b16 a[8:9], v16 offset:41120
    v_mfma_f32_16x16x32_bf16 v[216:219], a[20:23], v[100:103], v[216:219]
    ds_read_b64_tr_b16 a[10:11], v16 offset:46240
    v_mfma_f32_16x16x32_bf16 v[140:143], a[24:27], v[80:83], v[140:143]
    ds_read_b64_tr_b16 a[12:13], v16 offset:51360
    v_mfma_f32_16x16x32_bf16 v[140:143], a[28:31], v[92:95], v[140:143]
    ds_read_b64_tr_b16 a[14:15], v16 offset:56480
    v_mfma_f32_16x16x32_bf16 v[180:183], a[24:27], v[84:87], v[180:183]
    v_mfma_f32_16x16x32_bf16 v[180:183], a[28:31], v[96:99], v[180:183]
    v_mfma_f32_16x16x32_bf16 v[220:223], a[24:27], v[88:91], v[220:223]
    v_mfma_f32_16x16x32_bf16 v[220:223], a[28:31], v[100:103], v[220:223]
    s_waitcnt lgkmcnt(0)
    v_mfma_f32_16x16x32_bf16 v[144:147], a[0:3], v[80:83], v[144:147]
    ds_read_b64_tr_b16 a[16:17], v14 offset:41152
    v_mfma_f32_16x16x32_bf16 v[144:147], a[4:7], v[92:95], v[144:147]
    ds_read_b64_tr_b16 a[18:19], v14 offset:46272
    v_mfma_f32_16x16x32_bf16 v[184:187], a[0:3], v[84:87], v[184:187]
    ds_read_b64_tr_b16 a[20:21], v14 offset:51392
    v_mfma_f32_16x16x32_bf16 v[184:187], a[4:7], v[96:99], v[184:187]
    ds_read_b64_tr_b16 a[22:23], v14 offset:56512
    v_mfma_f32_16x16x32_bf16 v[224:227], a[0:3], v[88:91], v[224:227]
    ds_read_b64_tr_b16 a[24:25], v16 offset:41184
    v_mfma_f32_16x16x32_bf16 v[224:227], a[4:7], v[100:103], v[224:227]
    ds_read_b64_tr_b16 a[26:27], v16 offset:46304
    v_mfma_f32_16x16x32_bf16 v[148:151], a[8:11], v[80:83], v[148:151]
    ds_read_b64_tr_b16 a[28:29], v16 offset:51424
    v_mfma_f32_16x16x32_bf16 v[148:151], a[12:15], v[92:95], v[148:151]
    ds_read_b64_tr_b16 a[30:31], v16 offset:56544
    v_mfma_f32_16x16x32_bf16 v[188:191], a[8:11], v[84:87], v[188:191]
    v_mfma_f32_16x16x32_bf16 v[188:191], a[12:15], v[96:99], v[188:191]
    v_mfma_f32_16x16x32_bf16 v[228:231], a[8:11], v[88:91], v[228:231]
    v_mfma_f32_16x16x32_bf16 v[228:231], a[12:15], v[100:103], v[228:231]
    s_waitcnt lgkmcnt(0)
    v_mfma_f32_16x16x32_bf16 v[152:155], a[16:19], v[80:83], v[152:155]
    ds_read_b64_tr_b16 a[0:1], v14 offset:41216
    v_mfma_f32_16x16x32_bf16 v[152:155], a[20:23], v[92:95], v[152:155]
    ds_read_b64_tr_b16 a[2:3], v14 offset:46336
    v_mfma_f32_16x16x32_bf16 v[192:195], a[16:19], v[84:87], v[192:195]
    ds_read_b64_tr_b16 a[4:5], v14 offset:51456
    v_mfma_f32_16x16x32_bf16 v[192:195], a[20:23], v[96:99], v[192:195]
    ds_read_b64_tr_b16 a[6:7], v14 offset:56576
    v_mfma_f32_16x16x32_bf16 v[232:235], a[16:19], v[88:91], v[232:235]
    ds_read_b64_tr_b16 a[8:9], v16 offset:41248
    v_mfma_f32_16x16x32_bf16 v[232:235], a[20:23], v[100:103], v[232:235]
    ds_read_b64_tr_b16 a[10:11], v16 offset:46368
    v_mfma_f32_16x16x32_bf16 v[156:159], a[24:27], v[80:83], v[156:159]
    ds_read_b64_tr_b16 a[12:13], v16 offset:51488
    v_mfma_f32_16x16x32_bf16 v[156:159], a[28:31], v[92:95], v[156:159]
    ds_read_b64_tr_b16 a[14:15], v16 offset:56608
    v_mfma_f32_16x16x32_bf16 v[196:199], a[24:27], v[84:87], v[196:199]
    v_mfma_f32_16x16x32_bf16 v[196:199], a[28:31], v[96:99], v[196:199]
    v_mfma_f32_16x16x32_bf16 v[236:239], a[24:27], v[88:91], v[236:239]
    v_mfma_f32_16x16x32_bf16 v[236:239], a[28:31], v[100:103], v[236:239]
    s_waitcnt vmcnt(0) lgkmcnt(0)
    s_barrier
    v_mfma_f32_16x16x32_bf16 v[160:163], a[0:3], v[80:83], v[160:163]
    ds_read_b64_tr_b16 a[16:17], v15 offset:0
    v_mfma_f32_16x16x32_bf16 v[160:163], a[4:7], v[92:95], v[160:163]
    ds_read_b64_tr_b16 a[18:19], v15 offset:5120
    v_mfma_f32_16x16x32_bf16 v[200:203], a[0:3], v[84:87], v[200:203]
    ds_read_b64_tr_b16 a[20:21], v15 offset:10240
    v_mfma_f32_16x16x32_bf16 v[200:203], a[4:7], v[96:99], v[200:203]
    ds_read_b64_tr_b16 a[22:23], v15 offset:15360
    v_mfma_f32_16x16x32_bf16 v[240:243], a[0:3], v[88:91], v[240:243]
    ds_read_b64_tr_b16 a[24:25], v17 offset:32
    v_mfma_f32_16x16x32_bf16 v[240:243], a[4:7], v[100:103], v[240:243]
    ds_read_b64_tr_b16 a[26:27], v17 offset:5152
    v_mfma_f32_16x16x32_bf16 v[164:167], a[8:11], v[80:83], v[164:167]
    ds_read_b64_tr_b16 a[28:29], v17 offset:10272
    v_mfma_f32_16x16x32_bf16 v[164:167], a[12:15], v[92:95], v[164:167]
    ds_read_b64_tr_b16 a[30:31], v17 offset:15392
    v_mfma_f32_16x16x32_bf16 v[204:207], a[8:11], v[84:87], v[204:207]
    v_mfma_f32_16x16x32_bf16 v[204:207], a[12:15], v[96:99], v[204:207]
    v_mfma_f32_16x16x32_bf16 v[244:247], a[8:11], v[88:91], v[244:247]
    v_mfma_f32_16x16x32_bf16 v[244:247], a[12:15], v[100:103], v[244:247]
    s_waitcnt lgkmcnt(0)
    v_mfma_f32_16x16x32_bf16 v[128:131], a[16:19], v[104:107], v[128:131]
    ds_read_b64_tr_b16 a[0:1], v15 offset:64
    v_mfma_f32_16x16x32_bf16 v[128:131], a[20:23], v[116:119], v[128:131]
    ds_read_b64_tr_b16 a[2:3], v15 offset:5184
    v_mfma_f32_16x16x32_bf16 v[168:171], a[16:19], v[108:111], v[168:171]
    ds_read_b64_tr_b16 a[4:5], v15 offset:10304
    v_mfma_f32_16x16x32_bf16 v[168:171], a[20:23], v[120:123], v[168:171]
    ds_read_b64_tr_b16 a[6:7], v15 offset:15424
    v_mfma_f32_16x16x32_bf16 v[208:211], a[16:19], v[112:115], v[208:211]
    ds_read_b64_tr_b16 a[8:9], v17 offset:96
    v_mfma_f32_16x16x32_bf16 v[208:211], a[20:23], v[124:127], v[208:211]
    ds_read_b64_tr_b16 a[10:11], v17 offset:5216
    v_mfma_f32_16x16x32_bf16 v[132:135], a[24:27], v[104:107], v[132:135]
    ds_read_b64_tr_b16 a[12:13], v17 offset:10336
    v_mfma_f32_16x16x32_bf16 v[132:135], a[28:31], v[116:119], v[132:135]
    ds_read_b64_tr_b16 a[14:15], v17 offset:15456
    v_mfma_f32_16x16x32_bf16 v[172:175], a[24:27], v[108:111], v[172:175]
    v_mfma_f32_16x16x32_bf16 v[172:175], a[28:31], v[120:123], v[172:175]
    v_mfma_f32_16x16x32_bf16 v[212:215], a[24:27], v[112:115], v[212:215]
    v_mfma_f32_16x16x32_bf16 v[212:215], a[28:31], v[124:127], v[212:215]
    s_waitcnt lgkmcnt(0)
    v_mfma_f32_16x16x32_bf16 v[136:139], a[0:3], v[104:107], v[136:139]
    ds_read_b64_tr_b16 a[16:17], v15 offset:128
    v_mfma_f32_16x16x32_bf16 v[136:139], a[4:7], v[116:119], v[136:139]
    ds_read_b64_tr_b16 a[18:19], v15 offset:5248
    v_mfma_f32_16x16x32_bf16 v[176:179], a[0:3], v[108:111], v[176:179]
    ds_read_b64_tr_b16 a[20:21], v15 offset:10368
    v_mfma_f32_16x16x32_bf16 v[176:179], a[4:7], v[120:123], v[176:179]
    ds_read_b64_tr_b16 a[22:23], v15 offset:15488
    v_mfma_f32_16x16x32_bf16 v[216:219], a[0:3], v[112:115], v[216:219]
    ds_read_b64_tr_b16 a[24:25], v17 offset:160
    v_mfma_f32_16x16x32_bf16 v[216:219], a[4:7], v[124:127], v[216:219]
    ds_read_b64_tr_b16 a[26:27], v17 offset:5280
    v_mfma_f32_16x16x32_bf16 v[140:143], a[8:11], v[104:107], v[140:143]
    ds_read_b64_tr_b16 a[28:29], v17 offset:10400
    v_mfma_f32_16x16x32_bf16 v[140:143], a[12:15], v[116:119], v[140:143]
    ds_read_b64_tr_b16 a[30:31], v17 offset:15520
    v_mfma_f32_16x16x32_bf16 v[180:183], a[8:11], v[108:111], v[180:183]
    v_mfma_f32_16x16x32_bf16 v[180:183], a[12:15], v[120:123], v[180:183]
    v_mfma_f32_16x16x32_bf16 v[220:223], a[8:11], v[112:115], v[220:223]
    v_mfma_f32_16x16x32_bf16 v[220:223], a[12:15], v[124:127], v[220:223]
    s_waitcnt lgkmcnt(0)
    v_mfma_f32_16x16x32_bf16 v[144:147], a[16:19], v[104:107], v[144:147]
    ds_read_b64_tr_b16 a[0:1], v15 offset:192
    v_mfma_f32_16x16x32_bf16 v[144:147], a[20:23], v[116:119], v[144:147]
    ds_read_b64_tr_b16 a[2:3], v15 offset:5312
    v_mfma_f32_16x16x32_bf16 v[184:187], a[16:19], v[108:111], v[184:187]
    ds_read_b64_tr_b16 a[4:5], v15 offset:10432
    v_mfma_f32_16x16x32_bf16 v[184:187], a[20:23], v[120:123], v[184:187]
    ds_read_b64_tr_b16 a[6:7], v15 offset:15552
    v_mfma_f32_16x16x32_bf16 v[224:227], a[16:19], v[112:115], v[224:227]
    ds_read_b64_tr_b16 a[8:9], v17 offset:224
    v_mfma_f32_16x16x32_bf16 v[224:227], a[20:23], v[124:127], v[224:227]
    ds_read_b64_tr_b16 a[10:11], v17 offset:5344
    v_mfma_f32_16x16x32_bf16 v[148:151], a[24:27], v[104:107], v[148:151]
    ds_read_b64_tr_b16 a[12:13], v17 offset:10464
    v_mfma_f32_16x16x32_bf16 v[148:151], a[28:31], v[116:119], v[148:151]
    ds_read_b64_tr_b16 a[14:15], v17 offset:15584
    v_mfma_f32_16x16x32_bf16 v[188:191], a[24:27], v[108:111], v[188:191]
    v_mfma_f32_16x16x32_bf16 v[188:191], a[28:31], v[120:123], v[188:191]
    v_mfma_f32_16x16x32_bf16 v[228:231], a[24:27], v[112:115], v[228:231]
    v_mfma_f32_16x16x32_bf16 v[228:231], a[28:31], v[124:127], v[228:231]
    s_waitcnt lgkmcnt(0)
    v_mfma_f32_16x16x32_bf16 v[152:155], a[0:3], v[104:107], v[152:155]
    ds_read_b64_tr_b16 a[16:17], v15 offset:256
    v_mfma_f32_16x16x32_bf16 v[152:155], a[4:7], v[116:119], v[152:155]
    ds_read_b64_tr_b16 a[18:19], v15 offset:5376
    v_mfma_f32_16x16x32_bf16 v[192:195], a[0:3], v[108:111], v[192:195]
    ds_read_b64_tr_b16 a[20:21], v15 offset:10496
    v_mfma_f32_16x16x32_bf16 v[192:195], a[4:7], v[120:123], v[192:195]
    ds_read_b64_tr_b16 a[22:23], v15 offset:15616
    v_mfma_f32_16x16x32_bf16 v[232:235], a[0:3], v[112:115], v[232:235]
    ds_read_b64_tr_b16 a[24:25], v17 offset:288
    v_mfma_f32_16x16x32_bf16 v[232:235], a[4:7], v[124:127], v[232:235]
    ds_read_b64_tr_b16 a[26:27], v17 offset:5408
    v_mfma_f32_16x16x32_bf16 v[156:159], a[8:11], v[104:107], v[156:159]
    ds_read_b64_tr_b16 a[28:29], v17 offset:10528
    v_mfma_f32_16x16x32_bf16 v[156:159], a[12:15], v[116:119], v[156:159]
    ds_read_b64_tr_b16 a[30:31], v17 offset:15648
    v_mfma_f32_16x16x32_bf16 v[196:199], a[8:11], v[108:111], v[196:199]
    v_mfma_f32_16x16x32_bf16 v[196:199], a[12:15], v[120:123], v[196:199]
    v_mfma_f32_16x16x32_bf16 v[236:239], a[8:11], v[112:115], v[236:239]
    v_mfma_f32_16x16x32_bf16 v[236:239], a[12:15], v[124:127], v[236:239]
    s_waitcnt vmcnt(63) lgkmcnt(0)
    s_barrier
    v_mfma_f32_16x16x32_bf16 v[160:163], a[16:19], v[104:107], v[160:163]
    v_mfma_f32_16x16x32_bf16 v[160:163], a[20:23], v[116:119], v[160:163]
    v_mfma_f32_16x16x32_bf16 v[200:203], a[16:19], v[108:111], v[200:203]
    v_mfma_f32_16x16x32_bf16 v[200:203], a[20:23], v[120:123], v[200:203]
    v_mfma_f32_16x16x32_bf16 v[240:243], a[16:19], v[112:115], v[240:243]
    v_mfma_f32_16x16x32_bf16 v[240:243], a[20:23], v[124:127], v[240:243]
    v_mfma_f32_16x16x32_bf16 v[164:167], a[24:27], v[104:107], v[164:167]
    v_mfma_f32_16x16x32_bf16 v[164:167], a[28:31], v[116:119], v[164:167]
    v_mfma_f32_16x16x32_bf16 v[204:207], a[24:27], v[108:111], v[204:207]
    v_mfma_f32_16x16x32_bf16 v[204:207], a[28:31], v[120:123], v[204:207]
    v_mfma_f32_16x16x32_bf16 v[244:247], a[24:27], v[112:115], v[244:247]
    v_mfma_f32_16x16x32_bf16 v[244:247], a[28:31], v[124:127], v[244:247]
    s_nop 7
    s_lshl_b32 s23, s3, 2
    s_add_u32 s23, s23, s84
    s_mul_i32 s23, s23, 15360
    v_lshlrev_b32 v4, 4, v1
    s_cmp_eq_u32 s3, s84
    s_cbranch_scc1 K2_own
    v_cvt_pk_bf16_f32 v32, v128, v129
    v_cvt_pk_bf16_f32 v33, v130, v131
    v_cvt_pk_bf16_f32 v34, v132, v133
    v_cvt_pk_bf16_f32 v35, v134, v135
    s_add_u32 s24, s23, 0
    buffer_store_dwordx4 v[32:35], v4, s[16:19], s24 offen sc1
    v_cvt_pk_bf16_f32 v36, v136, v137
    v_cvt_pk_bf16_f32 v37, v138, v139
    v_cvt_pk_bf16_f32 v38, v140, v141
    v_cvt_pk_bf16_f32 v39, v142, v143
    buffer_store_dwordx4 v[36:39], v4, s[16:19], s24 offen offset:1024 sc1
    v_cvt_pk_bf16_f32 v40, v144, v145
    v_cvt_pk_bf16_f32 v41, v146, v147
    v_cvt_pk_bf16_f32 v42, v148, v149
    v_cvt_pk_bf16_f32 v43, v150, v151
    buffer_store_dwordx4 v[40:43], v4, s[16:19], s24 offen offset:2048 sc1
    v_cvt_pk_bf16_f32 v44, v152, v153
    v_cvt_pk_bf16_f32 v45, v154, v155
    v_cvt_pk_bf16_f32 v46, v156, v157
    v_cvt_pk_bf16_f32 v47, v158, v159
    buffer_store_dwordx4 v[44:47], v4, s[16:19], s24 offen offset:3072 sc1
    v_cvt_pk_bf16_f32 v48, v160, v161
    v_cvt_pk_bf16_f32 v49, v162, v163
    v_cvt_pk_bf16_f32 v50, v164, v165
    v_cvt_pk_bf16_f32 v51, v166, v167
    s_add_u32 s24, s23, 4096
    buffer_store_dwordx4 v[48:51], v4, s[16:19], s24 offen sc1
    v_cvt_pk_bf16_f32 v52, v168, v169
    v_cvt_pk_bf16_f32 v53, v170, v171
    v_cvt_pk_bf16_f32 v54, v172, v173
    v_cvt_pk_bf16_f32 v55, v174, v175
    buffer_store_dwordx4 v[52:55], v4, s[16:19], s24 offen offset:1024 sc1
    v_cvt_pk_bf16_f32 v56, v176, v177
    v_cvt_pk_bf16_f32 v57, v178, v179
    v_cvt_pk_bf16_f32 v58, v180, v181
    v_cvt_pk_bf16_f32 v59, v182, v183
    buffer_store_dwordx4 v[56:59], v4, s[16:19], s24 offen offset:2048 sc1
    v_cvt_pk_bf16_f32 v60, v184, v185
    v_cvt_pk_bf16_f32 v61, v186, v187
    v_cvt_pk_bf16_f32 v62, v188, v189
    v_cvt_pk_bf16_f32 v63, v190, v191
    buffer_store_dwordx4 v[60:63], v4, s[16:19], s24 offen offset:3072 sc1
    v_cvt_pk_bf16_f32 v32, v192, v193
    v_cvt_pk_bf16_f32 v33, v194, v195
    v_cvt_pk_bf16_f32 v34, v196, v197
    v_cvt_pk_bf16_f32 v35, v198, v199
    s_add_u32 s24, s23, 8192
    buffer_store_dwordx4 v[32:35], v4, s[16:19], s24 offen sc1
    v_cvt_pk_bf16_f32 v36, v200, v201
    v_cvt_pk_bf16_f32 v37, v202, v203
    v_cvt_pk_bf16_f32 v38, v204, v205
    v_cvt_pk_bf16_f32 v39, v206, v207
    buffer_store_dwordx4 v[36:39], v4, s[16:19], s24 offen offset:1024 sc1
    v_cvt_pk_bf16_f32 v40, v208, v209
    v_cvt_pk_bf16_f32 v41, v210, v211
    v_cvt_pk_bf16_f32 v42, v212, v213
    v_cvt_pk_bf16_f32 v43, v214, v215
    buffer_store_dwordx4 v[40:43], v4, s[16:19], s24 offen offset:2048 sc1
    v_cvt_pk_bf16_f32 v44, v216, v217
    v_cvt_pk_bf16_f32 v45, v218, v219
    v_cvt_pk_bf16_f32 v46, v220, v221
    v_cvt_pk_bf16_f32 v47, v222, v223
    buffer_store_dwordx4 v[44:47], v4, s[16:19], s24 offen offset:3072 sc1
    v_cvt_pk_bf16_f32 v48, v224, v225
    v_cvt_pk_bf16_f32 v49, v226, v227
    v_cvt_pk_bf16_f32 v50, v228, v229
    v_cvt_pk_bf16_f32 v51, v230, v231
    s_add_u32 s24, s23, 12288
    buffer_store_dwordx4 v[48:51], v4, s[16:19], s24 offen sc1
    v_cvt_pk_bf16_f32 v52, v232, v233
    v_cvt_pk_bf16_f32 v53, v234, v235
    v_cvt_pk_bf16_f32 v54, v236, v237
    v_cvt_pk_bf16_f32 v55, v238, v239
    buffer_store_dwordx4 v[52:55], v4, s[16:19], s24 offen offset:1024 sc1
    v_cvt_pk_bf16_f32 v56, v240, v241
    v_cvt_pk_bf16_f32 v57, v242, v243
    v_cvt_pk_bf16_f32 v58, v244, v245
    v_cvt_pk_bf16_f32 v59, v246, v247
    buffer_store_dwordx4 v[56:59], v4, s[16:19], s24 offen offset:2048 sc1
    s_branch K2_pub
K2_own:
    ds_write_b128 v4, v[128:131] offset:0
    ds_write_b128 v4, v[132:135] offset:1024
    ds_write_b128 v4, v[136:139] offset:2048
    ds_write_b128 v4, v[140:143] offset:3072
    ds_write_b128 v4, v[144:147] offset:4096
    ds_write_b128 v4, v[148:151] offset:5120
    ds_write_b128 v4, v[152:155] offset:6144
    ds_write_b128 v4, v[156:159] offset:7168
    s_waitcnt lgkmcnt(4)
    ds_write_b128 v4, v[160:163] offset:8192
    ds_write_b128 v4, v[164:167] offset:9216
    ds_write_b128 v4, v[168:171] offset:10240
    ds_write_b128 v4, v[172:175] offset:11264
    ds_write_b128 v4, v[176:179] offset:12288
    ds_write_b128 v4, v[180:183] offset:13312
    ds_write_b128 v4, v[184:187] offset:14336
    ds_write_b128 v4, v[188:191] offset:15360
    s_waitcnt lgkmcnt(4)
    ds_write_b128 v4, v[192:195] offset:16384
    ds_write_b128 v4, v[196:199] offset:17408
    ds_write_b128 v4, v[200:203] offset:18432
    ds_write_b128 v4, v[204:207] offset:19456
    ds_write_b128 v4, v[208:211] offset:20480
    ds_write_b128 v4, v[212:215] offset:21504
    ds_write_b128 v4, v[216:219] offset:22528
    ds_write_b128 v4, v[220:223] offset:23552
    s_waitcnt lgkmcnt(4)
    ds_write_b128 v4, v[224:227] offset:24576
    ds_write_b128 v4, v[228:231] offset:25600
    ds_write_b128 v4, v[232:235] offset:26624
    ds_write_b128 v4, v[236:239] offset:27648
    ds_write_b128 v4, v[240:243] offset:28672
    ds_write_b128 v4, v[244:247] offset:29696
K2_pub:
    s_mul_i32 s23, s7, 192
    s_mul_i32 s24, s84, 48
    s_add_u32 s23, s23, s24
    v_and_b32 v2, 15, v1
    v_add_u32 v2, s23, v2
    s_mov_b32 s24, 2560
    v_mul_lo_u32 v2, v2, s24
    s_mul_i32 s23, s6, 640
    s_mul_i32 s24, s85, 160
    s_add_u32 s23, s23, s24
    v_lshrrev_b32 v3, 4, v1
    v_lshlrev_b32 v3, 3, v3
    v_add_u32 v3, s23, v3
    v_lshlrev_b32 v3, 1, v3
    v_add_u32 v2, v2, v3
    s_waitcnt vmcnt(0) lgkmcnt(0)
    s_barrier
    s_cmp_lg_u32 s3, 0
    s_cbranch_scc1 K2_wait
    v_mov_b32 v5, 0
    v_mov_b32 v6, 1
    s_mov_b64 exec, 1
    buffer_atomic_add v6, v5, s[40:43], 0 offen sc1
K2_poll:
    buffer_load_dword v7, v5, s[40:43], 0 offen sc1
    s_waitcnt vmcnt(0)
    v_readfirstlane_b32 s23, v7
    s_nop 0
    s_cmp_ge_u32 s23, 4
    s_cbranch_scc1 K2_polled
    s_sleep 2
    s_branch K2_poll
K2_polled:
    s_mov_b64 exec, -1
K2_wait:
    s_barrier
    s_add_u32 s23, s84, 1
    s_and_b32 s23, s23, 3
    s_lshl_b32 s24, s84, 2
    s_add_u32 s23, s23, s24
    s_mul_i32 s52, s23, 15360
    s_add_u32 s23, s84, 2
    s_and_b32 s23, s23, 3
    s_lshl_b32 s24, s84, 2
    s_add_u32 s23, s23, s24
    s_mul_i32 s53, s23, 15360
    s_add_u32 s23, s84, 3
    s_and_b32 s23, s23, 3
    s_lshl_b32 s24, s84, 2
    s_add_u32 s23, s23, s24
    s_mul_i32 s54, s23, 15360
    s_lshl_b32 s25, s3, 10
    s_add_u32 s52, s52, s25
    s_add_u32 s53, s53, s25
    s_add_u32 s54, s54, s25
    s_lshl_b32 s25, s3, 11
    v_add_u32 v5, s25, v4
    buffer_load_dwordx4 v[32:35], v4, s[16:19], s52 offen sc1
    buffer_load_dwordx4 v[36:39], v4, s[16:19], s53 offen sc1
    buffer_load_dwordx4 v[40:43], v4, s[16:19], s54 offen sc1
    s_add_u32 s52, s52, 4096
    s_add_u32 s53, s53, 4096
    s_add_u32 s54, s54, 4096
    ds_read_b128 v[128:131], v5 offset:0
    ds_read_b128 v[132:135], v5 offset:1024
    buffer_load_dwordx4 v[44:47], v4, s[16:19], s52 offen sc1
    buffer_load_dwordx4 v[48:51], v4, s[16:19], s53 offen sc1
    buffer_load_dwordx4 v[52:55], v4, s[16:19], s54 offen sc1
    s_add_u32 s52, s52, 4096
    s_add_u32 s53, s53, 4096
    s_add_u32 s54, s54, 4096
    ds_read_b128 v[136:139], v5 offset:8192
    ds_read_b128 v[140:143], v5 offset:9216
    buffer_load_dwordx4 v[56:59], v4, s[16:19], s52 offen sc1
    buffer_load_dwordx4 v[60:63], v4, s[16:19], s53 offen sc1
    buffer_load_dwordx4 v[64:67], v4, s[16:19], s54 offen sc1
    s_add_u32 s52, s52, 4096
    s_add_u32 s53, s53, 4096
    s_add_u32 s54, s54, 4096
    ds_read_b128 v[144:147], v5 offset:16384
    ds_read_b128 v[148:151], v5 offset:17408
    buffer_load_dwordx4 v[68:71], v4, s[16:19], s52 offen sc1
    buffer_load_dwordx4 v[72:75], v4, s[16:19], s53 offen sc1
    buffer_load_dwordx4 v[76:79], v4, s[16:19], s54 offen sc1
    ds_read_b128 v[152:155], v5 offset:24576
    ds_read_b128 v[156:159], v5 offset:25600
    s_waitcnt lgkmcnt(0)
    s_waitcnt vmcnt(9)
    v_lshlrev_b32 v96, 16, v32
    v_add_f32 v128, v128, v96
    v_and_b32 v96, 4294901760, v32
    v_add_f32 v129, v129, v96
    v_lshlrev_b32 v96, 16, v33
    v_add_f32 v130, v130, v96
    v_and_b32 v96, 4294901760, v33
    v_add_f32 v131, v131, v96
    v_lshlrev_b32 v96, 16, v34
    v_add_f32 v132, v132, v96
    v_and_b32 v96, 4294901760, v34
    v_add_f32 v133, v133, v96
    v_lshlrev_b32 v96, 16, v35
    v_add_f32 v134, v134, v96
    v_and_b32 v96, 4294901760, v35
    v_add_f32 v135, v135, v96
    v_lshlrev_b32 v96, 16, v36
    v_add_f32 v128, v128, v96
    v_and_b32 v96, 4294901760, v36
    v_add_f32 v129, v129, v96
    v_lshlrev_b32 v96, 16, v37
    v_add_f32 v130, v130, v96
    v_and_b32 v96, 4294901760, v37
    v_add_f32 v131, v131, v96
    v_lshlrev_b32 v96, 16, v38
    v_add_f32 v132, v132, v96
    v_and_b32 v96, 4294901760, v38
    v_add_f32 v133, v133, v96
    v_lshlrev_b32 v96, 16, v39
    v_add_f32 v134, v134, v96
    v_and_b32 v96, 4294901760, v39
    v_add_f32 v135, v135, v96
    v_lshlrev_b32 v96, 16, v40
    v_add_f32 v128, v128, v96
    v_and_b32 v96, 4294901760, v40
    v_add_f32 v129, v129, v96
    v_lshlrev_b32 v96, 16, v41
    v_add_f32 v130, v130, v96
    v_and_b32 v96, 4294901760, v41
    v_add_f32 v131, v131, v96
    v_lshlrev_b32 v96, 16, v42
    v_add_f32 v132, v132, v96
    v_and_b32 v96, 4294901760, v42
    v_add_f32 v133, v133, v96
    v_lshlrev_b32 v96, 16, v43
    v_add_f32 v134, v134, v96
    v_and_b32 v96, 4294901760, v43
    v_add_f32 v135, v135, v96
    v_cvt_pk_bf16_f32 v100, v128, v129
    v_cvt_pk_bf16_f32 v101, v130, v131
    v_cvt_pk_bf16_f32 v102, v132, v133
    v_cvt_pk_bf16_f32 v103, v134, v135
    s_nop 0
    v_permlane32_swap_b32 v100, v102
    v_permlane32_swap_b32 v101, v103
    s_nop 0
    v_permlane16_swap_b32 v100, v102
    v_permlane16_swap_b32 v101, v103
    s_add_u32 s23, s3, 0
    s_mul_hi_u32 s24, s23, 858993460
    s_mul_i32 s27, s24, 5
    s_sub_u32 s27, s23, s27
    s_lshl_b32 s27, s27, 6
    s_mul_i32 s24, s24, 40960
    s_add_u32 s27, s27, s24
    buffer_store_dwordx4 v[100:103], v2, s[44:47], s27 offen
    s_waitcnt vmcnt(7)
    v_lshlrev_b32 v96, 16, v44
    v_add_f32 v136, v136, v96
    v_and_b32 v96, 4294901760, v44
    v_add_f32 v137, v137, v96
    v_lshlrev_b32 v96, 16, v45
    v_add_f32 v138, v138, v96
    v_and_b32 v96, 4294901760, v45
    v_add_f32 v139, v139, v96
    v_lshlrev_b32 v96, 16, v46
    v_add_f32 v140, v140, v96
    v_and_b32 v96, 4294901760, v46
    v_add_f32 v141, v141, v96
    v_lshlrev_b32 v96, 16, v47
    v_add_f32 v142, v142, v96
    v_and_b32 v96, 4294901760, v47
    v_add_f32 v143, v143, v96
    v_lshlrev_b32 v96, 16, v48
    v_add_f32 v136, v136, v96
    v_and_b32 v96, 4294901760, v48
    v_add_f32 v137, v137, v96
    v_lshlrev_b32 v96, 16, v49
    v_add_f32 v138, v138, v96
    v_and_b32 v96, 4294901760, v49
    v_add_f32 v139, v139, v96
    v_lshlrev_b32 v96, 16, v50
    v_add_f32 v140, v140, v96
    v_and_b32 v96, 4294901760, v50
    v_add_f32 v141, v141, v96
    v_lshlrev_b32 v96, 16, v51
    v_add_f32 v142, v142, v96
    v_and_b32 v96, 4294901760, v51
    v_add_f32 v143, v143, v96
    v_lshlrev_b32 v96, 16, v52
    v_add_f32 v136, v136, v96
    v_and_b32 v96, 4294901760, v52
    v_add_f32 v137, v137, v96
    v_lshlrev_b32 v96, 16, v53
    v_add_f32 v138, v138, v96
    v_and_b32 v96, 4294901760, v53
    v_add_f32 v139, v139, v96
    v_lshlrev_b32 v96, 16, v54
    v_add_f32 v140, v140, v96
    v_and_b32 v96, 4294901760, v54
    v_add_f32 v141, v141, v96
    v_lshlrev_b32 v96, 16, v55
    v_add_f32 v142, v142, v96
    v_and_b32 v96, 4294901760, v55
    v_add_f32 v143, v143, v96
    v_cvt_pk_bf16_f32 v104, v136, v137
    v_cvt_pk_bf16_f32 v105, v138, v139
    v_cvt_pk_bf16_f32 v106, v140, v141
    v_cvt_pk_bf16_f32 v107, v142, v143
    s_nop 0
    v_permlane32_swap_b32 v104, v106
    v_permlane32_swap_b32 v105, v107
    s_nop 0
    v_permlane16_swap_b32 v104, v106
    v_permlane16_swap_b32 v105, v107
    s_add_u32 s23, s3, 4
    s_mul_hi_u32 s24, s23, 858993460
    s_mul_i32 s27, s24, 5
    s_sub_u32 s27, s23, s27
    s_lshl_b32 s27, s27, 6
    s_mul_i32 s24, s24, 40960
    s_add_u32 s27, s27, s24
    buffer_store_dwordx4 v[104:107], v2, s[44:47], s27 offen
    s_waitcnt vmcnt(5)
    v_lshlrev_b32 v96, 16, v56
    v_add_f32 v144, v144, v96
    v_and_b32 v96, 4294901760, v56
    v_add_f32 v145, v145, v96
    v_lshlrev_b32 v96, 16, v57
    v_add_f32 v146, v146, v96
    v_and_b32 v96, 4294901760, v57
    v_add_f32 v147, v147, v96
    v_lshlrev_b32 v96, 16, v58
    v_add_f32 v148, v148, v96
    v_and_b32 v96, 4294901760, v58
    v_add_f32 v149, v149, v96
    v_lshlrev_b32 v96, 16, v59
    v_add_f32 v150, v150, v96
    v_and_b32 v96, 4294901760, v59
    v_add_f32 v151, v151, v96
    v_lshlrev_b32 v96, 16, v60
    v_add_f32 v144, v144, v96
    v_and_b32 v96, 4294901760, v60
    v_add_f32 v145, v145, v96
    v_lshlrev_b32 v96, 16, v61
    v_add_f32 v146, v146, v96
    v_and_b32 v96, 4294901760, v61
    v_add_f32 v147, v147, v96
    v_lshlrev_b32 v96, 16, v62
    v_add_f32 v148, v148, v96
    v_and_b32 v96, 4294901760, v62
    v_add_f32 v149, v149, v96
    v_lshlrev_b32 v96, 16, v63
    v_add_f32 v150, v150, v96
    v_and_b32 v96, 4294901760, v63
    v_add_f32 v151, v151, v96
    v_lshlrev_b32 v96, 16, v64
    v_add_f32 v144, v144, v96
    v_and_b32 v96, 4294901760, v64
    v_add_f32 v145, v145, v96
    v_lshlrev_b32 v96, 16, v65
    v_add_f32 v146, v146, v96
    v_and_b32 v96, 4294901760, v65
    v_add_f32 v147, v147, v96
    v_lshlrev_b32 v96, 16, v66
    v_add_f32 v148, v148, v96
    v_and_b32 v96, 4294901760, v66
    v_add_f32 v149, v149, v96
    v_lshlrev_b32 v96, 16, v67
    v_add_f32 v150, v150, v96
    v_and_b32 v96, 4294901760, v67
    v_add_f32 v151, v151, v96
    v_cvt_pk_bf16_f32 v108, v144, v145
    v_cvt_pk_bf16_f32 v109, v146, v147
    v_cvt_pk_bf16_f32 v110, v148, v149
    v_cvt_pk_bf16_f32 v111, v150, v151
    s_nop 0
    v_permlane32_swap_b32 v108, v110
    v_permlane32_swap_b32 v109, v111
    s_nop 0
    v_permlane16_swap_b32 v108, v110
    v_permlane16_swap_b32 v109, v111
    s_add_u32 s23, s3, 8
    s_mul_hi_u32 s24, s23, 858993460
    s_mul_i32 s27, s24, 5
    s_sub_u32 s27, s23, s27
    s_lshl_b32 s27, s27, 6
    s_mul_i32 s24, s24, 40960
    s_add_u32 s27, s27, s24
    buffer_store_dwordx4 v[108:111], v2, s[44:47], s27 offen
    s_waitcnt vmcnt(3)
    v_lshlrev_b32 v96, 16, v68
    v_add_f32 v152, v152, v96
    v_and_b32 v96, 4294901760, v68
    v_add_f32 v153, v153, v96
    v_lshlrev_b32 v96, 16, v69
    v_add_f32 v154, v154, v96
    v_and_b32 v96, 4294901760, v69
    v_add_f32 v155, v155, v96
    v_lshlrev_b32 v96, 16, v70
    v_add_f32 v156, v156, v96
    v_and_b32 v96, 4294901760, v70
    v_add_f32 v157, v157, v96
    v_lshlrev_b32 v96, 16, v71
    v_add_f32 v158, v158, v96
    v_and_b32 v96, 4294901760, v71
    v_add_f32 v159, v159, v96
    v_lshlrev_b32 v96, 16, v72
    v_add_f32 v152, v152, v96
    v_and_b32 v96, 4294901760, v72
    v_add_f32 v153, v153, v96
    v_lshlrev_b32 v96, 16, v73
    v_add_f32 v154, v154, v96
    v_and_b32 v96, 4294901760, v73
    v_add_f32 v155, v155, v96
    v_lshlrev_b32 v96, 16, v74
    v_add_f32 v156, v156, v96
    v_and_b32 v96, 4294901760, v74
    v_add_f32 v157, v157, v96
    v_lshlrev_b32 v96, 16, v75
    v_add_f32 v158, v158, v96
    v_and_b32 v96, 4294901760, v75
    v_add_f32 v159, v159, v96
    v_lshlrev_b32 v96, 16, v76
    v_add_f32 v152, v152, v96
    v_and_b32 v96, 4294901760, v76
    v_add_f32 v153, v153, v96
    v_lshlrev_b32 v96, 16, v77
    v_add_f32 v154, v154, v96
    v_and_b32 v96, 4294901760, v77
    v_add_f32 v155, v155, v96
    v_lshlrev_b32 v96, 16, v78
    v_add_f32 v156, v156, v96
    v_and_b32 v96, 4294901760, v78
    v_add_f32 v157, v157, v96
    v_lshlrev_b32 v96, 16, v79
    v_add_f32 v158, v158, v96
    v_and_b32 v96, 4294901760, v79
    v_add_f32 v159, v159, v96
    v_cvt_pk_bf16_f32 v112, v152, v153
    v_cvt_pk_bf16_f32 v113, v154, v155
    v_cvt_pk_bf16_f32 v114, v156, v157
    v_cvt_pk_bf16_f32 v115, v158, v159
    s_nop 0
    v_permlane32_swap_b32 v112, v114
    v_permlane32_swap_b32 v113, v115
    s_nop 0
    v_permlane16_swap_b32 v112, v114
    v_permlane16_swap_b32 v113, v115
    s_add_u32 s23, s3, 12
    s_mul_hi_u32 s24, s23, 858993460
    s_mul_i32 s27, s24, 5
    s_sub_u32 s27, s23, s27
    s_lshl_b32 s27, s27, 6
    s_mul_i32 s24, s24, 40960
    s_add_u32 s27, s27, s24
    s_cmp_ge_u32 s23, 15
    s_cselect_b32 s27, 2130706432, s27
    buffer_store_dwordx4 v[112:115], v2, s[44:47], s27 offen
    s_waitcnt vmcnt(0)
K1_end:
    s_endpgm
K1_slow:
    s_waitcnt vmcnt(0) lgkmcnt(0)
    s_barrier
    v_mov_b32 v14, v250
    v_xor_b32 v15, 64, v250
    v_xor_b32 v16, 0, v252
    v_xor_b32 v17, 32, v252
    v_xor_b32 v18, 64, v252
    v_xor_b32 v19, 96, v252
    v_add_u32 v16, 73728, v16
    v_add_u32 v17, 73728, v17
    v_add_u32 v18, 73728, v18
    v_add_u32 v19, 73728, v19
    v_mov_b32 v21, 4286578688
    v_mov_b32 v22, 4286578688
    v_mov_b32 v23, 4286578688
    s_mov_b32 s34, 0
    s_mov_b32 s53, 8
K1_sl1:
    s_barrier
    s_mul_i32 s51, s3, 6144
    s_add_u32 m0, s51, 0
    s_nop 0
    buffer_load_dwordx4 v8, s[16:19], s34 offen lds
    buffer_load_dwordx4 v9, s[16:19], s34 offen offset:1024 lds
    buffer_load_dwordx4 v10, s[16:19], s34 offen offset:2048 lds
    s_add_u32 s49, s34, 3072
    s_add_u32 m0, s51, 3072
    s_nop 0
    buffer_load_dwordx4 v8, s[16:19], s49 offen lds
    buffer_load_dwordx4 v9, s[16:19], s49 offen offset:1024 lds
    buffer_load_dwordx4 v10, s[16:19], s49 offen offset:2048 lds
    s_waitcnt vmcnt(0)
    s_barrier
    ds_read_b128 a[160:163], v14 offset:0
    ds_read_b128 a[164:167], v15 offset:0
    ds_read_b128 a[168:171], v14 offset:128
    ds_read_b128 a[172:175], v15 offset:128
    ds_read_b128 a[176:179], v14 offset:256
    ds_read_b128 a[180:183], v15 offset:256
    s_waitcnt lgkmcnt(0)
    v_mfma_f32_16x16x32_bf16 v[100:103], a[160:163], v[28:31], 0
    v_mfma_f32_16x16x32_bf16 v[100:103], a[164:167], v[32:35], v[100:103]
    v_mfma_f32_16x16x32_bf16 v[100:103], a[168:171], v[36:39], v[100:103]
    v_mfma_f32_16x16x32_bf16 v[100:103], a[172:175], v[40:43], v[100:103]
    v_mfma_f32_16x16x32_bf16 v[100:103], a[176:179], v[44:47], v[100:103]
    v_mfma_f32_16x16x32_bf16 v[100:103], a[180:183], v[48:51], v[100:103]
    v_mfma_f32_16x16x32_bf16 v[104:107], a[160:163], v[52:55], 0
    v_mfma_f32_16x16x32_bf16 v[104:107], a[164:167], v[56:59], v[104:107]
    v_mfma_f32_16x16x32_bf16 v[104:107], a[168:171], v[60:63], v[104:107]
    v_mfma_f32_16x16x32_bf16 v[104:107], a[172:175], v[64:67], v[104:107]
    v_mfma_f32_16x16x32_bf16 v[104:107], a[176:179], v[68:71], v[104:107]
    v_mfma_f32_16x16x32_bf16 v[104:107], a[180:183], v[72:75], v[104:107]
    v_mfma_f32_16x16x32_bf16 v[108:111], a[160:163], v[76:79], 0
    v_mfma_f32_16x16x32_bf16 v[108:111], a[164:167], v[80:83], v[108:111]
    v_mfma_f32_16x16x32_bf16 v[108:111], a[168:171], v[84:87], v[108:111]
    v_mfma_f32_16x16x32_bf16 v[108:111], a[172:175], v[88:91], v[108:111]
    v_mfma_f32_16x16x32_bf16 v[108:111], a[176:179], v[92:95], v[108:111]
    v_mfma_f32_16x16x32_bf16 v[108:111], a[180:183], v[96:99], v[108:111]
    ds_read_b128 a[160:163], v14 offset:6144
    ds_read_b128 a[164:167], v15 offset:6144
    ds_read_b128 a[168:171], v14 offset:6272
    ds_read_b128 a[172:175], v15 offset:6272
    ds_read_b128 a[176:179], v14 offset:6400
    ds_read_b128 a[180:183], v15 offset:6400
    s_waitcnt lgkmcnt(0)
    v_mfma_f32_16x16x32_bf16 v[112:115], a[160:163], v[28:31], 0
    v_mfma_f32_16x16x32_bf16 v[112:115], a[164:167], v[32:35], v[112:115]
    v_mfma_f32_16x16x32_bf16 v[112:115], a[168:171], v[36:39], v[112:115]
    v_mfma_f32_16x16x32_bf16 v[112:115], a[172:175], v[40:43], v[112:115]
    v_mfma_f32_16x16x32_bf16 v[112:115], a[176:179], v[44:47], v[112:115]
    v_mfma_f32_16x16x32_bf16 v[112:115], a[180:183], v[48:51], v[112:115]
    v_mfma_f32_16x16x32_bf16 v[116:119], a[160:163], v[52:55], 0
    v_mfma_f32_16x16x32_bf16 v[116:119], a[164:167], v[56:59], v[116:119]
    v_mfma_f32_16x16x32_bf16 v[116:119], a[168:171], v[60:63], v[116:119]
    v_mfma_f32_16x16x32_bf16 v[116:119], a[172:175], v[64:67], v[116:119]
    v_mfma_f32_16x16x32_bf16 v[116:119], a[176:179], v[68:71], v[116:119]
    v_mfma_f32_16x16x32_bf16 v[116:119], a[180:183], v[72:75], v[116:119]
    v_mfma_f32_16x16x32_bf16 v[120:123], a[160:163], v[76:79], 0
    v_mfma_f32_16x16x32_bf16 v[120:123], a[164:167], v[80:83], v[120:123]
    v_mfma_f32_16x16x32_bf16 v[120:123], a[168:171], v[84:87], v[120:123]
    v_mfma_f32_16x16x32_bf16 v[120:123], a[172:175], v[88:91], v[120:123]
    v_mfma_f32_16x16x32_bf16 v[120:123], a[176:179], v[92:95], v[120:123]
    v_mfma_f32_16x16x32_bf16 v[120:123], a[180:183], v[96:99], v[120:123]
    ds_read_b128 a[160:163], v14 offset:12288
    ds_read_b128 a[164:167], v15 offset:12288
    ds_read_b128 a[168:171], v14 offset:12416
    ds_read_b128 a[172:175], v15 offset:12416
    ds_read_b128 a[176:179], v14 offset:12544
    ds_read_b128 a[180:183], v15 offset:12544
    s_waitcnt lgkmcnt(0)
    v_mfma_f32_16x16x32_bf16 v[124:127], a[160:163], v[28:31], 0
    v_mfma_f32_16x16x32_bf16 v[124:127], a[164:167], v[32:35], v[124:127]
    v_mfma_f32_16x16x32_bf16 v[124:127], a[168:171], v[36:39], v[124:127]
    v_mfma_f32_16x16x32_bf16 v[124:127], a[172:175], v[40:43], v[124:127]
    v_mfma_f32_16x16x32_bf16 v[124:127], a[176:179], v[44:47], v[124:127]
    v_mfma_f32_16x16x32_bf16 v[124:127], a[180:183], v[48:51], v[124:127]
    v_mfma_f32_16x16x32_bf16 v[128:131], a[160:163], v[52:55], 0
    v_mfma_f32_16x16x32_bf16 v[128:131], a[164:167], v[56:59], v[128:131]
    v_mfma_f32_16x16x32_bf16 v[128:131], a[168:171], v[60:63], v[128:131]
    v_mfma_f32_16x16x32_bf16 v[128:131], a[172:175], v[64:67], v[128:131]
    v_mfma_f32_16x16x32_bf16 v[128:131], a[176:179], v[68:71], v[128:131]
    v_mfma_f32_16x16x32_bf16 v[128:131], a[180:183], v[72:75], v[128:131]
    v_mfma_f32_16x16x32_bf16 v[132:135], a[160:163], v[76:79], 0
    v_mfma_f32_16x16x32_bf16 v[132:135], a[164:167], v[80:83], v[132:135]
    v_mfma_f32_16x16x32_bf16 v[132:135], a[168:171], v[84:87], v[132:135]
    v_mfma_f32_16x16x32_bf16 v[132:135], a[172:175], v[88:91], v[132:135]
    v_mfma_f32_16x16x32_bf16 v[132:135], a[176:179], v[92:95], v[132:135]
    v_mfma_f32_16x16x32_bf16 v[132:135], a[180:183], v[96:99], v[132:135]
    ds_read_b128 a[160:163], v14 offset:18432
    ds_read_b128 a[164:167], v15 offset:18432
    ds_read_b128 a[168:171], v14 offset:18560
    ds_read_b128 a[172:175], v15 offset:18560
    ds_read_b128 a[176:179], v14 offset:18688
    ds_read_b128 a[180:183], v15 offset:18688
    s_waitcnt lgkmcnt(0)
    v_mfma_f32_16x16x32_bf16 v[136:139], a[160:163], v[28:31], 0
    v_mfma_f32_16x16x32_bf16 v[136:139], a[164:167], v[32:35], v[136:139]
    v_mfma_f32_16x16x32_bf16 v[136:139], a[168:171], v[36:39], v[136:139]
    v_mfma_f32_16x16x32_bf16 v[136:139], a[172:175], v[40:43], v[136:139]
    v_mfma_f32_16x16x32_bf16 v[136:139], a[176:179], v[44:47], v[136:139]
    v_mfma_f32_16x16x32_bf16 v[136:139], a[180:183], v[48:51], v[136:139]
    v_mfma_f32_16x16x32_bf16 v[140:143], a[160:163], v[52:55], 0
    v_mfma_f32_16x16x32_bf16 v[140:143], a[164:167], v[56:59], v[140:143]
    v_mfma_f32_16x16x32_bf16 v[140:143], a[168:171], v[60:63], v[140:143]
    v_mfma_f32_16x16x32_bf16 v[140:143], a[172:175], v[64:67], v[140:143]
    v_mfma_f32_16x16x32_bf16 v[140:143], a[176:179], v[68:71], v[140:143]
    v_mfma_f32_16x16x32_bf16 v[140:143], a[180:183], v[72:75], v[140:143]
    v_mfma_f32_16x16x32_bf16 v[144:147], a[160:163], v[76:79], 0
    v_mfma_f32_16x16x32_bf16 v[144:147], a[164:167], v[80:83], v[144:147]
    v_mfma_f32_16x16x32_bf16 v[144:147], a[168:171], v[84:87], v[144:147]
    v_mfma_f32_16x16x32_bf16 v[144:147], a[172:175], v[88:91], v[144:147]
    v_mfma_f32_16x16x32_bf16 v[144:147], a[176:179], v[92:95], v[144:147]
    v_mfma_f32_16x16x32_bf16 v[144:147], a[180:183], v[96:99], v[144:147]
    s_nop 7
    v_max3_f32 v21, v100, v101, v21
    v_max3_f32 v21, v102, v103, v21
    v_max3_f32 v22, v104, v105, v22
    v_max3_f32 v22, v106, v107, v22
    v_max3_f32 v23, v108, v109, v23
    v_max3_f32 v23, v110, v111, v23
    v_max3_f32 v21, v112, v113, v21
    v_max3_f32 v21, v114, v115, v21
    v_max3_f32 v22, v116, v117, v22
    v_max3_f32 v22, v118, v119, v22
    v_max3_f32 v23, v120, v121, v23
    v_max3_f32 v23, v122, v123, v23
    v_max3_f32 v21, v124, v125, v21
    v_max3_f32 v21, v126, v127, v21
    v_max3_f32 v22, v128, v129, v22
    v_max3_f32 v22, v130, v131, v22
    v_max3_f32 v23, v132, v133, v23
    v_max3_f32 v23, v134, v135, v23
    v_max3_f32 v21, v136, v137, v21
    v_max3_f32 v21, v138, v139, v21
    v_max3_f32 v22, v140, v141, v22
    v_max3_f32 v22, v142, v143, v22
    v_max3_f32 v23, v144, v145, v23
    v_max3_f32 v23, v146, v147, v23
    s_add_u32 s34, s34, 24576
    s_sub_u32 s53, s53, 1
    s_cmp_lg_u32 s53, 0
    s_cbranch_scc1 K1_sl1
    v_mov_b32 v24, v21
    s_nop 1
    v_permlane32_swap_b32 v21, v24
    s_nop 1
    v_max_f32 v21, v21, v24
    v_mov_b32 v24, v21
    s_nop 1
    v_permlane16_swap_b32 v21, v24
    s_nop 1
    v_max_f32 v21, v21, v24
    v_sub_f32 v148, 0, v21
    v_sub_f32 v149, 0, v21
    v_sub_f32 v150, 0, v21
    v_sub_f32 v151, 0, v21
    v_mov_b32 v24, v22
    s_nop 1
    v_permlane32_swap_b32 v22, v24
    s_nop 1
    v_max_f32 v22, v22, v24
    v_mov_b32 v24, v22
    s_nop 1
    v_permlane16_swap_b32 v22, v24
    s_nop 1
    v_max_f32 v22, v22, v24
    v_sub_f32 v152, 0, v22
    v_sub_f32 v153, 0, v22
    v_sub_f32 v154, 0, v22
    v_sub_f32 v155, 0, v22
    v_mov_b32 v24, v23
    s_nop 1
    v_permlane32_swap_b32 v23, v24
    s_nop 1
    v_max_f32 v23, v23, v24
    v_mov_b32 v24, v23
    s_nop 1
    v_permlane16_swap_b32 v23, v24
    s_nop 1
    v_max_f32 v23, v23, v24
    v_sub_f32 v156, 0, v23
    v_sub_f32 v157, 0, v23
    v_sub_f32 v158, 0, v23
    v_sub_f32 v159, 0, v23
    v_accvgpr_write_b32 a0, 0
    v_accvgpr_write_b32 a1, 0
    v_accvgpr_write_b32 a2, 0
    v_accvgpr_write_b32 a3, 0
    v_accvgpr_write_b32 a4, 0
    v_accvgpr_write_b32 a5, 0
    v_accvgpr_write_b32 a6, 0
    v_accvgpr_write_b32 a7, 0
    v_accvgpr_write_b32 a8, 0
    v_accvgpr_write_b32 a9, 0
    v_accvgpr_write_b32 a10, 0
    v_accvgpr_write_b32 a11, 0
    v_accvgpr_write_b32 a12, 0
    v_accvgpr_write_b32 a13, 0
    v_accvgpr_write_b32 a14, 0
    v_accvgpr_write_b32 a15, 0
    v_accvgpr_write_b32 a16, 0
    v_accvgpr_write_b32 a17, 0
    v_accvgpr_write_b32 a18, 0
    v_accvgpr_write_b32 a19, 0
    v_accvgpr_write_b32 a20, 0
    v_accvgpr_write_b32 a21, 0
    v_accvgpr_write_b32 a22, 0
    v_accvgpr_write_b32 a23, 0
    v_accvgpr_write_b32 a24, 0
    v_accvgpr_write_b32 a25, 0
    v_accvgpr_write_b32 a26, 0
    v_accvgpr_write_b32 a27, 0
    v_accvgpr_write_b32 a28, 0
    v_accvgpr_write_b32 a29, 0
    v_accvgpr_write_b32 a30, 0
    v_accvgpr_write_b32 a31, 0
    v_accvgpr_write_b32 a32, 0
    v_accvgpr_write_b32 a33, 0
    v_accvgpr_write_b32 a34, 0
    v_accvgpr_write_b32 a35, 0
    v_accvgpr_write_b32 a36, 0
    v_accvgpr_write_b32 a37, 0
    v_accvgpr_write_b32 a38, 0
    v_accvgpr_write_b32 a39, 0
    v_accvgpr_write_b32 a40, 0
    v_accvgpr_write_b32 a41, 0
    v_accvgpr_write_b32 a42, 0
    v_accvgpr_write_b32 a43, 0
    v_accvgpr_write_b32 a44, 0
    v_accvgpr_write_b32 a45, 0
    v_accvgpr_write_b32 a46, 0
    v_accvgpr_write_b32 a47, 0
    v_accvgpr_write_b32 a48, 0
    v_accvgpr_write_b32 a49, 0
    v_accvgpr_write_b32 a50, 0
    v_accvgpr_write_b32 a51, 0
    v_accvgpr_write_b32 a52, 0
    v_accvgpr_write_b32 a53, 0
    v_accvgpr_write_b32 a54, 0
    v_accvgpr_write_b32 a55, 0
    v_accvgpr_write_b32 a56, 0
    v_accvgpr_write_b32 a57, 0
    v_accvgpr_write_b32 a58, 0
    v_accvgpr_write_b32 a59, 0
    v_accvgpr_write_b32 a60, 0
    v_accvgpr_write_b32 a61, 0
    v_accvgpr_write_b32 a62, 0
    v_accvgpr_write_b32 a63, 0
    v_accvgpr_write_b32 a64, 0
    v_accvgpr_write_b32 a65, 0
    v_accvgpr_write_b32 a66, 0
    v_accvgpr_write_b32 a67, 0
    v_accvgpr_write_b32 a68, 0
    v_accvgpr_write_b32 a69, 0
    v_accvgpr_write_b32 a70, 0
    v_accvgpr_write_b32 a71, 0
    v_accvgpr_write_b32 a72, 0
    v_accvgpr_write_b32 a73, 0
    v_accvgpr_write_b32 a74, 0
    v_accvgpr_write_b32 a75, 0
    v_accvgpr_write_b32 a76, 0
    v_accvgpr_write_b32 a77, 0
    v_accvgpr_write_b32 a78, 0
    v_accvgpr_write_b32 a79, 0
    v_accvgpr_write_b32 a80, 0
    v_accvgpr_write_b32 a81, 0
    v_accvgpr_write_b32 a82, 0
    v_accvgpr_write_b32 a83, 0
    v_accvgpr_write_b32 a84, 0
    v_accvgpr_write_b32 a85, 0
    v_accvgpr_write_b32 a86, 0
    v_accvgpr_write_b32 a87, 0
    v_accvgpr_write_b32 a88, 0
    v_accvgpr_write_b32 a89, 0
    v_accvgpr_write_b32 a90, 0
    v_accvgpr_write_b32 a91, 0
    v_accvgpr_write_b32 a92, 0
    v_accvgpr_write_b32 a93, 0
    v_accvgpr_write_b32 a94, 0
    v_accvgpr_write_b32 a95, 0
    v_accvgpr_write_b32 a96, 0
    v_accvgpr_write_b32 a97, 0
    v_accvgpr_write_b32 a98, 0
    v_accvgpr_write_b32 a99, 0
    v_accvgpr_write_b32 a100, 0
    v_accvgpr_write_b32 a101, 0
    v_accvgpr_write_b32 a102, 0
    v_accvgpr_write_b32 a103, 0
    v_accvgpr_write_b32 a104, 0
    v_accvgpr_write_b32 a105, 0
    v_accvgpr_write_b32 a106, 0
    v_accvgpr_write_b32 a107, 0
    v_accvgpr_write_b32 a108, 0
    v_accvgpr_write_b32 a109, 0
    v_accvgpr_write_b32 a110, 0
    v_accvgpr_write_b32 a111, 0
    v_accvgpr_write_b32 a112, 0
    v_accvgpr_write_b32 a113, 0
    v_accvgpr_write_b32 a114, 0
    v_accvgpr_write_b32 a115, 0
    v_accvgpr_write_b32 a116, 0
    v_accvgpr_write_b32 a117, 0
    v_accvgpr_write_b32 a118, 0
    v_accvgpr_write_b32 a119, 0
    v_accvgpr_write_b32 a120, 0
    v_accvgpr_write_b32 a121, 0
    v_accvgpr_write_b32 a122, 0
    v_accvgpr_write_b32 a123, 0
    v_accvgpr_write_b32 a124, 0
    v_accvgpr_write_b32 a125, 0
    v_accvgpr_write_b32 a126, 0
    v_accvgpr_write_b32 a127, 0
    v_accvgpr_write_b32 a128, 0
    v_accvgpr_write_b32 a129, 0
    v_accvgpr_write_b32 a130, 0
    v_accvgpr_write_b32 a131, 0
    v_accvgpr_write_b32 a132, 0
    v_accvgpr_write_b32 a133, 0
    v_accvgpr_write_b32 a134, 0
    v_accvgpr_write_b32 a135, 0
    v_accvgpr_write_b32 a136, 0
    v_accvgpr_write_b32 a137, 0
    v_accvgpr_write_b32 a138, 0
    v_accvgpr_write_b32 a139, 0
    v_accvgpr_write_b32 a140, 0
    v_accvgpr_write_b32 a141, 0
    v_accvgpr_write_b32 a142, 0
    v_accvgpr_write_b32 a143, 0
    v_accvgpr_write_b32 a144, 0
    v_accvgpr_write_b32 a145, 0
    v_accvgpr_write_b32 a146, 0
    v_accvgpr_write_b32 a147, 0
    v_accvgpr_write_b32 a148, 0
    v_accvgpr_write_b32 a149, 0
    v_accvgpr_write_b32 a150, 0
    v_accvgpr_write_b32 a151, 0
    v_accvgpr_write_b32 a152, 0
    v_accvgpr_write_b32 a153, 0
    v_accvgpr_write_b32 a154, 0
    v_accvgpr_write_b32 a155, 0
    s_mov_b32 s34, 0
    s_mov_b32 s53, 8
K1_sl2:
    s_barrier
    s_mul_i32 s51, s3, 6144
    s_add_u32 m0, s51, 0
    s_nop 0
    buffer_load_dwordx4 v8, s[16:19], s34 offen lds
    buffer_load_dwordx4 v9, s[16:19], s34 offen offset:1024 lds
    buffer_load_dwordx4 v10, s[16:19], s34 offen offset:2048 lds
    s_add_u32 s49, s34, 3072
    s_add_u32 m0, s51, 3072
    s_nop 0
    buffer_load_dwordx4 v8, s[16:19], s49 offen lds
    buffer_load_dwordx4 v9, s[16:19], s49 offen offset:1024 lds
    buffer_load_dwordx4 v10, s[16:19], s49 offen offset:2048 lds
    s_mul_i32 s51, s3, 6144
    s_add_u32 m0, s51, 73728
    s_nop 0
    buffer_load_dwordx4 v8, s[20:23], s34 offen lds
    buffer_load_dwordx4 v9, s[20:23], s34 offen offset:1024 lds
    buffer_load_dwordx4 v10, s[20:23], s34 offen offset:2048 lds
    s_add_u32 s49, s34, 3072
    s_add_u32 m0, s51, 76800
    s_nop 0
    buffer_load_dwordx4 v8, s[20:23], s49 offen lds
    buffer_load_dwordx4 v9, s[20:23], s49 offen offset:1024 lds
    buffer_load_dwordx4 v10, s[20:23], s49 offen offset:2048 lds
    s_waitcnt vmcnt(0)
    s_barrier
    ds_read_b128 a[160:163], v14 offset:0
    ds_read_b128 a[164:167], v15 offset:0
    ds_read_b128 a[168:171], v14 offset:128
    ds_read_b128 a[172:175], v15 offset:128
    ds_read_b128 a[176:179], v14 offset:256
    ds_read_b128 a[180:183], v15 offset:256
    s_waitcnt lgkmcnt(0)
    v_mfma_f32_16x16x32_bf16 v[100:103], a[160:163], v[28:31], v[148:151]
    v_mfma_f32_16x16x32_bf16 v[100:103], a[164:167], v[32:35], v[100:103]
    v_mfma_f32_16x16x32_bf16 v[100:103], a[168:171], v[36:39], v[100:103]
    v_mfma_f32_16x16x32_bf16 v[100:103], a[172:175], v[40:43], v[100:103]
    v_mfma_f32_16x16x32_bf16 v[100:103], a[176:179], v[44:47], v[100:103]
    v_mfma_f32_16x16x32_bf16 v[100:103], a[180:183], v[48:51], v[100:103]
    v_mfma_f32_16x16x32_bf16 v[104:107], a[160:163], v[52:55], v[152:155]
    v_mfma_f32_16x16x32_bf16 v[104:107], a[164:167], v[56:59], v[104:107]
    v_mfma_f32_16x16x32_bf16 v[104:107], a[168:171], v[60:63], v[104:107]
    v_mfma_f32_16x16x32_bf16 v[104:107], a[172:175], v[64:67], v[104:107]
    v_mfma_f32_16x16x32_bf16 v[104:107], a[176:179], v[68:71], v[104:107]
    v_mfma_f32_16x16x32_bf16 v[104:107], a[180:183], v[72:75], v[104:107]
    v_mfma_f32_16x16x32_bf16 v[108:111], a[160:163], v[76:79], v[156:159]
    v_mfma_f32_16x16x32_bf16 v[108:111], a[164:167], v[80:83], v[108:111]
    v_mfma_f32_16x16x32_bf16 v[108:111], a[168:171], v[84:87], v[108:111]
    v_mfma_f32_16x16x32_bf16 v[108:111], a[172:175], v[88:91], v[108:111]
    v_mfma_f32_16x16x32_bf16 v[108:111], a[176:179], v[92:95], v[108:111]
    v_mfma_f32_16x16x32_bf16 v[108:111], a[180:183], v[96:99], v[108:111]
    ds_read_b128 a[160:163], v14 offset:6144
    ds_read_b128 a[164:167], v15 offset:6144
    ds_read_b128 a[168:171], v14 offset:6272
    ds_read_b128 a[172:175], v15 offset:6272
    ds_read_b128 a[176:179], v14 offset:6400
    ds_read_b128 a[180:183], v15 offset:6400
    s_waitcnt lgkmcnt(0)
    v_mfma_f32_16x16x32_bf16 v[112:115], a[160:163], v[28:31], v[148:151]
    v_mfma_f32_16x16x32_bf16 v[112:115], a[164:167], v[32:35], v[112:115]
    v_mfma_f32_16x16x32_bf16 v[112:115], a[168:171], v[36:39], v[112:115]
    v_mfma_f32_16x16x32_bf16 v[112:115], a[172:175], v[40:43], v[112:115]
    v_mfma_f32_16x16x32_bf16 v[112:115], a[176:179], v[44:47], v[112:115]
    v_mfma_f32_16x16x32_bf16 v[112:115], a[180:183], v[48:51], v[112:115]
    v_mfma_f32_16x16x32_bf16 v[116:119], a[160:163], v[52:55], v[152:155]
    v_mfma_f32_16x16x32_bf16 v[116:119], a[164:167], v[56:59], v[116:119]
    v_mfma_f32_16x16x32_bf16 v[116:119], a[168:171], v[60:63], v[116:119]
    v_mfma_f32_16x16x32_bf16 v[116:119], a[172:175], v[64:67], v[116:119]
    v_mfma_f32_16x16x32_bf16 v[116:119], a[176:179], v[68:71], v[116:119]
    v_mfma_f32_16x16x32_bf16 v[116:119], a[180:183], v[72:75], v[116:119]
    v_mfma_f32_16x16x32_bf16 v[120:123], a[160:163], v[76:79], v[156:159]
    v_mfma_f32_16x16x32_bf16 v[120:123], a[164:167], v[80:83], v[120:123]
    v_mfma_f32_16x16x32_bf16 v[120:123], a[168:171], v[84:87], v[120:123]
    v_mfma_f32_16x16x32_bf16 v[120:123], a[172:175], v[88:91], v[120:123]
    v_mfma_f32_16x16x32_bf16 v[120:123], a[176:179], v[92:95], v[120:123]
    v_mfma_f32_16x16x32_bf16 v[120:123], a[180:183], v[96:99], v[120:123]
    ds_read_b128 a[160:163], v14 offset:12288
    ds_read_b128 a[164:167], v15 offset:12288
    ds_read_b128 a[168:171], v14 offset:12416
    ds_read_b128 a[172:175], v15 offset:12416
    ds_read_b128 a[176:179], v14 offset:12544
    ds_read_b128 a[180:183], v15 offset:12544
    s_waitcnt lgkmcnt(0)
    v_mfma_f32_16x16x32_bf16 v[124:127], a[160:163], v[28:31], v[148:151]
    v_mfma_f32_16x16x32_bf16 v[124:127], a[164:167], v[32:35], v[124:127]
    v_mfma_f32_16x16x32_bf16 v[124:127], a[168:171], v[36:39], v[124:127]
    v_mfma_f32_16x16x32_bf16 v[124:127], a[172:175], v[40:43], v[124:127]
    v_mfma_f32_16x16x32_bf16 v[124:127], a[176:179], v[44:47], v[124:127]
    v_mfma_f32_16x16x32_bf16 v[124:127], a[180:183], v[48:51], v[124:127]
    v_mfma_f32_16x16x32_bf16 v[128:131], a[160:163], v[52:55], v[152:155]
    v_mfma_f32_16x16x32_bf16 v[128:131], a[164:167], v[56:59], v[128:131]
    v_mfma_f32_16x16x32_bf16 v[128:131], a[168:171], v[60:63], v[128:131]
    v_mfma_f32_16x16x32_bf16 v[128:131], a[172:175], v[64:67], v[128:131]
    v_mfma_f32_16x16x32_bf16 v[128:131], a[176:179], v[68:71], v[128:131]
    v_mfma_f32_16x16x32_bf16 v[128:131], a[180:183], v[72:75], v[128:131]
    v_mfma_f32_16x16x32_bf16 v[132:135], a[160:163], v[76:79], v[156:159]
    v_mfma_f32_16x16x32_bf16 v[132:135], a[164:167], v[80:83], v[132:135]
    v_mfma_f32_16x16x32_bf16 v[132:135], a[168:171], v[84:87], v[132:135]
    v_mfma_f32_16x16x32_bf16 v[132:135], a[172:175], v[88:91], v[132:135]
    v_mfma_f32_16x16x32_bf16 v[132:135], a[176:179], v[92:95], v[132:135]
    v_mfma_f32_16x16x32_bf16 v[132:135], a[180:183], v[96:99], v[132:135]
    ds_read_b128 a[160:163], v14 offset:18432
    ds_read_b128 a[164:167], v15 offset:18432
    ds_read_b128 a[168:171], v14 offset:18560
    ds_read_b128 a[172:175], v15 offset:18560
    ds_read_b128 a[176:179], v14 offset:18688
    ds_read_b128 a[180:183], v15 offset:18688
    s_waitcnt lgkmcnt(0)
    v_mfma_f32_16x16x32_bf16 v[136:139], a[160:163], v[28:31], v[148:151]
    v_mfma_f32_16x16x32_bf16 v[136:139], a[164:167], v[32:35], v[136:139]
    v_mfma_f32_16x16x32_bf16 v[136:139], a[168:171], v[36:39], v[136:139]
    v_mfma_f32_16x16x32_bf16 v[136:139], a[172:175], v[40:43], v[136:139]
    v_mfma_f32_16x16x32_bf16 v[136:139], a[176:179], v[44:47], v[136:139]
    v_mfma_f32_16x16x32_bf16 v[136:139], a[180:183], v[48:51], v[136:139]
    v_mfma_f32_16x16x32_bf16 v[140:143], a[160:163], v[52:55], v[152:155]
    v_mfma_f32_16x16x32_bf16 v[140:143], a[164:167], v[56:59], v[140:143]
    v_mfma_f32_16x16x32_bf16 v[140:143], a[168:171], v[60:63], v[140:143]
    v_mfma_f32_16x16x32_bf16 v[140:143], a[172:175], v[64:67], v[140:143]
    v_mfma_f32_16x16x32_bf16 v[140:143], a[176:179], v[68:71], v[140:143]
    v_mfma_f32_16x16x32_bf16 v[140:143], a[180:183], v[72:75], v[140:143]
    v_mfma_f32_16x16x32_bf16 v[144:147], a[160:163], v[76:79], v[156:159]
    v_mfma_f32_16x16x32_bf16 v[144:147], a[164:167], v[80:83], v[144:147]
    v_mfma_f32_16x16x32_bf16 v[144:147], a[168:171], v[84:87], v[144:147]
    v_mfma_f32_16x16x32_bf16 v[144:147], a[172:175], v[88:91], v[144:147]
    v_mfma_f32_16x16x32_bf16 v[144:147], a[176:179], v[92:95], v[144:147]
    v_mfma_f32_16x16x32_bf16 v[144:147], a[180:183], v[96:99], v[144:147]
    s_nop 7
    v_exp_f32 v100, v100
    v_exp_f32 v101, v101
    v_exp_f32 v102, v102
    v_exp_f32 v103, v103
    s_nop 0
    v_cvt_pk_bf16_f32 v196, v100, v101
    v_cvt_pk_bf16_f32 v197, v102, v103
    v_exp_f32 v104, v104
    v_exp_f32 v105, v105
    v_exp_f32 v106, v106
    v_exp_f32 v107, v107
    s_nop 0
    v_cvt_pk_bf16_f32 v200, v104, v105
    v_cvt_pk_bf16_f32 v201, v106, v107
    v_exp_f32 v108, v108
    v_exp_f32 v109, v109
    v_exp_f32 v110, v110
    v_exp_f32 v111, v111
    s_nop 0
    v_cvt_pk_bf16_f32 v204, v108, v109
    v_cvt_pk_bf16_f32 v205, v110, v111
    v_exp_f32 v112, v112
    v_exp_f32 v113, v113
    v_exp_f32 v114, v114
    v_exp_f32 v115, v115
    s_nop 0
    v_cvt_pk_bf16_f32 v198, v112, v113
    v_cvt_pk_bf16_f32 v199, v114, v115
    v_exp_f32 v116, v116
    v_exp_f32 v117, v117
    v_exp_f32 v118, v118
    v_exp_f32 v119, v119
    s_nop 0
    v_cvt_pk_bf16_f32 v202, v116, v117
    v_cvt_pk_bf16_f32 v203, v118, v119
    v_exp_f32 v120, v120
    v_exp_f32 v121, v121
    v_exp_f32 v122, v122
    v_exp_f32 v123, v123
    s_nop 0
    v_cvt_pk_bf16_f32 v206, v120, v121
    v_cvt_pk_bf16_f32 v207, v122, v123
    v_exp_f32 v124, v124
    v_exp_f32 v125, v125
    v_exp_f32 v126, v126
    v_exp_f32 v127, v127
    s_nop 0
    v_cvt_pk_bf16_f32 v208, v124, v125
    v_cvt_pk_bf16_f32 v209, v126, v127
    v_exp_f32 v128, v128
    v_exp_f32 v129, v129
    v_exp_f32 v130, v130
    v_exp_f32 v131, v131
    s_nop 0
    v_cvt_pk_bf16_f32 v212, v128, v129
    v_cvt_pk_bf16_f32 v213, v130, v131
    v_exp_f32 v132, v132
    v_exp_f32 v133, v133
    v_exp_f32 v134, v134
    v_exp_f32 v135, v135
    s_nop 0
    v_cvt_pk_bf16_f32 v216, v132, v133
    v_cvt_pk_bf16_f32 v217, v134, v135
    v_exp_f32 v136, v136
    v_exp_f32 v137, v137
    v_exp_f32 v138, v138
    v_exp_f32 v139, v139
    s_nop 0
    v_cvt_pk_bf16_f32 v210, v136, v137
    v_cvt_pk_bf16_f32 v211, v138, v139
    v_exp_f32 v140, v140
    v_exp_f32 v141, v141
    v_exp_f32 v142, v142
    v_exp_f32 v143, v143
    s_nop 0
    v_cvt_pk_bf16_f32 v214, v140, v141
    v_cvt_pk_bf16_f32 v215, v142, v143
    v_exp_f32 v144, v144
    v_exp_f32 v145, v145
    v_exp_f32 v146, v146
    v_exp_f32 v147, v147
    s_nop 0
    v_cvt_pk_bf16_f32 v218, v144, v145
    v_cvt_pk_bf16_f32 v219, v146, v147
    s_nop 1
    v_mfma_f32_16x16x32_bf16 a[144:147], a[156:159], v[196:199], a[144:147]
    v_mfma_f32_16x16x32_bf16 a[144:147], a[156:159], v[208:211], a[144:147]
    v_mfma_f32_16x16x32_bf16 a[148:151], a[156:159], v[200:203], a[148:151]
    v_mfma_f32_16x16x32_bf16 a[148:151], a[156:159], v[212:215], a[148:151]
    v_mfma_f32_16x16x32_bf16 a[152:155], a[156:159], v[204:207], a[152:155]
    v_mfma_f32_16x16x32_bf16 a[152:155], a[156:159], v[216:219], a[152:155]
    ds_read_b64_tr_b16 a[208:209], v16 offset:0
    ds_read_b64_tr_b16 a[210:211], v16 offset:6144
    ds_read_b64_tr_b16 a[212:213], v16 offset:12288
    ds_read_b64_tr_b16 a[214:215], v16 offset:18432
    ds_read_b64_tr_b16 a[216:217], v17 offset:0
    ds_read_b64_tr_b16 a[218:219], v17 offset:6144
    ds_read_b64_tr_b16 a[220:221], v17 offset:12288
    ds_read_b64_tr_b16 a[222:223], v17 offset:18432
    s_waitcnt lgkmcnt(0)
    v_mfma_f32_16x16x32_bf16 a[0:3], a[208:211], v[196:199], a[0:3]
    v_mfma_f32_16x16x32_bf16 a[0:3], a[212:215], v[208:211], a[0:3]
    v_mfma_f32_16x16x32_bf16 a[4:7], a[208:211], v[200:203], a[4:7]
    v_mfma_f32_16x16x32_bf16 a[4:7], a[212:215], v[212:215], a[4:7]
    v_mfma_f32_16x16x32_bf16 a[8:11], a[208:211], v[204:207], a[8:11]
    v_mfma_f32_16x16x32_bf16 a[8:11], a[212:215], v[216:219], a[8:11]
    v_mfma_f32_16x16x32_bf16 a[12:15], a[216:219], v[196:199], a[12:15]
    v_mfma_f32_16x16x32_bf16 a[12:15], a[220:223], v[208:211], a[12:15]
    v_mfma_f32_16x16x32_bf16 a[16:19], a[216:219], v[200:203], a[16:19]
    v_mfma_f32_16x16x32_bf16 a[16:19], a[220:223], v[212:215], a[16:19]
    v_mfma_f32_16x16x32_bf16 a[20:23], a[216:219], v[204:207], a[20:23]
    v_mfma_f32_16x16x32_bf16 a[20:23], a[220:223], v[216:219], a[20:23]
    ds_read_b64_tr_b16 a[208:209], v18 offset:0
    ds_read_b64_tr_b16 a[210:211], v18 offset:6144
    ds_read_b64_tr_b16 a[212:213], v18 offset:12288
    ds_read_b64_tr_b16 a[214:215], v18 offset:18432
    ds_read_b64_tr_b16 a[216:217], v19 offset:0
    ds_read_b64_tr_b16 a[218:219], v19 offset:6144
    ds_read_b64_tr_b16 a[220:221], v19 offset:12288
    ds_read_b64_tr_b16 a[222:223], v19 offset:18432
    s_waitcnt lgkmcnt(0)
    v_mfma_f32_16x16x32_bf16 a[24:27], a[208:211], v[196:199], a[24:27]
    v_mfma_f32_16x16x32_bf16 a[24:27], a[212:215], v[208:211], a[24:27]
    v_mfma_f32_16x16x32_bf16 a[28:31], a[208:211], v[200:203], a[28:31]
    v_mfma_f32_16x16x32_bf16 a[28:31], a[212:215], v[212:215], a[28:31]
    v_mfma_f32_16x16x32_bf16 a[32:35], a[208:211], v[204:207], a[32:35]
    v_mfma_f32_16x16x32_bf16 a[32:35], a[212:215], v[216:219], a[32:35]
    v_mfma_f32_16x16x32_bf16 a[36:39], a[216:219], v[196:199], a[36:39]
    v_mfma_f32_16x16x32_bf16 a[36:39], a[220:223], v[208:211], a[36:39]
    v_mfma_f32_16x16x32_bf16 a[40:43], a[216:219], v[200:203], a[40:43]
    v_mfma_f32_16x16x32_bf16 a[40:43], a[220:223], v[212:215], a[40:43]
    v_mfma_f32_16x16x32_bf16 a[44:47], a[216:219], v[204:207], a[44:47]
    v_mfma_f32_16x16x32_bf16 a[44:47], a[220:223], v[216:219], a[44:47]
    ds_read_b64_tr_b16 a[208:209], v16 offset:128
    ds_read_b64_tr_b16 a[210:211], v16 offset:6272
    ds_read_b64_tr_b16 a[212:213], v16 offset:12416
    ds_read_b64_tr_b16 a[214:215], v16 offset:18560
    ds_read_b64_tr_b16 a[216:217], v17 offset:128
    ds_read_b64_tr_b16 a[218:219], v17 offset:6272
    ds_read_b64_tr_b16 a[220:221], v17 offset:12416
    ds_read_b64_tr_b16 a[222:223], v17 offset:18560
    s_waitcnt lgkmcnt(0)
    v_mfma_f32_16x16x32_bf16 a[48:51], a[208:211], v[196:199], a[48:51]
    v_mfma_f32_16x16x32_bf16 a[48:51], a[212:215], v[208:211], a[48:51]
    v_mfma_f32_16x16x32_bf16 a[52:55], a[208:211], v[200:203], a[52:55]
    v_mfma_f32_16x16x32_bf16 a[52:55], a[212:215], v[212:215], a[52:55]
    v_mfma_f32_16x16x32_bf16 a[56:59], a[208:211], v[204:207], a[56:59]
    v_mfma_f32_16x16x32_bf16 a[56:59], a[212:215], v[216:219], a[56:59]
    v_mfma_f32_16x16x32_bf16 a[60:63], a[216:219], v[196:199], a[60:63]
    v_mfma_f32_16x16x32_bf16 a[60:63], a[220:223], v[208:211], a[60:63]
    v_mfma_f32_16x16x32_bf16 a[64:67], a[216:219], v[200:203], a[64:67]
    v_mfma_f32_16x16x32_bf16 a[64:67], a[220:223], v[212:215], a[64:67]
    v_mfma_f32_16x16x32_bf16 a[68:71], a[216:219], v[204:207], a[68:71]
    v_mfma_f32_16x16x32_bf16 a[68:71], a[220:223], v[216:219], a[68:71]
    ds_read_b64_tr_b16 a[208:209], v18 offset:128
    ds_read_b64_tr_b16 a[210:211], v18 offset:6272
    ds_read_b64_tr_b16 a[212:213], v18 offset:12416
    ds_read_b64_tr_b16 a[214:215], v18 offset:18560
    ds_read_b64_tr_b16 a[216:217], v19 offset:128
    ds_read_b64_tr_b16 a[218:219], v19 offset:6272
    ds_read_b64_tr_b16 a[220:221], v19 offset:12416
    ds_read_b64_tr_b16 a[222:223], v19 offset:18560
    s_waitcnt lgkmcnt(0)
    v_mfma_f32_16x16x32_bf16 a[72:75], a[208:211], v[196:199], a[72:75]
    v_mfma_f32_16x16x32_bf16 a[72:75], a[212:215], v[208:211], a[72:75]
    v_mfma_f32_16x16x32_bf16 a[76:79], a[208:211], v[200:203], a[76:79]
    v_mfma_f32_16x16x32_bf16 a[76:79], a[212:215], v[212:215], a[76:79]
    v_mfma_f32_16x16x32_bf16 a[80:83], a[208:211], v[204:207], a[80:83]
    v_mfma_f32_16x16x32_bf16 a[80:83], a[212:215], v[216:219], a[80:83]
    v_mfma_f32_16x16x32_bf16 a[84:87], a[216:219], v[196:199], a[84:87]
    v_mfma_f32_16x16x32_bf16 a[84:87], a[220:223], v[208:211], a[84:87]
    v_mfma_f32_16x16x32_bf16 a[88:91], a[216:219], v[200:203], a[88:91]
    v_mfma_f32_16x16x32_bf16 a[88:91], a[220:223], v[212:215], a[88:91]
    v_mfma_f32_16x16x32_bf16 a[92:95], a[216:219], v[204:207], a[92:95]
    v_mfma_f32_16x16x32_bf16 a[92:95], a[220:223], v[216:219], a[92:95]
    ds_read_b64_tr_b16 a[208:209], v16 offset:256
    ds_read_b64_tr_b16 a[210:211], v16 offset:6400
    ds_read_b64_tr_b16 a[212:213], v16 offset:12544
    ds_read_b64_tr_b16 a[214:215], v16 offset:18688
    ds_read_b64_tr_b16 a[216:217], v17 offset:256
    ds_read_b64_tr_b16 a[218:219], v17 offset:6400
    ds_read_b64_tr_b16 a[220:221], v17 offset:12544
    ds_read_b64_tr_b16 a[222:223], v17 offset:18688
    s_waitcnt lgkmcnt(0)
    v_mfma_f32_16x16x32_bf16 a[96:99], a[208:211], v[196:199], a[96:99]
    v_mfma_f32_16x16x32_bf16 a[96:99], a[212:215], v[208:211], a[96:99]
    v_mfma_f32_16x16x32_bf16 a[100:103], a[208:211], v[200:203], a[100:103]
    v_mfma_f32_16x16x32_bf16 a[100:103], a[212:215], v[212:215], a[100:103]
    v_mfma_f32_16x16x32_bf16 a[104:107], a[208:211], v[204:207], a[104:107]
    v_mfma_f32_16x16x32_bf16 a[104:107], a[212:215], v[216:219], a[104:107]
    v_mfma_f32_16x16x32_bf16 a[108:111], a[216:219], v[196:199], a[108:111]
    v_mfma_f32_16x16x32_bf16 a[108:111], a[220:223], v[208:211], a[108:111]
    v_mfma_f32_16x16x32_bf16 a[112:115], a[216:219], v[200:203], a[112:115]
    v_mfma_f32_16x16x32_bf16 a[112:115], a[220:223], v[212:215], a[112:115]
    v_mfma_f32_16x16x32_bf16 a[116:119], a[216:219], v[204:207], a[116:119]
    v_mfma_f32_16x16x32_bf16 a[116:119], a[220:223], v[216:219], a[116:119]
    ds_read_b64_tr_b16 a[208:209], v18 offset:256
    ds_read_b64_tr_b16 a[210:211], v18 offset:6400
    ds_read_b64_tr_b16 a[212:213], v18 offset:12544
    ds_read_b64_tr_b16 a[214:215], v18 offset:18688
    ds_read_b64_tr_b16 a[216:217], v19 offset:256
    ds_read_b64_tr_b16 a[218:219], v19 offset:6400
    ds_read_b64_tr_b16 a[220:221], v19 offset:12544
    ds_read_b64_tr_b16 a[222:223], v19 offset:18688
    s_waitcnt lgkmcnt(0)
    v_mfma_f32_16x16x32_bf16 a[120:123], a[208:211], v[196:199], a[120:123]
    v_mfma_f32_16x16x32_bf16 a[120:123], a[212:215], v[208:211], a[120:123]
    v_mfma_f32_16x16x32_bf16 a[124:127], a[208:211], v[200:203], a[124:127]
    v_mfma_f32_16x16x32_bf16 a[124:127], a[212:215], v[212:215], a[124:127]
    v_mfma_f32_16x16x32_bf16 a[128:131], a[208:211], v[204:207], a[128:131]
    v_mfma_f32_16x16x32_bf16 a[128:131], a[212:215], v[216:219], a[128:131]
    v_mfma_f32_16x16x32_bf16 a[132:135], a[216:219], v[196:199], a[132:135]
    v_mfma_f32_16x16x32_bf16 a[132:135], a[220:223], v[208:211], a[132:135]
    v_mfma_f32_16x16x32_bf16 a[136:139], a[216:219], v[200:203], a[136:139]
    v_mfma_f32_16x16x32_bf16 a[136:139], a[220:223], v[212:215], a[136:139]
    v_mfma_f32_16x16x32_bf16 a[140:143], a[216:219], v[204:207], a[140:143]
    v_mfma_f32_16x16x32_bf16 a[140:143], a[220:223], v[216:219], a[140:143]
    s_add_u32 s34, s34, 24576
    s_sub_u32 s53, s53, 1
    s_cmp_lg_u32 s53, 0
    s_cbranch_scc1 K1_sl2
    s_nop 7
    s_waitcnt vmcnt(0) lgkmcnt(0)
    s_barrier
    s_branch K1_fin
.section .rodata,"a"
.p2align 6
.amdhsa_kernel concat_heads__mha_block_cached__gqa_block_cached__near_ridge_kernel
  .amdhsa_next_free_vgpr 512
  .amdhsa_next_free_sgpr 102
  .amdhsa_accum_offset 256
  .amdhsa_group_segment_fixed_size 0
  .amdhsa_kernarg_size 104
  .amdhsa_user_sgpr_count 2
  .amdhsa_user_sgpr_kernarg_segment_ptr 1
  .amdhsa_system_sgpr_workgroup_id_x 1
.end_amdhsa_kernel
```
